```python
import torch

def _softmax(x, axis=-1):
    return torch.softmax(x, dim=axis)

def _gelu(x):
    return torch.nn.functional.gelu(x, approximate='tanh')

def _silu(x):
    return torch.nn.functional.silu(x)

def _sigmoid(x):
    return torch.sigmoid(x)

def _layernorm(x, axis=-1, eps=1e-05):
    m = x.mean(dim=axis, keepdim=True)
    v = x.var(dim=axis, keepdim=True, unbiased=False)
    return (x - m) / torch.sqrt(v + eps)

def _scatter_add(tgt, idx, src, axis=0):
    return tgt.clone().index_add_(axis, idx, src)

def _segment_sum(src, seg, n):
    out = torch.zeros((n,) + src.shape[1:], dtype=src.dtype)
    return out.index_add_(0, seg, src)

def _pad(x, pw):
    flat = tuple((v for pair in reversed(pw) for v in pair))
    return torch.nn.functional.pad(x, flat)
kernel_name = 'adaLN_cond__sliding_block__glu_gated_geglu__prompt'

def setup_inputs():

    _w = lambda a: (lambda t: t.to(torch.bfloat16) if t.is_floating_point() else t)(torch.as_tensor(a))

    def _A_setup():
        B, S, D = (1, 2048, 448)
        return {'x': _w((lambda *s: torch.randn(*s, dtype=torch.bfloat16) * 0.05)(B, S, D)), 'wqkv': _w((lambda *s: torch.randn(*s, dtype=torch.bfloat16) * 0.05)(D, 3 * D)), 'wo': _w((lambda *s: torch.randn(*s, dtype=torch.bfloat16) * 0.05)(D, D))}
    _A_in = _A_setup()

    def _B_setup():
        B, S, Dm, Df = (1, 2048, 448, 1792)
        return {'x': _w((lambda *s: torch.randn(*s, dtype=torch.bfloat16) * 0.05)(B, S, Dm)), 'w_gate': _w((lambda *s: torch.randn(*s, dtype=torch.bfloat16) * 0.8)(Dm, Df) * Dm ** (-0.5)), 'w_up': _w((lambda *s: torch.randn(*s, dtype=torch.bfloat16) * 0.8)(Dm, Df) * Dm ** (-0.5)), 'w_down': _w((lambda *s: torch.randn(*s, dtype=torch.bfloat16) * 0.8)(Df, Dm) * Df ** (-0.5))}
    _B_in = _B_setup()
    return {'A_x': _A_in['x'], 'A_wqkv': _A_in['wqkv'], 'A_wo': _A_in['wo'], 'B_x': _B_in['x'], 'B_w_gate': _B_in['w_gate'], 'B_w_up': _B_in['w_up'], 'B_w_down': _B_in['w_down'], 'c': _w((lambda *s: torch.randn(*s, dtype=torch.bfloat16) * 0.1)(1, 448) * 8.0), 'w_mod': _w((lambda *s: torch.randn(*s, dtype=torch.bfloat16) * 0.1)(448, 6 * 448) * 448 ** (-0.5) * 8.0)}

def reference(A_x, A_wqkv, A_wo, B_x, B_w_gate, B_w_up, B_w_down, c, w_mod):

    def _A_ref(x, wqkv, wo):
        B, S, D = x.shape
        H = 16
        Dh = D // H
        W = 256
        qkv = (lambda x, *d: x.permute(*d))((x @ wqkv).reshape(B, S, 3, H, Dh), 2, 0, 3, 1, 4)
        q, k, v = (qkv[0], qkv[1], qkv[2])
        scores = torch.einsum('bhqd,bhkd->bhqk', q, k) * Dh ** (-0.5)
        idx = torch.arange(S)
        mask = (idx[:, None] - idx[None, :] >= 0) & (idx[:, None] - idx[None, :] < W)
        scores = torch.where(mask[None, None], scores, -1000000000.0)
        p = _softmax(scores, axis=-1)
        o = torch.einsum('bhqk,bhkd->bhqd', p, v)
        return (lambda x, *d: x.permute(*d))(o, 0, 2, 1, 3).reshape(B, S, D) @ wo

    def _B_ref(x, w_gate, w_up, w_down):
        g = torch.einsum('bsd,df->bsf', x, w_gate)
        u = torch.einsum('bsd,df->bsf', x, w_up)
        h = _gelu(g) * u
        return torch.einsum('bsf,fd->bsd', h, w_down)
    x = A_x
    mod = (_silu(c) @ w_mod).reshape(c.shape[0], 6, 1, -1)
    sa, ca, ga, sb, cb, gb = (mod[:, 0].clone(), mod[:, 1].clone(), mod[:, 2].clone(), mod[:, 3].clone(), mod[:, 4].clone(), mod[:, 5].clone())
    h = _layernorm(x, axis=-1) * (1 + ca) + sa
    x = x + ga * _A_ref(h, A_wqkv, A_wo)
    h = _layernorm(x, axis=-1) * (1 + cb) + sb
    x = x + gb * _B_ref(h, B_w_gate, B_w_up, B_w_down)
    return x
```

```asm
; @launch kernel=k1_main_kernel grid=(256,1,1) block=(256,1,1) lds=163840
.amdgcn_target "amdgcn-amd-amdhsa--gfx950"
.text
.globl k1_main_kernel
.p2align 8
.type k1_main_kernel,@function
k1_main_kernel:
    s_cmp_ge_u32 s2, 256
    s_cbranch_scc1 k3_end
    s_memrealtime s[94:95]
    s_load_dwordx2 s[12:13], s[0:1], 0
    s_load_dwordx2 s[88:89], s[0:1], 8
    s_load_dwordx2 s[24:25], s[0:1], 56
    s_load_dwordx2 s[20:21], s[0:1], 64
    s_load_dwordx2 s[16:17], s[0:1], 88
    s_load_dwordx2 s[4:5], s[0:1], 0
    s_load_dwordx2 s[44:45], s[0:1], 72
    s_load_dwordx4 s[72:75], s[0:1], 32
    s_load_dwordx2 s[76:77], s[0:1], 48
    s_load_dwordx2 s[84:85], s[0:1], 16
    s_lshr_b32 s10, s2, 3
    s_cmp_ge_u32 s10, 2
    s_cbranch_scc1 k1_nopf
    s_getpc_b64 s[40:41]
k1_pc:
    s_sub_u32 s40, s40, k1_pc-k1_main_kernel
    s_subb_u32 s41, s41, 0
    s_and_b32 s41, s41, 0xffff
    s_mov_b32 s42, code_end-k1_main_kernel
    s_mov_b32 s43, 0x00020000
    s_lshl_b32 s11, s10, 15
    v_lshlrev_b32 v254, 7, v0
    buffer_load_dword v254, v254, s[40:43], s11 offen
k1_nopf:
    v_lshrrev_b32 v3, 6, v0
    v_and_b32 v2, 63, v0
    s_and_b32 s11, s10, 3
    v_readfirstlane_b32 s3, v3
    s_lshr_b32 s46, s10, 2
    s_bfe_u32 s47, s2, 0x10002
    s_lshl_b32 s56, s47, 3
    s_add_u32 s56, s56, s46
    s_and_b32 s57, s2, 3
    s_lshl_b32 s57, s57, 2
    s_add_u32 s57, s57, s11
    s_bfm_b32 s48, s57, 0
    s_and_b32 s50, s48, 0x2a54
    s_bcnt1_i32_b32 s50, s50
    s_sub_u32 s51, s57, s50
    s_mul_i32 s46, s46, 20
    s_mul_i32 s47, s47, 10
    s_add_u32 s46, s46, s47
    s_add_u32 s46, s46, s51
    s_mul_i32 s47, s56, 6
    s_add_u32 s47, s47, s50
    s_add_u32 s47, s47, 160
    s_lshr_b32 s48, 0x2a54, s57
    s_bitcmp1_b32 s48, 0
    s_cselect_b32 s55, s47, s46
    s_sub_u32 s10, s55, 76
    s_lshl_b32 s59, s56, 2
    s_add_u32 s59, s59, s3
    s_mul_i32 s92, s59, 28672
    s_lshl_b32 s49, s3, 12
    s_add_u32 s49, s49, 59392
    s_lshl_b32 s68, s3, 11
    s_mul_i32 s79, s3, 43008
    s_mul_i32 s47, s57, 56
    s_add_u32 s79, s79, s47
    s_add_u32 s93, s79, 896
    s_add_u32 s78, s79, 768
    v_lshrrev_b32 v8, 3, v2
    v_and_b32 v9, 7, v2
    v_lshrrev_b32 v4, 4, v2
    v_xor_b32 v3, v4, v9
    v_mul_u32_u24 v169, 896, v8
    v_lshl_add_u32 v169, v3, 4, v169
    v_xor_b32 v170, 64, v169
    v_add_u32 v171, 12288, v169
    v_add_u32 v176, 18432, v170
    v_add_u32 v170, 6144, v170
    v_lshrrev_b32 v74, 2, v2
    v_and_b32 v7, 3, v2
    v_mul_u32_u24 v168, 2688, v74
    v_lshlrev_b32 v3, 4, v7
    v_min_u32 v3, 40, v3
    v_add_u32 v168, v168, v3
    v_and_b32 v34, 31, v2
    v_lshrrev_b32 v35, 5, v2
    s_mov_b32 s14, 0x1c0000
    s_mov_b32 s15, 0x00020000
    s_mov_b32 s90, 0x126000
    s_mov_b32 s91, 0x00020000
    s_waitcnt lgkmcnt(0)
    s_lshr_b64 s[96:97], s[94:95], 6
    s_and_b32 s13, s13, 0xffff
    s_and_b32 s89, s89, 0xffff
    s_cmp_ge_u32 s10, 84
    s_cbranch_scc1 k1_norole1
    s_and_b32 s21, s21, 0xffff
    s_mov_b32 s22, 0x24c000
    s_mov_b32 s23, 0x00020000
    s_and_b32 s25, s25, 0xffff
    s_mov_b32 s26, 0x380
    s_mov_b32 s27, 0x00020000
    s_mul_i32 s28, s3, 224
    v_lshlrev_b32 v64, 1, v2
    buffer_load_ushort v72, v64, s[24:27], s28 offen
    buffer_load_ushort v73, v64, s[24:27], s28 offen offset:128
    s_mul_i32 s28, s3, 602112
    s_lshl_b32 s29, s10, 6
    s_add_u32 s28, s28, s29
    v_mul_u32_u24 v64, 5376, v74
    v_lshl_add_u32 v64, v7, 4, v64
    buffer_load_dwordx4 v[96:99], v64, s[20:23], s28 offen
    s_add_u32 s28, s28, 86016
    buffer_load_dwordx4 v[100:103], v64, s[20:23], s28 offen
    s_add_u32 s28, s28, 86016
    buffer_load_dwordx4 v[104:107], v64, s[20:23], s28 offen
    s_add_u32 s28, s28, 86016
    buffer_load_dwordx4 v[108:111], v64, s[20:23], s28 offen
    s_add_u32 s28, s28, 86016
    buffer_load_dwordx4 v[112:115], v64, s[20:23], s28 offen
    s_add_u32 s28, s28, 86016
    buffer_load_dwordx4 v[116:119], v64, s[20:23], s28 offen
    s_add_u32 s28, s28, 86016
    buffer_load_dwordx4 v[120:123], v64, s[20:23], s28 offen
k1_norole1:
    s_and_b32 s17, s17, 0xffff
    s_mov_b32 s18, 0x3000000
    s_mov_b32 s19, 0x00020000
    s_sub_u32 s61, s96, 20
    v_mov_b32 v39, s96
    v_and_b32 v3, 15, v2
    v_lshlrev_b32 v5, 4, v2
    v_add_u32 v6, 49152, v5
    s_cmp_ge_u32 s10, 84
    s_cbranch_scc1 k1_norole2
    v_lshlrev_b32 v74, 2, v74
    v_mov_b32 v64, 0
    v_mov_b32 v65, 0
    v_mov_b32 v66, 0
    v_mov_b32 v67, 0
    v_mov_b32 v68, 0
    v_mov_b32 v69, 0
    v_mov_b32 v70, 0
    v_mov_b32 v71, 0
    s_waitcnt vmcnt(7)
    v_lshlrev_b32 v72, 16, v72
    v_lshlrev_b32 v73, 16, v73
    v_mul_f32 v76, 0xbfb8aa3b, v72
    v_mul_f32 v77, 0xbfb8aa3b, v73
    v_exp_f32 v76, v76
    v_exp_f32 v77, v77
    s_nop 0
    v_add_f32 v76, 1.0, v76
    v_add_f32 v77, 1.0, v77
    v_rcp_f32 v76, v76
    v_rcp_f32 v77, v77
    s_nop 0
    v_mul_f32 v72, v72, v76
    v_mul_f32 v73, v73, v77
    v_cvt_pk_bf16_f32 v72, v72, v72
    v_cvt_pk_bf16_f32 v73, v73, v73
    ds_bpermute_b32 v224, v74, v72 offset:0
    ds_bpermute_b32 v225, v74, v72 offset:64
    ds_bpermute_b32 v226, v74, v72 offset:128
    ds_bpermute_b32 v227, v74, v72 offset:192
    ds_bpermute_b32 v228, v74, v73 offset:0
    ds_bpermute_b32 v229, v74, v73 offset:64
    ds_bpermute_b32 v230, v74, v73 offset:128
    v_and_b32 v75, 1, v4
    v_lshlrev_b32 v75, 1, v75
    v_lshrrev_b32 v76, 1, v4
    v_or_b32 v75, v75, v76
    v_lshl_add_u32 v75, v7, 3, v75
    s_lshl_b32 s28, s3, 8
    s_add_u32 s28, s28, 157696
    v_lshl_add_u32 v75, v75, 2, s28
    s_sub_u32 s28, s10, 14
    s_sub_u32 s29, s10, 56
    s_min_u32 s28, s28, s29
    s_cmp_lt_u32 s28, 14
    s_cselect_b32 s28, 1.0, 0
    s_lshl_b32 s29, s10, 7
    s_mul_i32 s30, s3, 17408
    s_add_u32 s30, s30, s29
    s_add_u32 s30, s30, 0x80000
    s_lshr_b32 s31, s29, 1
    s_add_u32 s31, s31, 0x8000
    s_cmp_lt_u32 s10, 28
    s_cselect_b32 s30, s30, 0x7f000000
    s_cmp_eq_u32 s3, 0
    s_cselect_b32 s31, s31, 0x7f000000
    s_cmp_eq_u32 s3, 1
    s_cselect_b32 s29, s29, 0x7f000000
    v_lshlrev_b32 v82, 3, v3
    v_add_u32 v83, 157696, v82
    v_mul_u32_u24 v84, 4352, v4
    v_add_u32 v84, v84, v82
    v_lshrrev_b32 v85, 1, v82
    s_waitcnt lgkmcnt(6)
    v_and_b32 v238, 0xffff, v224
    v_and_b32 v224, 0xffff0000, v224
    s_waitcnt lgkmcnt(5)
    v_and_b32 v239, 0xffff, v225
    v_and_b32 v225, 0xffff0000, v225
    s_waitcnt lgkmcnt(4)
    v_and_b32 v240, 0xffff, v226
    v_and_b32 v226, 0xffff0000, v226
    s_waitcnt lgkmcnt(3)
    v_and_b32 v241, 0xffff, v227
    v_and_b32 v227, 0xffff0000, v227
    s_waitcnt lgkmcnt(2)
    v_and_b32 v242, 0xffff, v228
    v_and_b32 v228, 0xffff0000, v228
    s_waitcnt lgkmcnt(1)
    v_and_b32 v243, 0xffff, v229
    v_and_b32 v229, 0xffff0000, v229
    s_waitcnt lgkmcnt(0)
    v_and_b32 v244, 0xffff, v230
    v_and_b32 v230, 0xffff0000, v230
    v_mov_b32 v73, v39
    s_waitcnt vmcnt(6)
    v_dot2_f32_bf16 v64, v96, v238, v64
    v_dot2_f32_bf16 v65, v96, v224, v65
    v_dot2_f32_bf16 v66, v97, v238, v66
    v_dot2_f32_bf16 v67, v97, v224, v67
    v_dot2_f32_bf16 v68, v98, v238, v68
    v_dot2_f32_bf16 v69, v98, v224, v69
    v_dot2_f32_bf16 v70, v99, v238, v70
    v_dot2_f32_bf16 v71, v99, v224, v71
    s_waitcnt vmcnt(5)
    v_dot2_f32_bf16 v64, v100, v239, v64
    v_dot2_f32_bf16 v65, v100, v225, v65
    v_dot2_f32_bf16 v66, v101, v239, v66
    v_dot2_f32_bf16 v67, v101, v225, v67
    v_dot2_f32_bf16 v68, v102, v239, v68
    v_dot2_f32_bf16 v69, v102, v225, v69
    v_dot2_f32_bf16 v70, v103, v239, v70
    v_dot2_f32_bf16 v71, v103, v225, v71
    s_waitcnt vmcnt(4)
    v_dot2_f32_bf16 v64, v104, v240, v64
    v_dot2_f32_bf16 v65, v104, v226, v65
    v_dot2_f32_bf16 v66, v105, v240, v66
    v_dot2_f32_bf16 v67, v105, v226, v67
    v_dot2_f32_bf16 v68, v106, v240, v68
    v_dot2_f32_bf16 v69, v106, v226, v69
    v_dot2_f32_bf16 v70, v107, v240, v70
    v_dot2_f32_bf16 v71, v107, v226, v71
    s_waitcnt vmcnt(3)
    v_dot2_f32_bf16 v64, v108, v241, v64
    v_dot2_f32_bf16 v65, v108, v227, v65
    v_dot2_f32_bf16 v66, v109, v241, v66
    v_dot2_f32_bf16 v67, v109, v227, v67
    v_dot2_f32_bf16 v68, v110, v241, v68
    v_dot2_f32_bf16 v69, v110, v227, v69
    v_dot2_f32_bf16 v70, v111, v241, v70
    v_dot2_f32_bf16 v71, v111, v227, v71
    s_waitcnt vmcnt(2)
    v_dot2_f32_bf16 v64, v112, v242, v64
    v_dot2_f32_bf16 v65, v112, v228, v65
    v_dot2_f32_bf16 v66, v113, v242, v66
    v_dot2_f32_bf16 v67, v113, v228, v67
    v_dot2_f32_bf16 v68, v114, v242, v68
    v_dot2_f32_bf16 v69, v114, v228, v69
    v_dot2_f32_bf16 v70, v115, v242, v70
    v_dot2_f32_bf16 v71, v115, v228, v71
    s_waitcnt vmcnt(1)
    v_dot2_f32_bf16 v64, v116, v243, v64
    v_dot2_f32_bf16 v65, v116, v229, v65
    v_dot2_f32_bf16 v66, v117, v243, v66
    v_dot2_f32_bf16 v67, v117, v229, v67
    v_dot2_f32_bf16 v68, v118, v243, v68
    v_dot2_f32_bf16 v69, v118, v229, v69
    v_dot2_f32_bf16 v70, v119, v243, v70
    v_dot2_f32_bf16 v71, v119, v229, v71
    s_waitcnt vmcnt(0)
    v_dot2_f32_bf16 v64, v120, v244, v64
    v_dot2_f32_bf16 v65, v120, v230, v65
    v_dot2_f32_bf16 v66, v121, v244, v66
    v_dot2_f32_bf16 v67, v121, v230, v67
    v_dot2_f32_bf16 v68, v122, v244, v68
    v_dot2_f32_bf16 v69, v122, v230, v69
    v_dot2_f32_bf16 v70, v123, v244, v70
    v_dot2_f32_bf16 v71, v123, v230, v71
    s_nop 2
    v_permlane32_swap_b32 v64, v65
    v_permlane32_swap_b32 v66, v67
    v_permlane32_swap_b32 v68, v69
    v_permlane32_swap_b32 v70, v71
    s_nop 0
    v_add_f32 v76, v64, v65
    v_add_f32 v77, v66, v67
    v_add_f32 v78, v68, v69
    v_add_f32 v79, v70, v71
    s_nop 0
    v_permlane16_swap_b32 v76, v77
    v_permlane16_swap_b32 v78, v79
    s_nop 0
    v_add_f32 v80, v76, v77
    v_add_f32 v81, v78, v79
    s_nop 1
    v_add_f32_dpp v80, v80, v80 row_ror:8 row_mask:0xf bank_mask:0xf
    v_add_f32_dpp v81, v81, v81 row_ror:8 row_mask:0xf bank_mask:0xf
    s_nop 1
    v_add_f32_dpp v80, v80, v80 row_ror:4 row_mask:0xf bank_mask:0xf
    v_add_f32_dpp v81, v81, v81 row_ror:4 row_mask:0xf bank_mask:0xf
    ds_write2_b32 v75, v80, v81 offset0:0 offset1:4
    s_waitcnt lgkmcnt(0)
    s_barrier
    ds_read_b64 v[64:65], v83 offset:0
    ds_read_b64 v[66:67], v83 offset:256
    ds_read_b64 v[68:69], v83 offset:512
    ds_read_b64 v[70:71], v83 offset:768
    s_waitcnt lgkmcnt(0)
    v_pk_add_f32 v[64:65], v[64:65], v[66:67]
    v_pk_add_f32 v[68:69], v[68:69], v[70:71]
    v_pk_add_f32 v[64:65], v[64:65], v[68:69]
    v_cvt_pk_bf16_f32 v66, v64, v65
    v_lshlrev_b32 v64, 16, v66
    v_and_b32 v65, 0xffff0000, v66
    v_add_f32 v64, s28, v64
    v_add_f32 v65, s28, v65
    v_cvt_pk_bf16_f32 v72, v64, v65
    buffer_store_dwordx2 v[72:73], v84, s[16:19], s30 offen sc1
    v_lshlrev_b32 v64, 16, v72
    v_and_b32 v65, 0xffff0000, v72
    s_mov_b64 exec, 0xffff
    buffer_store_dword v72, v85, s[16:19], s31 offen sc1
    buffer_store_dwordx2 v[64:65], v82, s[16:19], s29 offen sc1
    s_mov_b64 exec, -1
k1_norole2:
    s_mov_b32 m0, s68
    s_add_u32 s68, s68, 8192
    buffer_load_dwordx4 v168, s[88:91], s93 offen lds
    v_lshrrev_b32 v1, 3, v2
    v_min_u32 v1, 6, v1
    v_lshlrev_b32 v1, 8, v1
    v_lshl_add_u32 v1, v7, 4, v1
    v_bfe_u32 v10, v2, 2, 1
    v_xor_b32 v10, 1, v10
    v_mul_u32_u24 v10, 1792, v10
    v_add_u32 v212, v1, v10
    s_mul_i32 s64, s56, 4352
    s_lshl_b32 s65, s3, 6
    s_add_u32 s64, s64, s65
    s_add_u32 s64, s64, 0x80000
    v_bfe_u32 v1, v34, 1, 3
    v_xor_b32 v1, v1, v35
    v_lshlrev_b32 v1, 4, v1
    v_lshl_add_u32 v1, v34, 7, v1
    v_add_u32 v172, s49, v1
    v_xor_b32 v173, 32, v172
    v_xor_b32 v174, 64, v172
    v_xor_b32 v175, 96, v172
    v_bfe_u32 v1, v2, 2, 2
    v_lshl_add_u32 v1, v35, 3, v1
    v_and_b32 v11, 1, v4
    buffer_load_dwordx4 v168, s[88:91], s78 offen offset:1024 lds
    s_add_u32 s93, s93, 172032
    s_add_u32 s78, s78, 172032
    v_lshl_add_u32 v11, v11, 2, v7
    v_lshrrev_b32 v10, 1, v11
    v_cmp_eq_u32 vcc, 3, v10
    v_xor_b32 v10, 1, v11
    v_lshlrev_b32 v1, 6, v1
    v_cndmask_b32 v11, v11, v10, vcc
    v_lshl_add_u32 v1, v11, 3, v1
    s_lshl_b32 s51, s3, 11
    v_add_u32 v201, s51, v1
    v_add_u32 v179, s49, v1
    v_add_u32 v12, s51, v5
    v_add_u32 v13, s49, v5
    v_mov_b32 v36, 0x3f803f80
    v_mov_b32 v45, 0xffff
    v_mov_b32 v16, 0
    v_mov_b32 v17, 0
    v_mov_b32 v18, 0
    v_mov_b32 v19, 0
    s_lshl_b32 s20, s55, 2
    s_add_u32 s20, s20, s3
    v_bfe_u32 v1, v2, 4, 1
    v_xor_b32 v1, v1, v9
    s_add_u32 m0, s49, 0
    s_nop 0
    buffer_load_dwordx4 v169, s[12:15], s92 offen offset:0 lds
    v_lshlrev_b32 v1, 4, v1
    v_bfe_u32 v10, v2, 2, 2
    v_bfe_u32 v11, v2, 3, 1
    s_cmp_lt_u32 s20, 392
    s_cbranch_scc1 k1_pk_wgu
    s_mov_b32 s11, 8
    v_lshl_add_u32 v208, v4, 3, v10
    v_lshl_add_u32 v11, v4, 1, v11
    v_xor_b32 v11, v11, v7
    v_lshlrev_b32 v11, 4, v11
    v_lshl_add_u32 v208, v208, 7, v11
    s_mov_b64 s[28:29], s[76:77]
    s_mov_b64 s[32:33], s[76:77]
    s_mov_b32 s30, 0x188000
    s_sub_u32 s20, s20, 392
    s_mul_i32 s23, s20, 149797
    s_lshr_b32 s21, s23, 20
    s_mul_i32 s23, s21, 7
    s_sub_u32 s22, s20, s23
    s_lshl_b32 s20, s21, 2
    s_lshl_b32 s23, s22, 7
    s_and_b32 s25, s20, 15
    s_lshr_b32 s36, s20, 4
    s_mul_i32 s25, s25, 7
    s_add_u32 s36, s36, s25
    s_lshl_b32 s36, s36, 4
    s_mul_i32 s36, s36, 896
    s_add_u32 s36, s36, s23
    s_add_u32 s20, s20, 1
    s_and_b32 s25, s20, 15
    s_lshr_b32 s37, s20, 4
    s_mul_i32 s25, s25, 7
    s_add_u32 s37, s37, s25
    s_lshl_b32 s37, s37, 4
    s_mul_i32 s37, s37, 896
    s_add_u32 s37, s37, s23
    s_add_u32 s20, s20, 1
    s_and_b32 s25, s20, 15
    s_lshr_b32 s38, s20, 4
    s_mul_i32 s25, s25, 7
    s_add_u32 s38, s38, s25
    s_lshl_b32 s38, s38, 4
    s_mul_i32 s38, s38, 896
    s_add_u32 s38, s38, s23
    s_add_u32 s20, s20, 1
    s_and_b32 s25, s20, 15
    s_lshr_b32 s39, s20, 4
    s_mul_i32 s25, s25, 7
    s_add_u32 s39, s39, s25
    s_lshl_b32 s39, s39, 4
    s_mul_i32 s39, s39, 896
    s_add_u32 s39, s39, s23
    s_mul_i32 s70, s22, 28
    s_add_u32 s70, s70, s21
    s_lshl_b32 s70, s70, 13
    s_add_u32 s70, s70, 0x800000
    s_cmp_lt_u32 s21, 28
    s_cselect_b32 s70, s70, 0x7f000000
    s_cselect_b32 s30, s30, 0
    s_movk_i32 s40, 7168
    v_mul_u32_u24 v204, 896, v8
    s_add_u32 s71, s70, 1024
    s_add_u32 s72, s70, 2048
    s_add_u32 s73, s70, 3072
    s_add_u32 s74, s70, 4096
    s_add_u32 s75, s70, 5120
    s_add_u32 s76, s70, 6144
    s_add_u32 s77, s70, 7168
    s_branch k1_pk_go
k1_pk_wgu:
    s_mov_b64 s[28:29], s[72:73]
    s_mov_b64 s[32:33], s[74:75]
    s_mov_b32 s30, 0x188000
    s_mov_b32 s11, 32
    s_mul_i32 s23, s20, 37450
    s_lshr_b32 s21, s23, 20
    s_mul_i32 s23, s21, 28
    s_sub_u32 s22, s20, s23
    s_mul_i32 s36, s21, 114688
    s_lshl_b32 s23, s22, 7
    s_add_u32 s36, s36, s23
    s_mov_b32 s37, s36
    s_add_u32 s38, s36, 57344
    s_mov_b32 s39, s38
    s_movk_i32 s40, 28672
    s_lshl_b32 s27, s21, 1
    s_lshl_b32 s20, s22, 2
    s_mul_i32 s23, s20, 149797
    s_lshr_b32 s21, s23, 20
    s_mul_i32 s23, s21, 7
    s_sub_u32 s22, s20, s23
    s_mov_b32 s24, 3
    s_mov_b32 s25, 0
    s_cmp_ge_u32 s22, 3
    s_cselect_b32 s24, 1, s24
    s_cselect_b32 s25, 81, s25
    s_cmp_ge_u32 s22, 4
    s_cselect_b32 s24, 1, s24
    s_cselect_b32 s25, 108, s25
    s_cmp_ge_u32 s22, 5
    s_cselect_b32 s24, 1, s24
    s_cselect_b32 s25, 135, s25
    s_cmp_ge_u32 s22, 6
    s_cselect_b32 s24, 1, s24
    s_cselect_b32 s25, 162, s25
    s_add_u32 s25, s25, s22
    s_mul_i32 s26, s24, s27
    s_add_u32 s25, s25, s26
    s_lshl_b32 s25, s25, 10
    s_mul_i32 s70, s21, 207872
    s_add_u32 s70, s70, s25
    s_add_u32 s70, s70, 0x400000
    s_lshl_b32 s24, s24, 10
    s_add_u32 s74, s70, s24
    s_add_u32 s20, s20, 1
    s_mul_i32 s23, s20, 149797
    s_lshr_b32 s21, s23, 20
    s_mul_i32 s23, s21, 7
    s_sub_u32 s22, s20, s23
    s_mov_b32 s24, 3
    s_mov_b32 s25, 0
    s_cmp_ge_u32 s22, 3
    s_cselect_b32 s24, 1, s24
    s_cselect_b32 s25, 81, s25
    s_cmp_ge_u32 s22, 4
    s_cselect_b32 s24, 1, s24
    s_cselect_b32 s25, 108, s25
    s_cmp_ge_u32 s22, 5
    s_cselect_b32 s24, 1, s24
    s_cselect_b32 s25, 135, s25
    s_cmp_ge_u32 s22, 6
    s_cselect_b32 s24, 1, s24
    s_cselect_b32 s25, 162, s25
    s_add_u32 s25, s25, s22
    s_mul_i32 s26, s24, s27
    s_add_u32 s25, s25, s26
    s_lshl_b32 s25, s25, 10
    s_mul_i32 s71, s21, 207872
    s_add_u32 s71, s71, s25
    s_add_u32 s71, s71, 0x400000
    s_lshl_b32 s24, s24, 10
    s_add_u32 s75, s71, s24
    s_add_u32 s20, s20, 1
    s_mul_i32 s23, s20, 149797
    s_lshr_b32 s21, s23, 20
    s_mul_i32 s23, s21, 7
    s_sub_u32 s22, s20, s23
    s_mov_b32 s24, 3
    s_mov_b32 s25, 0
    s_cmp_ge_u32 s22, 3
    s_cselect_b32 s24, 1, s24
    s_cselect_b32 s25, 81, s25
    s_cmp_ge_u32 s22, 4
    s_cselect_b32 s24, 1, s24
    s_cselect_b32 s25, 108, s25
    s_cmp_ge_u32 s22, 5
    s_cselect_b32 s24, 1, s24
    s_cselect_b32 s25, 135, s25
    s_cmp_ge_u32 s22, 6
    s_cselect_b32 s24, 1, s24
    s_cselect_b32 s25, 162, s25
    s_add_u32 s25, s25, s22
    s_mul_i32 s26, s24, s27
    s_add_u32 s25, s25, s26
    s_lshl_b32 s25, s25, 10
    s_mul_i32 s72, s21, 207872
    s_add_u32 s72, s72, s25
    s_add_u32 s72, s72, 0x400000
    s_lshl_b32 s24, s24, 10
    s_add_u32 s76, s72, s24
    s_add_u32 s20, s20, 1
    s_mul_i32 s23, s20, 149797
    s_lshr_b32 s21, s23, 20
    s_mul_i32 s23, s21, 7
    s_sub_u32 s22, s20, s23
    s_mov_b32 s24, 3
    s_mov_b32 s25, 0
    s_cmp_ge_u32 s22, 3
    s_cselect_b32 s24, 1, s24
    s_cselect_b32 s25, 81, s25
    s_cmp_ge_u32 s22, 4
    s_cselect_b32 s24, 1, s24
    s_cselect_b32 s25, 108, s25
    s_cmp_ge_u32 s22, 5
    s_cselect_b32 s24, 1, s24
    s_cselect_b32 s25, 135, s25
    s_cmp_ge_u32 s22, 6
    s_cselect_b32 s24, 1, s24
    s_cselect_b32 s25, 162, s25
    s_add_u32 s25, s25, s22
    s_mul_i32 s26, s24, s27
    s_add_u32 s25, s25, s26
    s_lshl_b32 s25, s25, 10
    s_mul_i32 s73, s21, 207872
    s_add_u32 s73, s73, s25
    s_add_u32 s73, s73, 0x400000
    s_lshl_b32 s24, s24, 10
    s_add_u32 s77, s73, s24
    v_and_b32 v208, 1, v4
    v_lshl_add_u32 v208, v208, 1, v35
    v_lshl_add_u32 v11, v208, 1, v11
    v_lshl_add_u32 v208, v208, 3, v10
    v_and_b32 v10, 1, v7
    v_xor_b32 v11, v11, v10
    v_lshlrev_b32 v11, 4, v11
    v_lshl_add_u32 v208, v208, 7, v11
    v_lshrrev_b32 v10, 1, v7
    v_lshl_add_u32 v208, v10, 3, v208
    v_mul_u32_u24 v204, 3584, v8
k1_pk_go:
    buffer_load_dwordx4 v170, s[12:15], s92 offen offset:1024 lds
    buffer_load_dwordx4 v171, s[12:15], s92 offen offset:2048 lds
    buffer_load_dwordx4 v176, s[12:15], s92 offen offset:3072 lds
    s_add_u32 s92, s92, 128
    s_mov_b32 m0, s68
    s_add_u32 s68, s68, 8192
    buffer_load_dwordx4 v168, s[88:91], s93 offen lds
    buffer_load_dwordx4 v168, s[88:91], s78 offen offset:1024 lds
    s_add_u32 s93, s93, 172032
    s_add_u32 s78, s78, 172032
    s_mov_b32 m0, s68
    s_add_u32 s68, s68, 8192
    buffer_load_dwordx4 v168, s[88:91], s93 offen lds
    buffer_load_dwordx4 v168, s[88:91], s78 offen offset:1024 lds
    s_add_u32 s93, s93, 172032
    s_add_u32 s78, s78, 172032
    s_add_u32 m0, s49, 16384
    s_nop 0
    buffer_load_dwordx4 v169, s[12:15], s92 offen offset:0 lds
    buffer_load_dwordx4 v170, s[12:15], s92 offen offset:1024 lds
    v_add_u32 v204, v204, v1
    s_add_u32 s20, s49, 32768
    v_add_u32 v0, s20, v208
    v_accvgpr_write_b32 a176, v204
    s_mov_b32 s34, s30
    s_mov_b32 s31, 0x00020000
    s_mov_b32 s35, 0x00020000
    s_and_b32 s29, s29, 0xffff
    s_and_b32 s33, s33, 0xffff
    s_add_u32 s53, s49, 19456
    v_lshl_add_u32 v213, v2, 3, s53
    buffer_load_dwordx4 v171, s[12:15], s92 offen offset:2048 lds
    v_cmp_eq_u32 vcc, 16, v34
    v_lshl_add_u32 v214, v35, 4, s53
    v_add_u32 v1, 32, v214
    v_add_u32 v15, 512, v214
    v_cndmask_b32 v214, v214, v1, vcc
    v_bfe_u32 v1, v34, 1, 1
    v_bfe_u32 v10, v34, 3, 2
    v_lshl_add_u32 v1, v10, 1, v1
    v_bfe_u32 v10, v34, 2, 1
    v_xor_b32 v10, v10, v35
    v_lshl_add_u32 v1, v10, 3, v1
    v_and_b32 v10, 1, v34
    v_lshlrev_b32 v10, 4, v10
    v_lshlrev_b32 v10, v10, v45
    v_and_b32 v11, 0x1b, v34
    v_cmp_eq_u32 s[42:43], 16, v11
    v_cmp_eq_u32 vcc, 0, v1
    s_nop 1
    v_cndmask_b32 v28, 0, v10, vcc
    v_cndmask_b32 v28, v28, -1, s[42:43]
    v_cmp_eq_u32 vcc, 1, v1
    s_nop 1
    buffer_load_dwordx4 v176, s[12:15], s92 offen offset:3072 lds
    s_add_u32 s92, s92, 128
    v_cndmask_b32 v29, 0, v10, vcc
    v_cndmask_b32 v29, v29, -1, s[42:43]
    v_cmp_eq_u32 vcc, 2, v1
    s_nop 1
    v_cndmask_b32 v30, 0, v10, vcc
    v_cndmask_b32 v30, v30, -1, s[42:43]
    v_cmp_eq_u32 vcc, 3, v1
    s_nop 1
    v_cndmask_b32 v31, 0, v10, vcc
    v_cndmask_b32 v31, v31, -1, s[42:43]
    s_lshl_b32 s53, s3, 2
    s_add_u32 s53, s53, 57344
    v_add_u32 v14, s53, v5
    v_mov_b32 v32, 0
    v_mov_b32 v33, 0
    v_mov_b32 v10, 0
    s_mov_b32 s6, 0
    s_mov_b32 s7, -1
    s_and_b32 s8, s57, 7
    s_lshr_b32 s58, s57, 3
    s_lshl_b32 s9, s56, 1
    s_add_u32 s9, s9, s58
    s_mov_b32 m0, s68
    s_add_u32 s68, s68, 8192
    buffer_load_dwordx4 v168, s[88:91], s93 offen lds
    s_lshl_b32 s55, s55, 2
    s_add_u32 s55, s55, 0x50000
    s_cmp_eq_u32 s3, 0
    s_cselect_b32 s55, s55, 0x7f000000
    s_mul_i32 s51, s56, 1280
    s_add_u32 s51, s51, 0x50000
    v_lshrrev_b32 v11, 1, v2
    v_and_b32 v9, 1, v2
    v_lshl_add_u32 v11, v11, 2, v9
    v_lshlrev_b32 v11, 7, v11
    v_cmp_eq_u32 vcc, 0, v2
    v_mov_b32 v38, 0x7fffffff
    s_nop 0
    v_cndmask_b32 v38, v38, 0, vcc
    s_lshl_b32 s27, s57, 6
    s_add_u32 s27, s27, s59
    s_lshl_b32 s50, s27, 12
    s_add_u32 s50, s50, 0xc00000
    s_add_u32 s27, s27, s3
    s_sub_u32 s27, s27, 8
    s_lshl_b32 s52, s27, 12
    s_add_u32 s52, s52, 0xc00000
    buffer_load_dwordx4 v168, s[88:91], s78 offen offset:1024 lds
    s_add_u32 s93, s93, 172032
    s_add_u32 s78, s78, 172032
    s_lshl_b32 s60, s56, 4
    s_add_u32 s60, s60, s57
    s_lshl_b32 s60, s60, 2
    s_lshr_b32 s53, s3, 1
    s_lshl_b32 s53, s53, 6
    s_add_u32 s53, s53, s60
    s_and_b32 s27, s3, 1
    s_lshl_b32 s27, s27, 1
    s_add_u32 s53, s53, s27
    s_sub_u32 s53, s53, 128
    s_lshl_b32 s53, s53, 7
    s_add_u32 s53, s53, 0x20000
    s_add_u32 s60, s60, s3
    s_lshl_b32 s60, s60, 7
    s_add_u32 s60, s60, 0x20000
    s_lshl_b32 s27, s3, 12
    s_add_u32 s27, s27, 114688
    v_add_u32 v7, s27, v5
    s_lshl_b32 s54, s59, 15
    s_lshl_b32 s27, s57, 10
    s_add_u32 s54, s54, s27
    s_add_u32 s54, s54, 0x1000000
    s_mov_b32 m0, s68
    s_add_u32 s68, s68, 8192
    buffer_load_dwordx4 v168, s[88:91], s93 offen lds
    v_lshrrev_b32 v8, 4, v34
    v_lshlrev_b32 v8, 14, v8
    v_lshl_add_u32 v8, v35, 8, v8
    v_lshl_add_u32 v8, v3, 4, v8
    s_lshl_b32 s47, s56, 4
    s_add_u32 s47, s47, s3
    s_lshl_b32 s47, s47, 1
    s_add_u32 s47, s47, s58
    s_lshl_b32 s47, s47, 8
    s_add_u32 s47, s47, 0x20000
    s_mul_i32 s20, s9, 64
    s_add_u32 s20, s20, s3
    s_lshl_b32 s20, s20, 10
    s_add_u32 s20, s20, 0x1000000
    s_mul_i32 s24, s3, 25088
    s_lshl_b32 s27, s8, 7
    s_add_u32 s24, s24, s27
    s_mul_i32 s22, s57, 207872
    s_add_u32 s22, s22, 0x400000
    s_add_u32 s46, s22, 200704
    s_lshl_b32 s26, s3, 12
    s_add_u32 s22, s22, s26
    buffer_load_dwordx4 v168, s[88:91], s78 offen offset:1024 lds
    s_add_u32 s93, s93, 172032
    s_add_u32 s78, s78, 172032
    s_mul_i32 s23, s3, 3072
    s_mul_i32 s41, s8, 229376
    s_lshl_b32 s27, s3, 12
    s_add_u32 s41, s41, s27
    s_add_u32 s41, s41, 0x800000
    s_cmp_eq_u32 s8, 7
    s_cselect_b32 s41, 0x7f000000, s41
    s_cselect_b32 s24, 0x7f000000, s24
    s_mov_b32 s62, 3
    s_mov_b32 s63, 0
    s_lshl_b32 s80, s59, 8
    s_add_u32 s80, s80, s57
    s_lshl_b32 s80, s80, 9
    s_add_u32 s80, s80, 0x2400000
    s_lshl_b32 s10, s59, 4
    s_add_u32 s10, s10, s57
    s_mul_i32 s10, s10, 1792
    s_add_u32 s10, s10, 0x2000000
    v_accvgpr_write_b32 a252, -1
    v_accvgpr_write_b32 a253, -1
    v_accvgpr_write_b32 a254, -1
    v_accvgpr_write_b32 a255, -1
    s_waitcnt vmcnt(12)
    ds_read_b128 a[0:3], v172 offset:0
    ds_read_b128 a[4:7], v173 offset:0
    ds_read_b128 a[8:11], v174 offset:0
    s_add_u32 m0, s49, 32768
    s_nop 0
    buffer_load_dwordx4 v169, s[12:15], s92 offen offset:0 lds
    ds_read_b128 a[12:15], v175 offset:0
    ds_read_b128 v[64:67], v172 offset:0
    ds_read_b128 v[68:71], v173 offset:0
    buffer_load_dwordx4 v170, s[12:15], s92 offen offset:1024 lds
    ds_read_b128 v[72:75], v174 offset:0
    ds_read_b128 v[76:79], v175 offset:0
    s_waitcnt vmcnt(18)
    buffer_load_dwordx4 v171, s[12:15], s92 offen offset:2048 lds
    ds_read_b64_tr_b16 v[96:97], v201 offset:0
    ds_read_b64_tr_b16 v[98:99], v201 offset:256
    ds_read_b64_tr_b16 v[100:101], v201 offset:1024
    buffer_load_dwordx4 v176, s[12:15], s92 offen offset:3072 lds
    s_add_u32 s92, s92, 128
    ds_read_b64_tr_b16 v[102:103], v201 offset:1280
    s_waitcnt vmcnt(14)
    ds_read_b64_tr_b16 v[104:105], v201 offset:8192
    ds_read_b64_tr_b16 v[106:107], v201 offset:8448
    s_mov_b32 m0, s68
    s_add_u32 s68, s68, 8192
    buffer_load_dwordx4 v168, s[88:91], s93 offen lds
    ds_read_b64_tr_b16 v[108:109], v201 offset:9216
    ds_read_b64_tr_b16 v[110:111], v201 offset:9472
    s_waitcnt vmcnt(13)
    buffer_load_dwordx4 v168, s[88:91], s78 offen offset:1024 lds
    s_add_u32 s93, s93, 172032
    s_add_u32 s78, s78, 172032
    ds_read_b64_tr_b16 v[112:113], v201 offset:16384
    ds_read_b64_tr_b16 v[114:115], v201 offset:16640
    ds_read_b64_tr_b16 v[116:117], v201 offset:17408
    s_mov_b32 m0, s68
    s_add_u32 s68, s68, 8192
    buffer_load_dwordx4 v168, s[88:91], s93 offen lds
    ds_read_b64_tr_b16 v[118:119], v201 offset:17664
    s_waitcnt vmcnt(9)
    ds_read_b64_tr_b16 v[120:121], v201 offset:24576
    buffer_load_dwordx4 v168, s[88:91], s78 offen offset:1024 lds
    ds_read_b64_tr_b16 v[122:123], v201 offset:24832
    ds_read_b64_tr_b16 v[124:125], v201 offset:25600
    ds_read_b64_tr_b16 v[126:127], v201 offset:25856
    s_waitcnt vmcnt(12)
    ds_read_b128 a[16:19], v172 offset:16384
    ds_read_b128 a[20:23], v173 offset:16384
    ds_read_b128 a[24:27], v174 offset:16384
    ds_read_b128 a[28:31], v175 offset:16384
    ds_read_b128 v[80:83], v172 offset:16384
    ds_read_b128 v[84:87], v173 offset:16384
    buffer_load_dwordx4 v[216:219], v212, s[16:19], s64 offen offset:0 sc1
    ds_read_b128 v[88:91], v174 offset:16384
    ds_read_b128 v[92:95], v175 offset:16384
    s_waitcnt lgkmcnt(15)
    v_dot2_f32_bf16 v16, v64, v64, v16
    v_dot2_f32_bf16 v17, v65, v65, v17
    v_dot2_f32_bf16 v18, v66, v66, v18
    s_add_u32 m0, s49, 49152
    s_nop 0
    buffer_load_dwordx4 v169, s[12:15], s92 offen offset:0 lds
    v_dot2_f32_bf16 v19, v67, v67, v19
    s_waitcnt lgkmcnt(15)
    v_dot2_f32_bf16 v16, v68, v68, v16
    v_dot2_f32_bf16 v17, v69, v69, v17
    v_dot2_f32_bf16 v18, v70, v70, v18
    v_dot2_f32_bf16 v19, v71, v71, v19
    s_waitcnt lgkmcnt(15)
    buffer_load_dwordx4 v170, s[12:15], s92 offen offset:1024 lds
    v_dot2_f32_bf16 v16, v72, v72, v16
    v_dot2_f32_bf16 v17, v73, v73, v17
    v_dot2_f32_bf16 v18, v74, v74, v18
    v_dot2_f32_bf16 v19, v75, v75, v19
    s_waitcnt lgkmcnt(15)
    v_dot2_f32_bf16 v16, v76, v76, v16
    buffer_load_dwordx4 v171, s[12:15], s92 offen offset:2048 lds
    v_dot2_f32_bf16 v17, v77, v77, v17
    v_dot2_f32_bf16 v18, v78, v78, v18
    v_dot2_f32_bf16 v19, v79, v79, v19
    s_waitcnt vmcnt(12)
    ds_read_b64_tr_b16 v[128:129], v201 offset:32768
    ds_read_b64_tr_b16 v[130:131], v201 offset:33024
    ds_read_b64_tr_b16 v[132:133], v201 offset:33792
    buffer_load_dwordx4 v176, s[12:15], s92 offen offset:3072 lds
    s_add_u32 s92, s92, 128
    ds_read_b64_tr_b16 v[134:135], v201 offset:34048
    s_waitcnt vmcnt(7)
    ds_read_b64_tr_b16 v[136:137], v201 offset:40960
    ds_read_b64_tr_b16 v[138:139], v201 offset:41216
    ds_read_b64_tr_b16 v[140:141], v201 offset:41984
    ds_read_b64_tr_b16 v[142:143], v201 offset:42240
    s_waitcnt vmcnt(9)
    ds_read_b128 a[32:35], v172 offset:32768
    ds_read_b128 a[36:39], v173 offset:32768
    ds_read_b128 a[40:43], v174 offset:32768
    ds_read_b128 a[44:47], v175 offset:32768
    ds_read_b128 v[64:67], v172 offset:32768
    ds_read_b128 v[68:71], v173 offset:32768
    ds_read_b128 v[72:75], v174 offset:32768
    ds_read_b128 v[76:79], v175 offset:32768
    s_waitcnt lgkmcnt(15)
    v_dot2_f32_bf16 v16, v80, v80, v16
    v_dot2_f32_bf16 v17, v81, v81, v17
    v_mov_b32 v1, 0x7fffffff
    s_lshl_b32 s21, s57, 7
    s_add_u32 s25, s21, s51
    v_writelane_b32 v1, s60, 0
    v_writelane_b32 v1, s25, 1
    s_lshl_b32 s25, s59, 11
    s_add_u32 s25, s25, s21
    s_add_u32 s25, s25, 0x1e00000
    v_writelane_b32 v1, s25, 2
    buffer_load_dword a187, v1, s[16:19], 0 offen sc1
    v_dot2_f32_bf16 v18, v82, v82, v18
    v_dot2_f32_bf16 v19, v83, v83, v19
    s_waitcnt lgkmcnt(15)
    v_dot2_f32_bf16 v16, v84, v84, v16
    v_dot2_f32_bf16 v17, v85, v85, v17
    v_dot2_f32_bf16 v18, v86, v86, v18
    v_dot2_f32_bf16 v19, v87, v87, v19
    s_waitcnt lgkmcnt(15)
    v_dot2_f32_bf16 v16, v88, v88, v16
    v_dot2_f32_bf16 v17, v89, v89, v17
    v_dot2_f32_bf16 v18, v90, v90, v18
    s_and_b32 s21, s56, 7
    s_lshl_b32 s21, s21, 2
    s_add_u32 s21, s21, s3
    s_mul_i32 s25, s21, 12544
    s_lshl_b32 s21, s8, 7
    s_add_u32 s25, s25, s21
    v_mul_u32_u24 v1, 896, v3
    s_and_b32 s85, s85, 0xffff
    s_mov_b32 s86, 0x62000
    s_mov_b32 s87, 0x00020000
    s_mov_b64 exec, 0xffff
    buffer_load_dword a182, v1, s[84:87], s25 offen
    s_mov_b64 exec, -1
    v_dot2_f32_bf16 v19, v91, v91, v19
    s_waitcnt lgkmcnt(15)
    v_dot2_f32_bf16 v16, v92, v92, v16
    v_dot2_f32_bf16 v17, v93, v93, v17
    v_dot2_f32_bf16 v18, v94, v94, v18
    v_dot2_f32_bf16 v19, v95, v95, v19
    s_waitcnt vmcnt(7)
    ds_read_b64_tr_b16 v[144:145], v201 offset:49152
    ds_read_b64_tr_b16 v[146:147], v201 offset:49408
    ds_read_b64_tr_b16 v[148:149], v201 offset:50176
    ds_read_b64_tr_b16 v[150:151], v201 offset:50432
    s_waitcnt lgkmcnt(7)
    v_dot2_f32_bf16 v16, v64, v64, v16
    v_dot2_f32_bf16 v17, v65, v65, v17
    v_dot2_f32_bf16 v18, v66, v66, v18
    v_dot2_f32_bf16 v19, v67, v67, v19
    s_waitcnt lgkmcnt(6)
    v_dot2_f32_bf16 v16, v68, v68, v16
    v_dot2_f32_bf16 v17, v69, v69, v17
    v_dot2_f32_bf16 v18, v70, v70, v18
    v_dot2_f32_bf16 v19, v71, v71, v19
    s_waitcnt lgkmcnt(5)
    v_dot2_f32_bf16 v16, v72, v72, v16
    v_dot2_f32_bf16 v17, v73, v73, v17
    v_dot2_f32_bf16 v18, v74, v74, v18
    v_dot2_f32_bf16 v19, v75, v75, v19
    s_waitcnt lgkmcnt(4)
    v_dot2_f32_bf16 v16, v76, v76, v16
    v_dot2_f32_bf16 v17, v77, v77, v17
    v_dot2_f32_bf16 v18, v78, v78, v18
    v_dot2_f32_bf16 v19, v79, v79, v19
    s_waitcnt vmcnt(6)
    v_subrev_u32 v217, s61, v217
    v_subrev_u32 v219, s61, v219
    v_max_u32 v217, v217, v219
    v_cmp_gt_u32 vcc, 64, v217
    s_cmp_eq_u64 vcc, -1
    s_cbranch_scc0 slow_1
back_2:
    v_mov_b32 v217, v218
    s_mov_b32 s42, 0x10000000
    s_mov_b32 s43, 0x10000000
    ds_write_b64 v213, v[216:217]
    ds_read_b128 v[56:59], v214 offset:0
    ds_read_b128 v[60:63], v214 offset:64
    ds_read_b128 v[180:183], v214 offset:128
    ds_read_b128 v[184:187], v214 offset:192
    ds_read_b128 v[188:191], v214 offset:256
    ds_read_b128 v[20:23], v214 offset:320
    ds_read_b128 v[24:27], v214 offset:384
    s_add_u32 m0, s49, 65536
    s_nop 0
    buffer_load_dwordx4 v169, s[12:15], s92 offen offset:0 lds
    buffer_load_dwordx4 v170, s[12:15], s92 offen offset:1024 lds
    s_waitcnt lgkmcnt(6)
    v_and_b32 v56, v56, v28
    v_and_b32 v57, v57, v29
    v_and_b32 v58, v58, v30
    v_and_b32 v59, v59, v31
    s_nop 1
    v_mfma_f32_32x32x16_bf16 v[224:239], v[56:59], v[96:99], 0
    v_mfma_f32_32x32x16_bf16 v[240:255], v[56:59], v[100:103], 0
    buffer_load_dwordx4 v171, s[12:15], s92 offen offset:2048 lds
    s_waitcnt lgkmcnt(5)
    v_and_b32 v60, v60, v28
    v_and_b32 v61, v61, v29
    v_and_b32 v62, v62, v30
    v_and_b32 v63, v63, v31
    s_nop 1
    v_mfma_f32_32x32x16_bf16 v[40:55], v[60:63], v[104:107], 0
    v_cvt_pk_bf16_f32 v224, v224, v225
    v_cvt_pk_bf16_f32 v225, v226, v227
    v_cvt_pk_bf16_f32 v226, v228, v229
    v_cvt_pk_bf16_f32 v227, v230, v231
    v_add_f32 v32, v32, v232
    v_cndmask_b32 v224, v224, v36, s[42:43]
    v_cndmask_b32 v225, v225, v36, s[42:43]
    v_cndmask_b32 v226, v226, v36, s[42:43]
    v_cndmask_b32 v227, v227, v36, s[42:43]
    ds_write_b128 v12, v[224:227] offset:0
    v_mfma_f32_32x32x16_bf16 v[224:239], v[60:63], v[108:111], 0
    buffer_load_dwordx4 v176, s[12:15], s92 offen offset:3072 lds
    s_add_u32 s92, s92, 128
    v_cvt_pk_bf16_f32 v240, v240, v241
    v_cvt_pk_bf16_f32 v241, v242, v243
    v_cvt_pk_bf16_f32 v242, v244, v245
    v_cvt_pk_bf16_f32 v243, v246, v247
    v_add_f32 v33, v33, v248
    ds_write_b128 v12, v[240:243] offset:1024
    s_waitcnt lgkmcnt(6)
    v_and_b32 v180, v180, v28
    v_and_b32 v181, v181, v29
    v_and_b32 v182, v182, v30
    v_and_b32 v183, v183, v31
    s_nop 1
    v_mfma_f32_32x32x16_bf16 v[240:255], v[180:183], v[112:115], 0
    v_cvt_pk_bf16_f32 v40, v40, v41
    v_cvt_pk_bf16_f32 v41, v42, v43
    v_cvt_pk_bf16_f32 v42, v44, v45
    v_cvt_pk_bf16_f32 v43, v46, v47
    v_add_f32 v32, v32, v48
    v_cndmask_b32 v40, v40, v36, s[42:43]
    v_cndmask_b32 v41, v41, v36, s[42:43]
    v_cndmask_b32 v42, v42, v36, s[42:43]
    v_cndmask_b32 v43, v43, v36, s[42:43]
    ds_write_b128 v12, v[40:43] offset:8192
    v_mfma_f32_32x32x16_bf16 v[40:55], v[180:183], v[116:119], 0
    s_lshr_b32 s21, s40, 3
    v_mul_u32_u24 v1, s21, v3
    s_mov_b64 exec, 0xffff
    buffer_load_dword a183, v1, s[28:31], s36 offen
    buffer_load_dword a184, v1, s[32:35], s37 offen
    s_mov_b64 exec, -1
    v_cvt_pk_bf16_f32 v224, v224, v225
    v_cvt_pk_bf16_f32 v225, v226, v227
    v_cvt_pk_bf16_f32 v226, v228, v229
    v_cvt_pk_bf16_f32 v227, v230, v231
    v_add_f32 v33, v33, v232
    ds_write_b128 v12, v[224:227] offset:9216
    s_waitcnt lgkmcnt(7)
    v_and_b32 v184, v184, v28
    v_and_b32 v185, v185, v29
    v_and_b32 v186, v186, v30
    v_and_b32 v187, v187, v31
    s_nop 1
    v_mfma_f32_32x32x16_bf16 v[224:239], v[184:187], v[120:123], 0
    v_cvt_pk_bf16_f32 v240, v240, v241
    v_cvt_pk_bf16_f32 v241, v242, v243
    v_cvt_pk_bf16_f32 v242, v244, v245
    v_cvt_pk_bf16_f32 v243, v246, v247
    v_add_f32 v32, v32, v248
    v_cndmask_b32 v240, v240, v36, s[42:43]
    v_cndmask_b32 v241, v241, v36, s[42:43]
    v_cndmask_b32 v242, v242, v36, s[42:43]
    v_cndmask_b32 v243, v243, v36, s[42:43]
    ds_write_b128 v12, v[240:243] offset:16384
    s_waitcnt lgkmcnt(1)
    s_barrier
    s_cmp_ge_u32 s55, 0x5024c
    s_cselect_b32 s21, s55, 0x7f000000
    s_cselect_b32 s55, 0x7f000000, s55
    v_mul_u32_u24 v1, 1280, v2
    s_mov_b64 exec, 0xffff
    buffer_store_dword v39, v1, s[16:19], s21 offen sc1
    s_mov_b64 exec, -1
    ds_read_b128 v[64:67], v5 offset:0
    v_mfma_f32_32x32x16_bf16 v[240:255], v[184:187], v[124:127], 0
    s_add_u32 m0, s49, 81920
    s_nop 0
    buffer_load_dwordx4 v169, s[12:15], s92 offen offset:0 lds
    v_cvt_pk_bf16_f32 v40, v40, v41
    v_cvt_pk_bf16_f32 v41, v42, v43
    v_cvt_pk_bf16_f32 v42, v44, v45
    v_cvt_pk_bf16_f32 v43, v46, v47
    v_add_f32 v33, v33, v48
    ds_write_b128 v12, v[40:43] offset:17408
    ds_read_b128 v[68:71], v5 offset:1024
    s_waitcnt lgkmcnt(10)
    v_and_b32 v188, v188, v28
    v_and_b32 v189, v189, v29
    v_and_b32 v190, v190, v30
    v_and_b32 v191, v191, v31
    s_nop 1
    v_mfma_f32_32x32x16_bf16 v[40:55], v[188:191], v[128:131], 0
    v_cvt_pk_bf16_f32 v224, v224, v225
    v_cvt_pk_bf16_f32 v225, v226, v227
    v_cvt_pk_bf16_f32 v226, v228, v229
    v_cvt_pk_bf16_f32 v227, v230, v231
    v_add_f32 v32, v32, v232
    v_cndmask_b32 v224, v224, v36, s[42:43]
    v_cndmask_b32 v225, v225, v36, s[42:43]
    v_cndmask_b32 v226, v226, v36, s[42:43]
    v_cndmask_b32 v227, v227, v36, s[42:43]
    ds_write_b128 v12, v[224:227] offset:24576
    ds_read_b128 v[72:75], v5 offset:2048
    v_mfma_f32_32x32x16_bf16 v[224:239], v[188:191], v[132:135], 0
    buffer_load_dwordx4 v170, s[12:15], s92 offen offset:1024 lds
    v_cvt_pk_bf16_f32 v240, v240, v241
    v_cvt_pk_bf16_f32 v241, v242, v243
    v_cvt_pk_bf16_f32 v242, v244, v245
    v_cvt_pk_bf16_f32 v243, v246, v247
    v_add_f32 v33, v33, v248
    ds_write_b128 v12, v[240:243] offset:25600
    ds_read_b128 v[76:79], v5 offset:3072
    s_waitcnt lgkmcnt(13)
    v_and_b32 v20, v20, v28
    v_and_b32 v21, v21, v29
    v_and_b32 v22, v22, v30
    v_and_b32 v23, v23, v31
    s_nop 1
    v_mfma_f32_32x32x16_bf16 v[240:255], v[20:23], v[136:139], 0
    v_cvt_pk_bf16_f32 v40, v40, v41
    v_cvt_pk_bf16_f32 v41, v42, v43
    v_cvt_pk_bf16_f32 v42, v44, v45
    v_cvt_pk_bf16_f32 v43, v46, v47
    v_add_f32 v32, v32, v48
    v_cndmask_b32 v40, v40, v36, s[42:43]
    v_cndmask_b32 v41, v41, v36, s[42:43]
    v_cndmask_b32 v42, v42, v36, s[42:43]
    v_cndmask_b32 v43, v43, v36, s[42:43]
    ds_write_b128 v12, v[40:43] offset:32768
    ds_read_b128 v[80:83], v5 offset:4096
    v_mfma_f32_32x32x16_bf16 v[40:55], v[20:23], v[140:143], 0
    buffer_load_dwordx4 v171, s[12:15], s92 offen offset:2048 lds
    v_cvt_pk_bf16_f32 v224, v224, v225
    v_cvt_pk_bf16_f32 v225, v226, v227
    v_cvt_pk_bf16_f32 v226, v228, v229
    v_cvt_pk_bf16_f32 v227, v230, v231
    v_add_f32 v33, v33, v232
    ds_write_b128 v12, v[224:227] offset:33792
    ds_read_b128 v[84:87], v5 offset:5120
    s_waitcnt lgkmcnt(15)
    v_and_b32 v24, v24, v28
    v_and_b32 v25, v25, v29
    v_and_b32 v26, v26, v30
    v_and_b32 v27, v27, v31
    s_nop 1
    v_mfma_f32_32x32x16_bf16 v[224:239], v[24:27], v[144:147], 0
    v_cvt_pk_bf16_f32 v240, v240, v241
    v_cvt_pk_bf16_f32 v241, v242, v243
    v_cvt_pk_bf16_f32 v242, v244, v245
    v_cvt_pk_bf16_f32 v243, v246, v247
    v_add_f32 v32, v32, v248
    v_cndmask_b32 v240, v240, v36, s[42:43]
    v_cndmask_b32 v241, v241, v36, s[42:43]
    v_cndmask_b32 v242, v242, v36, s[42:43]
    v_cndmask_b32 v243, v243, v36, s[42:43]
    ds_write_b128 v12, v[240:243] offset:40960
    v_mfma_f32_32x32x16_bf16 v[240:255], v[24:27], v[148:151], 0
    buffer_load_dwordx4 v176, s[12:15], s92 offen offset:3072 lds
    s_add_u32 s92, s92, 128
    v_cvt_pk_bf16_f32 v40, v40, v41
    v_cvt_pk_bf16_f32 v41, v42, v43
    v_cvt_pk_bf16_f32 v42, v44, v45
    v_cvt_pk_bf16_f32 v43, v46, v47
    v_add_f32 v33, v33, v48
    ds_write_b128 v12, v[40:43] offset:41984
    s_waitcnt lgkmcnt(12)
    v_mfma_f32_32x32x16_bf16 v[192:207], v[64:67], a[0:3], 0
    ds_read_b128 v[88:91], v5 offset:6144
    v_cvt_pk_bf16_f32 v224, v224, v225
    v_cvt_pk_bf16_f32 v225, v226, v227
    v_cvt_pk_bf16_f32 v226, v228, v229
    v_cvt_pk_bf16_f32 v227, v230, v231
    v_add_f32 v32, v32, v232
    v_cndmask_b32 v224, v224, v36, s[42:43]
    v_cndmask_b32 v225, v225, v36, s[42:43]
    v_cndmask_b32 v226, v226, v36, s[42:43]
    v_cndmask_b32 v227, v227, v36, s[42:43]
    ds_write_b128 v12, v[224:227] offset:49152
    v_cvt_pk_bf16_f32 v1, v32, v32
    v_lshlrev_b32 v1, 16, v1
    v_sub_f32 v1, v32, v1
    v_cvt_pk_bf16_f32 v32, v32, v1
    ds_write_b32 v14, v32 offset:0
    s_waitcnt lgkmcnt(13)
    v_mfma_f32_32x32x16_bf16 v[208:223], a[0:3], v[68:71], 0
    ds_read_b128 v[92:95], v5 offset:7168
    v_cvt_pk_bf16_f32 v240, v240, v241
    v_cvt_pk_bf16_f32 v241, v242, v243
    v_cvt_pk_bf16_f32 v242, v244, v245
    v_cvt_pk_bf16_f32 v243, v246, v247
    v_add_f32 v33, v33, v248
    ds_write_b128 v12, v[240:243] offset:50176
    v_cvt_pk_bf16_f32 v1, v33, v33
    v_lshlrev_b32 v1, 16, v1
    v_sub_f32 v1, v33, v1
    v_cvt_pk_bf16_f32 v33, v33, v1
    ds_write_b32 v14, v33 offset:1024
    s_waitcnt lgkmcnt(14)
    v_mfma_f32_32x32x16_bf16 v[192:207], v[72:75], a[4:7], v[192:207]
    ds_read_b128 v[64:67], v5 offset:8192
    s_lshr_b32 s21, s40, 3
    v_mul_u32_u24 v1, s21, v3
    s_mov_b64 exec, 0xffff
    buffer_load_dword a185, v1, s[28:31], s38 offen
    buffer_load_dword a186, v1, s[32:35], s39 offen
    s_mov_b64 exec, -1
    s_waitcnt lgkmcnt(13)
    v_mfma_f32_32x32x16_bf16 v[208:223], a[4:7], v[76:79], v[208:223]
    ds_read_b128 v[68:71], v5 offset:9216
    s_waitcnt lgkmcnt(12)
    v_mfma_f32_32x32x16_bf16 v[192:207], v[80:83], a[8:11], v[192:207]
    s_waitcnt lgkmcnt(2)
    s_barrier
    ds_read_b128 v[72:75], v5 offset:10240
    s_waitcnt lgkmcnt(11)
    v_mfma_f32_32x32x16_bf16 v[208:223], a[8:11], v[84:87], v[208:223]
    ds_read_b128 v[76:79], v5 offset:11264
    v_mul_u32_u24 v169, 896, v34
    v_lshl_add_u32 v169, v35, 4, v169
    buffer_load_dwordx4 a[96:99], v169, s[12:15], s92 offen offset:0
    s_waitcnt lgkmcnt(9)
    v_mfma_f32_32x32x16_bf16 v[192:207], v[88:91], a[12:15], v[192:207]
    ds_read_b128 v[80:83], v5 offset:12288
    v_cndmask_b32 v9, 0, v36, s[42:43]
    v_cmp_le_u32 s[42:43], 28, v34
    s_waitcnt lgkmcnt(7)
    v_mfma_f32_32x32x16_bf16 v[208:223], a[12:15], v[92:95], v[208:223]
    ds_read_b128 v[84:87], v5 offset:13312
    s_waitcnt lgkmcnt(5)
    v_mfma_f32_32x32x16_bf16 v[192:207], v[64:67], a[16:19], v[192:207]
    ds_read_b128 v[88:91], v5 offset:14336
    buffer_load_dwordx4 a[100:103], v169, s[12:15], s92 offen offset:32
    s_waitcnt lgkmcnt(5)
    v_mfma_f32_32x32x16_bf16 v[208:223], a[16:19], v[68:71], v[208:223]
    ds_read_b128 v[92:95], v5 offset:15360
    s_waitcnt lgkmcnt(5)
    v_mfma_f32_32x32x16_bf16 v[192:207], v[72:75], a[20:23], v[192:207]
    ds_read_b128 v[64:67], v5 offset:16384
    s_waitcnt lgkmcnt(5)
    v_mfma_f32_32x32x16_bf16 v[208:223], a[20:23], v[76:79], v[208:223]
    ds_read_b128 v[68:71], v5 offset:17408
    buffer_load_dwordx4 a[104:107], v169, s[12:15], s92 offen offset:64
    s_waitcnt lgkmcnt(5)
    v_mfma_f32_32x32x16_bf16 v[192:207], v[80:83], a[24:27], v[192:207]
    ds_read_b128 v[72:75], v5 offset:18432
    s_waitcnt lgkmcnt(5)
    v_mfma_f32_32x32x16_bf16 v[208:223], a[24:27], v[84:87], v[208:223]
    ds_read_b128 v[76:79], v5 offset:19456
    s_waitcnt lgkmcnt(5)
    v_mfma_f32_32x32x16_bf16 v[192:207], v[88:91], a[28:31], v[192:207]
    ds_read_b128 v[80:83], v5 offset:20480
    buffer_load_dwordx4 a[108:111], v169, s[12:15], s92 offen offset:96
    s_waitcnt lgkmcnt(5)
    v_mfma_f32_32x32x16_bf16 v[208:223], a[28:31], v[92:95], v[208:223]
    ds_read_b128 v[84:87], v5 offset:21504
    s_waitcnt vmcnt(19)
    ds_read_b128 a[48:51], v172 offset:49152
    ds_read_b128 a[52:55], v173 offset:49152
    ds_read_b128 a[56:59], v174 offset:49152
    ds_read_b128 a[60:63], v175 offset:49152
    s_waitcnt lgkmcnt(9)
    v_mfma_f32_32x32x16_bf16 v[192:207], v[64:67], a[32:35], v[192:207]
    ds_read_b128 v[88:91], v5 offset:22528
    s_waitcnt lgkmcnt(9)
    v_mfma_f32_32x32x16_bf16 v[208:223], a[32:35], v[68:71], v[208:223]
    ds_read_b128 v[92:95], v5 offset:23552
    v_accvgpr_read_b32 v240, a176
    s_nop 0
    v_xor_b32 v241, 32, v240
    v_xor_b32 v242, 64, v240
    v_xor_b32 v243, 96, v240
    s_add_u32 m0, s49, 32768
    s_nop 0
    buffer_load_dwordx4 v240, s[28:31], s36 offen lds
    s_waitcnt lgkmcnt(9)
    v_mfma_f32_32x32x16_bf16 v[192:207], v[72:75], a[36:39], v[192:207]
    ds_read_b128 v[64:67], v5 offset:24576
    s_waitcnt lgkmcnt(9)
    v_mfma_f32_32x32x16_bf16 v[208:223], a[36:39], v[76:79], v[208:223]
    ds_read_b128 v[68:71], v5 offset:25600
    s_waitcnt lgkmcnt(9)
    v_mfma_f32_32x32x16_bf16 v[192:207], v[80:83], a[40:43], v[192:207]
    ds_read_b128 v[72:75], v5 offset:26624
    s_add_u32 m0, s49, 33792
    s_add_u32 s36, s36, s40
    buffer_load_dwordx4 v241, s[28:31], s36 offen lds
    s_waitcnt lgkmcnt(9)
    v_mfma_f32_32x32x16_bf16 v[208:223], a[40:43], v[84:87], v[208:223]
    ds_read_b128 v[76:79], v5 offset:27648
    s_waitcnt lgkmcnt(5)
    v_mfma_f32_32x32x16_bf16 v[192:207], v[88:91], a[44:47], v[192:207]
    ds_read_b128 v[80:83], v5 offset:28672
    s_waitcnt lgkmcnt(5)
    v_mfma_f32_32x32x16_bf16 v[208:223], a[44:47], v[92:95], v[208:223]
    ds_read_b128 v[84:87], v5 offset:29696
    s_add_u32 m0, s49, 34816
    s_nop 0
    buffer_load_dwordx4 v242, s[32:35], s37 offen lds
    s_waitcnt lgkmcnt(5)
    v_mfma_f32_32x32x16_bf16 v[192:207], v[64:67], a[48:51], v[192:207]
    ds_read_b128 v[88:91], v5 offset:30720
    v_mfma_f32_32x32x16_bf16 v[112:127], a[48:51], a[48:51], 0
    s_waitcnt lgkmcnt(5)
    v_mfma_f32_32x32x16_bf16 v[208:223], a[48:51], v[68:71], v[208:223]
    ds_read_b128 v[92:95], v5 offset:31744
    s_add_u32 m0, s49, 35840
    s_add_u32 s37, s37, s40
    buffer_load_dwordx4 v243, s[32:35], s37 offen lds
    s_barrier
    s_waitcnt lgkmcnt(5)
    v_mfma_f32_32x32x16_bf16 v[192:207], v[72:75], a[52:55], v[192:207]
    ds_read_b128 v[64:67], v5 offset:32768
    v_add_u32 v172, 32768, v172
    v_add_u32 v173, 32768, v173
    v_add_u32 v174, 32768, v174
    v_add_u32 v175, 32768, v175
    v_mfma_f32_32x32x16_bf16 v[112:127], a[52:55], a[52:55], v[112:127]
    s_waitcnt vmcnt(17)
    ds_read_b128 a[64:67], v172 offset:32768
    ds_read_b128 a[68:71], v173 offset:32768
    ds_read_b128 a[72:75], v174 offset:32768
    ds_read_b128 a[76:79], v175 offset:32768
    s_waitcnt lgkmcnt(9)
    v_mfma_f32_32x32x16_bf16 v[208:223], a[52:55], v[76:79], v[208:223]
    ds_read_b128 v[68:71], v5 offset:33792
    s_add_u32 m0, s49, 0
    s_nop 0
    buffer_load_dwordx4 v168, s[88:91], s79 offen lds
    s_add_u32 s79, s79, 172032
    s_waitcnt lgkmcnt(9)
    v_mfma_f32_32x32x16_bf16 v[192:207], v[80:83], a[56:59], v[192:207]
    ds_read_b128 v[72:75], v5 offset:34816
    v_mfma_f32_32x32x16_bf16 v[112:127], a[56:59], a[56:59], v[112:127]
    s_waitcnt lgkmcnt(9)
    v_mfma_f32_32x32x16_bf16 v[208:223], a[56:59], v[84:87], v[208:223]
    ds_read_b128 v[76:79], v5 offset:35840
    s_add_u32 m0, s49, 1024
    s_nop 0
    buffer_load_dwordx4 v168, s[88:91], s79 offen lds
    s_add_u32 s79, s79, 172032
    s_waitcnt lgkmcnt(9)
    v_mfma_f32_32x32x16_bf16 v[192:207], v[88:91], a[60:63], v[192:207]
    ds_read_b128 v[80:83], v5 offset:36864
    v_mfma_f32_32x32x16_bf16 v[112:127], a[60:63], a[60:63], v[112:127]
    s_waitcnt lgkmcnt(9)
    v_mfma_f32_32x32x16_bf16 v[208:223], a[60:63], v[92:95], v[208:223]
    ds_read_b128 v[84:87], v5 offset:37888
    s_add_u32 m0, s49, 2048
    s_nop 0
    buffer_load_dwordx4 v168, s[88:91], s79 offen lds
    s_add_u32 s79, s79, 172032
    s_waitcnt lgkmcnt(5)
    v_mfma_f32_32x32x16_bf16 v[192:207], v[64:67], a[64:67], v[192:207]
    ds_read_b128 v[88:91], v5 offset:38912
    v_mfma_f32_32x32x16_bf16 v[112:127], a[64:67], a[64:67], v[112:127]
    s_waitcnt lgkmcnt(5)
    v_mfma_f32_32x32x16_bf16 v[208:223], a[64:67], v[68:71], v[208:223]
    ds_read_b128 v[92:95], v5 offset:39936
    s_add_u32 m0, s49, 3072
    s_nop 0
    buffer_load_dwordx4 v168, s[88:91], s79 offen lds
    s_add_u32 s79, s79, 172032
    s_waitcnt lgkmcnt(5)
    v_mfma_f32_32x32x16_bf16 v[192:207], v[72:75], a[68:71], v[192:207]
    ds_read_b128 v[64:67], v5 offset:40960
    s_waitcnt vmcnt(14)
    ds_read_b128 a[80:83], v172 offset:49152
    ds_read_b128 a[84:87], v173 offset:49152
    ds_read_b128 a[88:91], v174 offset:49152
    ds_read_b128 a[92:95], v175 offset:49152
    v_mfma_f32_32x32x16_bf16 v[112:127], a[68:71], a[68:71], v[112:127]
    s_waitcnt lgkmcnt(9)
    v_mfma_f32_32x32x16_bf16 v[208:223], a[68:71], v[76:79], v[208:223]
    ds_read_b128 v[68:71], v5 offset:43008
    s_add_u32 m0, s49, 16384
    s_nop 0
    buffer_load_dwordx4 v168, s[88:91], s79 offen lds
    s_add_u32 s79, s79, 172032
    s_waitcnt lgkmcnt(9)
    v_mfma_f32_32x32x16_bf16 v[192:207], v[80:83], a[72:75], v[192:207]
    ds_read_b128 v[72:75], v5 offset:45056
    v_mfma_f32_32x32x16_bf16 v[112:127], a[72:75], a[72:75], v[112:127]
    s_waitcnt lgkmcnt(9)
    v_mfma_f32_32x32x16_bf16 v[208:223], a[72:75], v[84:87], v[208:223]
    ds_read_b128 v[76:79], v5 offset:47104
    s_add_u32 m0, s49, 17408
    s_nop 0
    buffer_load_dwordx4 v168, s[88:91], s79 offen lds
    s_add_u32 s79, s79, 172032
    s_waitcnt lgkmcnt(9)
    v_mfma_f32_32x32x16_bf16 v[192:207], v[88:91], a[76:79], v[192:207]
    ds_read_b128 v[80:83], v6 offset:0
    v_mfma_f32_32x32x16_bf16 v[112:127], a[76:79], a[76:79], v[112:127]
    s_waitcnt lgkmcnt(9)
    v_mfma_f32_32x32x16_bf16 v[208:223], a[76:79], v[92:95], v[208:223]
    ds_read_b128 v[84:87], v6 offset:2048
    s_add_u32 m0, s49, 18432
    s_nop 0
    buffer_load_dwordx4 v168, s[88:91], s79 offen lds
    s_waitcnt lgkmcnt(5)
    v_mfma_f32_32x32x16_bf16 v[192:207], v[64:67], a[80:83], v[192:207]
    ds_read_b128 v[88:91], v6 offset:4096
    v_mfma_f32_32x32x16_bf16 v[112:127], a[80:83], a[80:83], v[112:127]
    s_waitcnt lgkmcnt(5)
    v_mfma_f32_32x32x16_bf16 v[192:207], v[68:71], a[84:87], v[192:207]
    ds_read_b128 v[92:95], v6 offset:6144
    s_waitcnt lgkmcnt(15)
    s_add_u32 m0, s49, 65536
    s_nop 0
    buffer_load_dwordx4 v240, s[28:31], s38 offen lds
    v_mfma_f32_32x32x16_bf16 v[112:127], a[84:87], a[84:87], v[112:127]
    s_waitcnt lgkmcnt(5)
    v_mfma_f32_32x32x16_bf16 v[192:207], v[72:75], a[88:91], v[192:207]
    ds_read_b128 v[64:67], v5 offset:41984
    v_mfma_f32_32x32x16_bf16 v[112:127], a[88:91], a[88:91], v[112:127]
    s_add_u32 m0, s49, 66560
    s_add_u32 s38, s38, s40
    buffer_load_dwordx4 v241, s[28:31], s38 offen lds
    s_waitcnt lgkmcnt(5)
    v_mfma_f32_32x32x16_bf16 v[192:207], v[76:79], a[92:95], v[192:207]
    ds_read_b128 v[68:71], v5 offset:44032
    v_mfma_f32_32x32x16_bf16 v[112:127], a[92:95], a[92:95], v[112:127]
    s_waitcnt vmcnt(16)
    v_mfma_f32_32x32x16_bf16 v[112:127], a[96:99], a[96:99], v[112:127]
    s_add_u32 m0, s49, 67584
    s_nop 0
    buffer_load_dwordx4 v242, s[32:35], s39 offen lds
    s_waitcnt vmcnt(16)
    v_mfma_f32_32x32x16_bf16 v[112:127], a[100:103], a[100:103], v[112:127]
    s_waitcnt vmcnt(15)
    v_mfma_f32_32x32x16_bf16 v[112:127], a[104:107], a[104:107], v[112:127]
    s_waitcnt vmcnt(14)
    v_mfma_f32_32x32x16_bf16 v[112:127], a[108:111], a[108:111], v[112:127]
    s_add_u32 m0, s49, 68608
    s_add_u32 s39, s39, s40
    buffer_load_dwordx4 v243, s[32:35], s39 offen lds
    s_waitcnt lgkmcnt(5)
    v_mfma_f32_32x32x16_bf16 v[192:207], v[80:83], a[96:99], v[192:207]
    ds_read_b128 v[72:75], v5 offset:46080
    s_waitcnt lgkmcnt(5)
    v_mfma_f32_32x32x16_bf16 v[192:207], v[84:87], a[100:103], v[192:207]
    ds_read_b128 v[76:79], v5 offset:48128
    v_add_f32 v16, v16, v17
    v_add_f32 v18, v18, v19
    v_add_f32 v18, v18, v16
    s_mov_b32 vcc_lo, 0xffff0000
    s_mov_b32 vcc_hi, 0xffff0000
    s_waitcnt lgkmcnt(5)
    v_mfma_f32_32x32x16_bf16 v[192:207], v[88:91], a[104:107], v[192:207]
    ds_read_b128 v[80:83], v6 offset:1024
    buffer_store_dwordx4 a[252:255], v8, s[16:19], s54 offen offset:0 sc1
    s_waitcnt lgkmcnt(5)
    v_mfma_f32_32x32x16_bf16 v[192:207], v[92:95], a[108:111], v[192:207]
    ds_read_b128 v[84:87], v6 offset:3072
    v_cndmask_b32 v112, v112, v120, vcc
    v_cndmask_b32 v113, v113, v121, vcc
    v_cndmask_b32 v114, v114, v122, vcc
    v_cndmask_b32 v115, v115, v123, vcc
    s_waitcnt lgkmcnt(5)
    v_mfma_f32_32x32x16_bf16 v[208:223], a[80:83], v[64:67], v[208:223]
    ds_read_b128 v[88:91], v6 offset:5120
    v_cndmask_b32 v116, v116, v124, vcc
    v_cndmask_b32 v117, v117, v125, vcc
    v_cndmask_b32 v118, v118, v126, vcc
    v_cndmask_b32 v119, v119, v127, vcc
    s_waitcnt lgkmcnt(5)
    v_mfma_f32_32x32x16_bf16 v[208:223], a[84:87], v[68:71], v[208:223]
    ds_read_b128 v[92:95], v6 offset:7168
    buffer_store_dwordx4 a[252:255], v8, s[16:19], s54 offen offset:512 sc1
    s_waitcnt lgkmcnt(5)
    v_mfma_f32_32x32x16_bf16 v[208:223], a[88:91], v[72:75], v[208:223]
    ds_read_b128 v[64:67], v6 offset:8192
    s_mov_b32 vcc_lo, 0xff00ff00
    s_mov_b32 vcc_hi, 0xff00ff00
    v_cndmask_b32 v112, v112, v116, vcc
    v_cndmask_b32 v113, v113, v117, vcc
    v_cndmask_b32 v114, v114, v118, vcc
    s_waitcnt lgkmcnt(5)
    v_mfma_f32_32x32x16_bf16 v[208:223], a[92:95], v[76:79], v[208:223]
    ds_read_b128 v[68:71], v6 offset:9216
    v_cndmask_b32 v115, v115, v119, vcc
    s_mov_b32 vcc_lo, 0xcccccccc
    s_mov_b32 vcc_hi, 0xcccccccc
    v_cndmask_b32 v112, v112, v114, vcc
    v_cndmask_b32 v113, v113, v115, vcc
    s_waitcnt lgkmcnt(5)
    v_mfma_f32_32x32x16_bf16 v[208:223], a[96:99], v[80:83], v[208:223]
    buffer_store_dwordx4 a[252:255], v5, s[16:19], s10 offen offset:0 sc1
    s_mov_b32 vcc_lo, 0xaaaaaaaa
    s_mov_b32 vcc_hi, 0xaaaaaaaa
    v_cndmask_b32 v112, v112, v113, vcc
    s_waitcnt lgkmcnt(4)
    v_mfma_f32_32x32x16_bf16 v[208:223], a[100:103], v[84:87], v[208:223]
    s_mov_b32 vcc_lo, 0x0f0f0f0f
    s_mov_b32 vcc_hi, 0xf0f0f0f0
    v_cndmask_b32 v112, 0, v112, vcc
    v_add_f32 v18, v18, v112
    v_cndmask_b32 v16, 0, v204, s[6:7]
    v_mov_b32 v17, v16
    v_mov_b32 v19, v18
    s_waitcnt lgkmcnt(3)
    v_mfma_f32_32x32x16_bf16 v[208:223], a[104:107], v[88:91], v[208:223]
    s_nop 1
    v_permlane32_swap_b32 v16, v17
    v_permlane32_swap_b32 v18, v19
    s_nop 1
    s_waitcnt lgkmcnt(2)
    v_mfma_f32_32x32x16_bf16 v[208:223], a[108:111], v[92:95], v[208:223]
    buffer_store_dwordx4 a[252:255], v5, s[16:19], s10 offen offset:768 sc1
    v_add_f32 v16, v16, v17
    v_add_f32 v18, v18, v19
    v_mul_f32 v16, 0x3b124925, v16
    v_mul_f32 v18, 0x3b124925, v18
    v_fma_f32 v18, -v16, v16, v18
    v_max_f32 v18, 0, v18
    v_sub_f32 v16, 0, v16
    v_cvt_pk_bf16_f32 v16, v16, v16
    v_cvt_pk_bf16_f32 v18, v18, v18
    v_lshlrev_b32 v18, 16, v18
    v_add_f32 v18, 0x3727c5ac, v18
    v_cvt_pk_bf16_f32 v18, v18, v18
    v_lshlrev_b32 v18, 16, v18
    v_sqrt_f32 v18, v18
    v_lshl_add_u32 v19, v34, 2, s49
    v_cvt_pk_bf16_f32 v17, v18, v18
    v_lshlrev_b32 v18, 16, v17
    v_rcp_f32 v36, v18
    v_cndmask_b32 v16, v17, v16, s[6:7]
    v_cndmask_b32 v37, v36, 0, s[6:7]
    ds_write_b32 v19, v36 offset:19968
    v_mov_b32 v17, v16
    v_mov_b32 v18, v16
    ds_read_b128 v[96:99], v15 offset:0
    ds_read_b128 v[100:103], v15 offset:32
    ds_read_b128 v[104:107], v15 offset:64
    ds_read_b128 v[108:111], v15 offset:96
    v_mov_b32 v19, v16
    s_nop 1
    s_waitcnt lgkmcnt(6)
    v_mfma_f32_32x32x16_bf16 v[192:207], v[64:67], v[16:19], v[192:207]
    s_waitcnt lgkmcnt(5)
    v_mfma_f32_32x32x16_bf16 v[208:223], v[16:19], v[68:71], v[208:223]
    s_nop 3
    v_mul_f32 v192, v192, v36
    v_mul_f32 v193, v193, v36
    v_mul_f32 v194, v194, v36
    v_mul_f32 v195, v195, v36
    v_mul_f32 v196, v196, v36
    v_mul_f32 v197, v197, v36
    s_waitcnt vmcnt(14)
    ds_read_b64_tr_b16 v[152:153], v179 offset:0
    ds_read_b64_tr_b16 v[154:155], v179 offset:256
    v_mul_f32 v198, v198, v36
    v_mul_f32 v199, v199, v36
    v_mul_f32 v200, v200, v36
    v_mul_f32 v201, v201, v36
    v_mul_f32 v202, v202, v36
    v_mul_f32 v203, v203, v36
    v_mul_f32 v204, v204, v37
    s_waitcnt vmcnt(13)
    ds_read_b64_tr_b16 v[156:157], v179 offset:1024
    ds_read_b64_tr_b16 v[158:159], v179 offset:1280
    v_mul_f32 v205, v205, v37
    v_mul_f32 v206, v206, v37
    v_mul_f32 v207, v207, v37
    v_cvt_pk_bf16_f32 v192, v192, v193
    v_cvt_pk_bf16_f32 v193, v194, v195
    v_cvt_pk_bf16_f32 v194, v196, v197
    v_cvt_pk_bf16_f32 v195, v198, v199
    s_waitcnt vmcnt(12)
    ds_read_b64_tr_b16 v[160:161], v179 offset:2048
    ds_read_b64_tr_b16 v[162:163], v179 offset:2304
    v_cvt_pk_bf16_f32 v196, v200, v201
    v_cvt_pk_bf16_f32 v197, v202, v203
    v_cvt_pk_bf16_f32 v198, v204, v205
    v_cvt_pk_bf16_f32 v199, v206, v207
    buffer_store_dwordx4 v[192:195], v5, s[16:19], s50 offen offset:0 sc1
    buffer_store_dwordx4 v[196:199], v5, s[16:19], s50 offen offset:1024 sc1
    s_waitcnt lgkmcnt(6)
    v_mul_f32 v208, v208, v96
    s_waitcnt vmcnt(13)
    ds_read_b64_tr_b16 v[164:165], v179 offset:3072
    ds_read_b64_tr_b16 v[166:167], v179 offset:3328
    s_waitcnt lgkmcnt(6)
    v_mfma_f32_32x32x16_bf16 v[224:239], v[56:59], v[152:155], 0
    v_mul_f32 v209, v209, v97
    v_mul_f32 v210, v210, v98
    v_mul_f32 v211, v211, v99
    v_mul_f32 v212, v212, v100
    v_mul_f32 v213, v213, v101
    v_mul_f32 v214, v214, v102
    v_mul_f32 v215, v215, v103
    s_waitcnt vmcnt(12)
    ds_read_b64_tr_b16 v[168:169], v179 offset:16384
    ds_read_b64_tr_b16 v[170:171], v179 offset:16640
    s_waitcnt lgkmcnt(6)
    v_mfma_f32_32x32x16_bf16 v[240:255], v[60:63], v[156:159], 0
    v_mul_f32 v216, v216, v104
    v_mul_f32 v217, v217, v105
    v_mul_f32 v218, v218, v106
    v_mul_f32 v219, v219, v107
    v_mul_f32 v220, v220, v108
    v_mul_f32 v221, v221, v109
    v_mul_f32 v222, v222, v110
    s_waitcnt vmcnt(11)
    ds_read_b64_tr_b16 v[172:173], v179 offset:17408
    ds_read_b64_tr_b16 v[174:175], v179 offset:17664
    s_waitcnt lgkmcnt(6)
    v_mfma_f32_32x32x16_bf16 v[40:55], v[180:183], v[160:163], 0
    v_mul_f32 v223, v223, v111
    v_cvt_pk_bf16_f32 v208, v208, v209
    v_cvt_pk_bf16_f32 v209, v210, v211
    v_cvt_pk_bf16_f32 v210, v212, v213
    v_cvt_pk_bf16_f32 v211, v214, v215
    v_cvt_pk_bf16_f32 v212, v216, v217
    v_cvt_pk_bf16_f32 v213, v218, v219
    s_waitcnt vmcnt(10)
    ds_read_b64_tr_b16 v[176:177], v179 offset:18432
    ds_read_b64_tr_b16 v[178:179], v179 offset:18688
    v_cvt_pk_bf16_f32 v214, v220, v221
    v_cvt_pk_bf16_f32 v215, v222, v223
    v_cndmask_b32 v208, v208, v9, s[42:43]
    v_cndmask_b32 v209, v209, v9, s[42:43]
    v_cndmask_b32 v210, v210, v9, s[42:43]
    v_cndmask_b32 v211, v211, v9, s[42:43]
    v_cndmask_b32 v212, v212, v9, s[42:43]
    v_cndmask_b32 v213, v213, v9, s[42:43]
    v_cndmask_b32 v214, v214, v9, s[42:43]
    v_cndmask_b32 v215, v215, v9, s[42:43]
    buffer_store_dwordx4 v[208:211], v5, s[16:19], s50 offen offset:2048 sc1
    buffer_store_dwordx4 v[212:215], v5, s[16:19], s50 offen offset:3072 sc1
    ds_write_b128 v7, v[192:195] offset:32768
    ds_write_b128 v7, v[196:199] offset:33792
    ds_write_b128 v7, v[208:211] offset:34816
    ds_write_b128 v7, v[212:215] offset:35840
    v_cvt_pk_bf16_f32 v224, v224, v225
    v_cvt_pk_bf16_f32 v225, v226, v227
    v_cvt_pk_bf16_f32 v226, v228, v229
    v_cvt_pk_bf16_f32 v227, v230, v231
    v_add_f32 v10, v10, v232
    ds_write_b128 v13, v[224:227] offset:0
    s_waitcnt lgkmcnt(11)
    v_mfma_f32_32x32x16_bf16 v[224:239], v[184:187], v[164:167], 0
    v_cvt_pk_bf16_f32 v240, v240, v241
    v_cvt_pk_bf16_f32 v241, v242, v243
    v_cvt_pk_bf16_f32 v242, v244, v245
    v_cvt_pk_bf16_f32 v243, v246, v247
    v_add_f32 v10, v10, v248
    ds_write_b128 v13, v[240:243] offset:1024
    s_waitcnt lgkmcnt(10)
    v_mfma_f32_32x32x16_bf16 v[240:255], v[188:191], v[168:171], 0
    v_cvt_pk_bf16_f32 v40, v40, v41
    v_cvt_pk_bf16_f32 v41, v42, v43
    v_cvt_pk_bf16_f32 v42, v44, v45
    v_cvt_pk_bf16_f32 v43, v46, v47
    v_add_f32 v10, v10, v48
    ds_write_b128 v13, v[40:43] offset:2048
    s_waitcnt lgkmcnt(9)
    v_mfma_f32_32x32x16_bf16 v[40:55], v[20:23], v[172:175], 0
    v_cvt_pk_bf16_f32 v224, v224, v225
    v_cvt_pk_bf16_f32 v225, v226, v227
    v_cvt_pk_bf16_f32 v226, v228, v229
    v_cvt_pk_bf16_f32 v227, v230, v231
    v_add_f32 v10, v10, v232
    ds_write_b128 v13, v[224:227] offset:3072
    s_waitcnt lgkmcnt(8)
    v_mfma_f32_32x32x16_bf16 v[224:239], v[24:27], v[176:179], 0
    v_cvt_pk_bf16_f32 v240, v240, v241
    v_cvt_pk_bf16_f32 v241, v242, v243
    v_cvt_pk_bf16_f32 v242, v244, v245
    v_cvt_pk_bf16_f32 v243, v246, v247
    v_add_f32 v10, v10, v248
    ds_write_b128 v13, v[240:243] offset:16384
    s_nop 1
    v_cvt_pk_bf16_f32 v40, v40, v41
    v_cvt_pk_bf16_f32 v41, v42, v43
    v_cvt_pk_bf16_f32 v42, v44, v45
    v_cvt_pk_bf16_f32 v43, v46, v47
    v_add_f32 v10, v10, v48
    ds_write_b128 v13, v[40:43] offset:17408
    s_nop 3
    v_cvt_pk_bf16_f32 v224, v224, v225
    v_cvt_pk_bf16_f32 v225, v226, v227
    v_cvt_pk_bf16_f32 v226, v228, v229
    v_cvt_pk_bf16_f32 v227, v230, v231
    v_add_f32 v10, v10, v232
    ds_write_b128 v13, v[224:227] offset:18432
    v_cvt_pk_bf16_f32 v1, v10, v10
    v_lshlrev_b32 v1, 16, v1
    v_sub_f32 v1, v10, v1
    v_cvt_pk_bf16_f32 v10, v10, v1
    ds_write_b32 v14, v10 offset:51200
    s_waitcnt lgkmcnt(0)
    s_barrier
    ds_read_b128 v[64:67], v6 offset:10240
    ds_read_b128 v[68:71], v6 offset:14336
    ds_read_b128 v[72:75], v6 offset:18432
    ds_read_b128 v[76:79], v6 offset:22528
    ds_read_b128 v[80:83], v6 offset:11264
    ds_read_b128 v[84:87], v6 offset:15360
    ds_read_b128 v[88:91], v6 offset:19456
    s_waitcnt lgkmcnt(6)
    v_mfma_f32_32x32x16_bf16 v[224:239], v[64:67], a[0:3], 0
    v_xor_b32 v244, s11, v0
    v_xor_b32 v245, 64, v0
    v_xor_b32 v246, 64, v244
    s_mov_b32 s14, 0x3e8b97f6
    v_lshlrev_b32 v20, 2, v35
    v_mov_b32 v22, 0xff800000
    s_cmp_lt_u32 s59, 8
    s_cselect_b32 s15, 0xff800000, 0
    v_mov_b32 v23, s15
    ds_read_b128 v[92:95], v6 offset:23552
    s_waitcnt lgkmcnt(6)
    v_mfma_f32_32x32x16_bf16 v[224:239], v[68:71], a[4:7], v[224:239]
    s_waitcnt vmcnt(19)
    ds_read_b64_tr_b16 a[144:145], v0 offset:0
    ds_read_b64_tr_b16 a[146:147], v0 offset:512
    v_add_u32 v21, 0, v20
    v_cmp_gt_u32 vcc, v21, v34
    s_nop 0
    s_nop 0
    v_cndmask_b32 v96, v22, v23, vcc
    ds_read_b128 v[64:67], v6 offset:12288
    s_waitcnt lgkmcnt(8)
    v_mfma_f32_32x32x16_bf16 v[224:239], v[72:75], a[8:11], v[224:239]
    ds_read_b64_tr_b16 a[148:149], v244 offset:0
    ds_read_b64_tr_b16 a[150:151], v244 offset:512
    v_add_u32 v21, 1, v20
    v_cmp_gt_u32 vcc, v21, v34
    s_nop 0
    s_nop 0
    v_cndmask_b32 v97, v22, v23, vcc
    ds_read_b128 v[68:71], v6 offset:16384
    s_waitcnt lgkmcnt(10)
    v_mfma_f32_32x32x16_bf16 v[224:239], v[76:79], a[12:15], v[224:239]
    ds_read_b64_tr_b16 a[152:153], v245 offset:0
    ds_read_b64_tr_b16 a[154:155], v245 offset:512
    v_add_u32 v21, 2, v20
    v_cmp_gt_u32 vcc, v21, v34
    s_nop 0
    s_nop 0
    v_cndmask_b32 v98, v22, v23, vcc
    ds_read_b128 v[72:75], v6 offset:20480
    s_waitcnt lgkmcnt(12)
    v_mfma_f32_32x32x16_bf16 v[224:239], v[80:83], a[16:19], v[224:239]
    ds_read_b64_tr_b16 a[156:157], v246 offset:0
    ds_read_b64_tr_b16 a[158:159], v246 offset:512
    v_add_u32 v21, 3, v20
    v_cmp_gt_u32 vcc, v21, v34
    s_nop 0
    s_nop 0
    v_cndmask_b32 v99, v22, v23, vcc
    ds_read_b128 v[76:79], v6 offset:24576
    s_waitcnt lgkmcnt(14)
    v_mfma_f32_32x32x16_bf16 v[224:239], v[84:87], a[20:23], v[224:239]
    s_waitcnt lgkmcnt(10)
    buffer_store_dwordx4 a[144:147], v5, s[16:19], s70 offen sc1
    v_add_u32 v21, 8, v20
    v_cmp_gt_u32 vcc, v21, v34
    s_nop 0
    s_nop 0
    v_cndmask_b32 v100, v22, v23, vcc
    ds_read_b128 v[80:83], v6 offset:13312
    s_waitcnt lgkmcnt(14)
    v_mfma_f32_32x32x16_bf16 v[224:239], v[88:91], a[24:27], v[224:239]
    s_waitcnt vmcnt(9)
    ds_read_b64_tr_b16 a[160:161], v0 offset:32768
    ds_read_b64_tr_b16 a[162:163], v0 offset:33280
    v_add_u32 v21, 9, v20
    v_cmp_gt_u32 vcc, v21, v34
    s_nop 0
    s_nop 0
    v_cndmask_b32 v101, v22, v23, vcc
    ds_read_b128 v[84:87], v6 offset:17408
    s_waitcnt lgkmcnt(15)
    v_mfma_f32_32x32x16_bf16 v[224:239], v[92:95], a[28:31], v[224:239]
    s_waitcnt lgkmcnt(11)
    buffer_store_dwordx4 a[148:151], v5, s[16:19], s71 offen sc1
    v_add_u32 v21, 10, v20
    v_cmp_gt_u32 vcc, v21, v34
    s_nop 0
    s_nop 0
    v_cndmask_b32 v102, v22, v23, vcc
    ds_read_b128 v[88:91], v6 offset:21504
    s_waitcnt lgkmcnt(14)
    v_mfma_f32_32x32x16_bf16 v[224:239], v[64:67], a[32:35], v[224:239]
    ds_read_b64_tr_b16 a[164:165], v244 offset:32768
    ds_read_b64_tr_b16 a[166:167], v244 offset:33280
    v_add_u32 v21, 11, v20
    v_cmp_gt_u32 vcc, v21, v34
    s_nop 0
    s_nop 0
    v_cndmask_b32 v103, v22, v23, vcc
    ds_read_b128 v[92:95], v6 offset:25600
    s_waitcnt lgkmcnt(14)
    v_mfma_f32_32x32x16_bf16 v[224:239], v[68:71], a[36:39], v[224:239]
    s_waitcnt lgkmcnt(12)
    buffer_store_dwordx4 a[152:155], v5, s[16:19], s72 offen sc1
    v_add_u32 v21, 16, v20
    v_cmp_gt_u32 vcc, v21, v34
    s_nop 0
    s_nop 0
    v_cndmask_b32 v104, v22, v23, vcc
    ds_read_b128 v[64:67], v6 offset:26624
    s_waitcnt lgkmcnt(12)
    v_mfma_f32_32x32x16_bf16 v[224:239], v[72:75], a[40:43], v[224:239]
    ds_read_b64_tr_b16 a[168:169], v245 offset:32768
    ds_read_b64_tr_b16 a[170:171], v245 offset:33280
    v_add_u32 v21, 17, v20
    v_cmp_gt_u32 vcc, v21, v34
    s_nop 0
    s_nop 0
    v_cndmask_b32 v105, v22, v23, vcc
    s_waitcnt vmcnt(3)
    buffer_store_dword v39, v38, s[16:19], s60 offen offset:0 sc1
    ds_read_b128 v[68:71], v6 offset:30720
    s_waitcnt lgkmcnt(12)
    v_mfma_f32_32x32x16_bf16 v[224:239], v[76:79], a[44:47], v[224:239]
    s_waitcnt lgkmcnt(13)
    buffer_store_dwordx4 a[156:159], v5, s[16:19], s73 offen sc1
    v_add_u32 v21, 18, v20
    v_cmp_gt_u32 vcc, v21, v34
    s_nop 0
    s_nop 0
    v_cndmask_b32 v106, v22, v23, vcc
    ds_read_b128 v[72:75], v6 offset:34816
    s_waitcnt lgkmcnt(12)
    v_mfma_f32_32x32x16_bf16 v[224:239], v[80:83], a[48:51], v[224:239]
    ds_read_b64_tr_b16 a[172:173], v246 offset:32768
    ds_read_b64_tr_b16 a[174:175], v246 offset:33280
    v_add_u32 v21, 19, v20
    v_cmp_gt_u32 vcc, v21, v34
    s_nop 0
    s_nop 0
    v_cndmask_b32 v107, v22, v23, vcc
    ds_read_b128 v[76:79], v6 offset:38912
    s_waitcnt lgkmcnt(12)
    v_mfma_f32_32x32x16_bf16 v[224:239], v[84:87], a[52:55], v[224:239]
    s_waitcnt lgkmcnt(13)
    buffer_store_dwordx4 a[160:163], v5, s[16:19], s74 offen sc1
    v_add_u32 v21, 24, v20
    v_cmp_gt_u32 vcc, v21, v34
    s_nop 0
    s_nop 0
    v_cndmask_b32 v108, v22, v23, vcc
    ds_read_b128 v[80:83], v6 offset:27648
    s_waitcnt lgkmcnt(12)
    v_mfma_f32_32x32x16_bf16 v[224:239], v[88:91], a[56:59], v[224:239]
    s_waitcnt lgkmcnt(10)
    buffer_store_dwordx4 a[164:167], v5, s[16:19], s75 offen sc1
    v_add_u32 v21, 25, v20
    v_cmp_gt_u32 vcc, v21, v34
    s_nop 0
    s_nop 0
    v_cndmask_b32 v109, v22, v23, vcc
    ds_read_b128 v[84:87], v6 offset:31744
    s_waitcnt lgkmcnt(10)
    v_mfma_f32_32x32x16_bf16 v[224:239], v[92:95], a[60:63], v[224:239]
    s_waitcnt lgkmcnt(7)
    buffer_store_dwordx4 a[168:171], v5, s[16:19], s76 offen sc1
    v_add_u32 v21, 26, v20
    v_cmp_gt_u32 vcc, v21, v34
    s_nop 0
    s_nop 0
    v_cndmask_b32 v110, v22, v23, vcc
    ds_read_b128 v[88:91], v6 offset:35840
    s_waitcnt lgkmcnt(10)
    v_mfma_f32_32x32x16_bf16 v[224:239], v[64:67], a[64:67], v[224:239]
    s_waitcnt lgkmcnt(4)
    buffer_store_dwordx4 a[172:175], v5, s[16:19], s77 offen sc1
    v_add_u32 v21, 27, v20
    v_cmp_gt_u32 vcc, v21, v34
    s_nop 0
    s_nop 0
    v_cndmask_b32 v111, v22, v23, vcc
    ds_read_b128 v[92:95], v6 offset:39936
    s_waitcnt lgkmcnt(8)
    v_mfma_f32_32x32x16_bf16 v[224:239], v[68:71], a[68:71], v[224:239]
    s_load_dwordx2 s[28:29], s[0:1], 16
    s_mov_b32 s30, 0x62000
    s_cmp_lt_u32 s59, 7
    s_cselect_b32 s15, 0xff800000, 0
    v_mov_b32 v112, s15
    v_mov_b32 v113, s15
    v_mov_b32 v114, s15
    ds_read_b128 v[64:67], v6 offset:28672
    s_waitcnt lgkmcnt(8)
    v_mfma_f32_32x32x16_bf16 v[224:239], v[72:75], a[72:75], v[224:239]
    v_mov_b32 v115, s15
    v_mov_b32 v116, s15
    v_mov_b32 v117, s15
    v_mov_b32 v118, s15
    v_mov_b32 v119, s15
    ds_read_b128 v[68:71], v6 offset:32768
    s_waitcnt lgkmcnt(6)
    v_mfma_f32_32x32x16_bf16 v[224:239], v[76:79], a[76:79], v[224:239]
    v_mov_b32 v120, s15
    v_mov_b32 v121, s15
    v_mov_b32 v122, s15
    v_mov_b32 v123, s15
    v_mov_b32 v124, s15
    ds_read_b128 v[72:75], v6 offset:36864
    s_waitcnt lgkmcnt(6)
    v_mfma_f32_32x32x16_bf16 v[224:239], v[80:83], a[80:83], v[224:239]
    v_mov_b32 v125, s15
    v_mov_b32 v126, s15
    v_mov_b32 v127, s15
    s_cmp_lt_u32 s59, 6
    s_cselect_b32 s15, 0xff800000, 0
    v_mov_b32 v128, s15
    ds_read_b128 v[76:79], v6 offset:40960
    s_waitcnt lgkmcnt(6)
    v_mfma_f32_32x32x16_bf16 v[224:239], v[84:87], a[84:87], v[224:239]
    v_mov_b32 v129, s15
    v_mov_b32 v130, s15
    v_mov_b32 v131, s15
    v_mov_b32 v132, s15
    v_mov_b32 v133, s15
    ds_read_b128 v[80:83], v6 offset:59392
    s_waitcnt lgkmcnt(6)
    v_mfma_f32_32x32x16_bf16 v[224:239], v[88:91], a[88:91], v[224:239]
    v_mov_b32 v134, s15
    v_mov_b32 v135, s15
    v_mov_b32 v136, s15
    v_mov_b32 v137, s15
    v_mov_b32 v138, s15
    s_waitcnt lgkmcnt(5)
    v_mfma_f32_32x32x16_bf16 v[224:239], v[92:95], a[92:95], v[224:239]
    v_mov_b32 v139, s15
    v_mov_b32 v140, s15
    v_mov_b32 v141, s15
    v_mov_b32 v142, s15
    v_mov_b32 v143, s15
    s_waitcnt lgkmcnt(4)
    v_mfma_f32_32x32x16_bf16 v[224:239], v[64:67], a[96:99], v[224:239]
    s_cmp_lt_u32 s59, 5
    s_cselect_b32 s15, 0xff800000, 0
    v_mov_b32 v144, s15
    v_mov_b32 v145, s15
    v_mov_b32 v146, s15
    v_mov_b32 v147, s15
    s_waitcnt lgkmcnt(3)
    v_mfma_f32_32x32x16_bf16 v[224:239], v[68:71], a[100:103], v[224:239]
    v_mov_b32 v148, s15
    v_mov_b32 v149, s15
    v_mov_b32 v150, s15
    v_mov_b32 v151, s15
    v_mov_b32 v152, s15
    s_waitcnt lgkmcnt(2)
    v_mfma_f32_32x32x16_bf16 v[224:239], v[72:75], a[104:107], v[224:239]
    v_mov_b32 v153, s15
    v_mov_b32 v154, s15
    v_mov_b32 v155, s15
    v_mov_b32 v156, s15
    v_mov_b32 v157, s15
    s_waitcnt lgkmcnt(1)
    v_mfma_f32_32x32x16_bf16 v[224:239], v[76:79], a[108:111], v[224:239]
    v_mov_b32 v158, s15
    v_mov_b32 v159, s15
    s_cmp_lt_u32 s59, 4
    s_cselect_b32 s15, 0xff800000, 0
    v_mov_b32 v160, s15
    v_mov_b32 v161, s15
    s_waitcnt lgkmcnt(0)
    v_mfma_f32_32x32x16_bf16 v[224:239], v[80:83], v[16:19], v[224:239]
    v_mov_b32 v162, s15
    v_mov_b32 v163, s15
    v_mov_b32 v164, s15
    v_mov_b32 v165, s15
    v_mov_b32 v166, s15
    s_waitcnt lgkmcnt(0)
    s_barrier
    s_lshl_b32 s27, s3, 13
    s_add_u32 s27, s27, 114688
    s_mov_b32 m0, s27
    s_add_u32 s21, s59, s3
    s_cmp_lt_u32 s21, 8
    s_cbranch_scc1 k1_nohalo
    s_mov_b64 exec, s[62:63]
    buffer_load_dword v1, v11, s[16:19], s53 offen offset:0 sc1
    s_mov_b64 exec, -1
    v_mov_b32 v167, s15
    v_mov_b32 v168, s15
    v_mov_b32 v169, s15
    v_mov_b32 v170, s15
    v_mov_b32 v171, s15
    v_mov_b32 v172, s15
    v_mov_b32 v173, s15
    v_mov_b32 v174, s15
    v_mov_b32 v175, s15
    s_cmp_lt_u32 s59, 3
    s_cselect_b32 s15, 0xff800000, 0
    v_mov_b32 v176, s15
    v_mov_b32 v177, s15
    v_mov_b32 v178, s15
    v_mov_b32 v179, s15
    v_mov_b32 v180, s15
    v_mov_b32 v181, s15
    v_mov_b32 v182, s15
    v_mov_b32 v183, s15
    v_mov_b32 v184, s15
    v_mov_b32 v185, s15
    v_mov_b32 v186, s15
    v_mov_b32 v187, s15
    v_mov_b32 v188, s15
    v_mov_b32 v189, s15
    v_mov_b32 v190, s15
    v_mov_b32 v191, s15
    s_add_u32 s32, s3, 0
    s_and_b32 s32, s32, 3
    s_mul_i32 s21, s32, 16384
    v_add_u32 v12, s21, v5
    s_add_u32 s33, s3, 1
    s_and_b32 s33, s33, 3
    s_mul_i32 s21, s33, 16384
    v_add_u32 v13, s21, v5
    s_add_u32 s34, s3, 2
    s_and_b32 s34, s34, 3
    s_mul_i32 s21, s34, 16384
    v_add_u32 v14, s21, v5
    s_add_u32 s35, s3, 3
    s_and_b32 s35, s35, 3
    s_mul_i32 s21, s35, 16384
    v_add_u32 v15, s21, v5
    s_and_b32 s29, s29, 0xffff
    v_lshrrev_b32 v72, 3, v2
    v_and_b32 v73, 4, v72
    v_add_u32 v72, v73, v72
    v_mul_u32_u24 v64, 896, v72
    v_and_b32 v72, 7, v2
    v_bfe_u32 v73, v2, 4, 1
    v_xor_b32 v72, v72, v73
    v_lshl_add_u32 v64, v72, 4, v64
    v_xor_b32 v65, 32, v64
    v_xor_b32 v66, 64, v64
    v_xor_b32 v67, 96, v64
    v_add_u32 v65, 2560, v65
    v_add_u32 v66, 12288, v66
    v_add_u32 v67, 14848, v67
    v_lshl_add_u32 v67, v35, 28, v67
    v_bfe_u32 v72, v2, 2, 2
    v_bfe_u32 v73, v2, 3, 1
    v_lshl_add_u32 v68, v4, 3, v72
    v_lshl_add_u32 v73, v4, 1, v73
    v_and_b32 v72, 3, v2
    v_xor_b32 v73, v73, v72
    v_lshlrev_b32 v73, 4, v73
    v_lshl_add_u32 v68, v68, 7, v73
    s_add_u32 s21, s26, 32768
    v_add_u32 v68, s21, v68
    v_xor_b32 v69, 8, v68
    v_xor_b32 v70, 64, v68
    v_xor_b32 v71, 72, v68
    s_cmp_lt_u32 s59, 2
    s_cselect_b32 s15, 0xff800000, 0
    v_mov_b32 v192, s15
    v_mov_b32 v193, s15
    v_mov_b32 v194, s15
    v_mov_b32 v195, s15
    v_mov_b32 v196, s15
    v_mov_b32 v197, s15
    v_mov_b32 v198, s15
    v_mov_b32 v199, s15
    v_mov_b32 v200, s15
    v_mov_b32 v201, s15
    v_mov_b32 v202, s15
    v_mov_b32 v203, s15
    v_mov_b32 v204, s15
    v_mov_b32 v205, s15
    v_mov_b32 v206, s15
    v_mov_b32 v207, s15
    s_cmp_lt_u32 s59, 1
    s_cselect_b32 s15, 0xff800000, 0
    v_mov_b32 v208, s15
    v_mov_b32 v209, s15
    v_mov_b32 v210, s15
    v_mov_b32 v211, s15
    v_mov_b32 v212, s15
    v_mov_b32 v213, s15
    v_mov_b32 v214, s15
    v_mov_b32 v215, s15
    v_mov_b32 v216, s15
    v_mov_b32 v217, s15
    v_mov_b32 v218, s15
    v_mov_b32 v219, s15
    v_mov_b32 v220, s15
    v_mov_b32 v221, s15
    v_mov_b32 v222, s15
    v_mov_b32 v223, s15
    s_waitcnt vmcnt(0)
    v_subrev_u32 v1, s61, v1
    v_cmp_gt_u32 vcc, 64, v1
    s_and_b64 s[42:43], vcc, s[62:63]
    s_cmp_eq_u64 s[42:43], s[62:63]
    s_cbranch_scc0 slow_3
back_4:
    buffer_load_dwordx4 v5, s[16:19], s52 offen offset:0 sc1 lds
    buffer_load_dwordx4 v5, s[16:19], s52 offen offset:1024 sc1 lds
    buffer_load_dwordx4 v5, s[16:19], s52 offen offset:2048 sc1 lds
    buffer_load_dwordx4 v5, s[16:19], s52 offen offset:3072 sc1 lds
    s_add_u32 s27, s27, 4096
    s_mov_b32 m0, s27
    s_add_u32 s52, s52, 4096
    buffer_load_dwordx4 v5, s[16:19], s52 offen offset:0 sc1 lds
    buffer_load_dwordx4 v5, s[16:19], s52 offen offset:1024 sc1 lds
    buffer_load_dwordx4 v5, s[16:19], s52 offen offset:2048 sc1 lds
    buffer_load_dwordx4 v5, s[16:19], s52 offen offset:3072 sc1 lds
    s_waitcnt vmcnt(9)
    s_barrier
    v_mul_u32_u24 v72, 1280, v2
    s_mov_b64 exec, 0xffff
    buffer_store_dword v39, v72, s[16:19], s55 offen sc1
    s_mov_b64 exec, -1
    s_branch k1_halo_done
k1_nohalo:
    v_mov_b32 v167, s15
    v_mov_b32 v168, s15
    v_mov_b32 v169, s15
    v_mov_b32 v170, s15
    v_mov_b32 v171, s15
    v_mov_b32 v172, s15
    v_mov_b32 v173, s15
    v_mov_b32 v174, s15
    v_mov_b32 v175, s15
    s_cmp_lt_u32 s59, 3
    s_cselect_b32 s15, 0xff800000, 0
    v_mov_b32 v176, s15
    v_mov_b32 v177, s15
    v_mov_b32 v178, s15
    v_mov_b32 v179, s15
    v_mov_b32 v180, s15
    v_mov_b32 v181, s15
    v_mov_b32 v182, s15
    v_mov_b32 v183, s15
    v_mov_b32 v184, s15
    v_mov_b32 v185, s15
    v_mov_b32 v186, s15
    v_mov_b32 v187, s15
    v_mov_b32 v188, s15
    v_mov_b32 v189, s15
    v_mov_b32 v190, s15
    v_mov_b32 v191, s15
    s_add_u32 s32, s3, 0
    s_and_b32 s32, s32, 3
    s_mul_i32 s21, s32, 16384
    v_add_u32 v12, s21, v5
    s_add_u32 s33, s3, 1
    s_and_b32 s33, s33, 3
    s_mul_i32 s21, s33, 16384
    v_add_u32 v13, s21, v5
    s_add_u32 s34, s3, 2
    s_and_b32 s34, s34, 3
    s_mul_i32 s21, s34, 16384
    v_add_u32 v14, s21, v5
    s_add_u32 s35, s3, 3
    s_and_b32 s35, s35, 3
    s_mul_i32 s21, s35, 16384
    v_add_u32 v15, s21, v5
    s_and_b32 s29, s29, 0xffff
    v_lshrrev_b32 v72, 3, v2
    v_and_b32 v73, 4, v72
    v_add_u32 v72, v73, v72
    v_mul_u32_u24 v64, 896, v72
    v_and_b32 v72, 7, v2
    v_bfe_u32 v73, v2, 4, 1
    v_xor_b32 v72, v72, v73
    v_lshl_add_u32 v64, v72, 4, v64
    v_xor_b32 v65, 32, v64
    v_xor_b32 v66, 64, v64
    v_xor_b32 v67, 96, v64
    v_add_u32 v65, 2560, v65
    v_add_u32 v66, 12288, v66
    v_add_u32 v67, 14848, v67
    v_lshl_add_u32 v67, v35, 28, v67
    v_bfe_u32 v72, v2, 2, 2
    v_bfe_u32 v73, v2, 3, 1
    v_lshl_add_u32 v68, v4, 3, v72
    v_lshl_add_u32 v73, v4, 1, v73
    v_and_b32 v72, 3, v2
    v_xor_b32 v73, v73, v72
    v_lshlrev_b32 v73, 4, v73
    v_lshl_add_u32 v68, v68, 7, v73
    s_add_u32 s21, s26, 32768
    v_add_u32 v68, s21, v68
    v_xor_b32 v69, 8, v68
    v_xor_b32 v70, 64, v68
    v_xor_b32 v71, 72, v68
    s_cmp_lt_u32 s59, 2
    s_cselect_b32 s15, 0xff800000, 0
    v_mov_b32 v192, s15
    v_mov_b32 v193, s15
    v_mov_b32 v194, s15
    v_mov_b32 v195, s15
    v_mov_b32 v196, s15
    v_mov_b32 v197, s15
    v_mov_b32 v198, s15
    v_mov_b32 v199, s15
    v_mov_b32 v200, s15
    v_mov_b32 v201, s15
    v_mov_b32 v202, s15
    v_mov_b32 v203, s15
    v_mov_b32 v204, s15
    v_mov_b32 v205, s15
    v_mov_b32 v206, s15
    v_mov_b32 v207, s15
    s_cmp_lt_u32 s59, 1
    s_cselect_b32 s15, 0xff800000, 0
    v_mov_b32 v208, s15
    v_mov_b32 v209, s15
    v_mov_b32 v210, s15
    v_mov_b32 v211, s15
    v_mov_b32 v212, s15
    v_mov_b32 v213, s15
    v_mov_b32 v214, s15
    v_mov_b32 v215, s15
    v_mov_b32 v216, s15
    v_mov_b32 v217, s15
    v_mov_b32 v218, s15
    v_mov_b32 v219, s15
    v_mov_b32 v220, s15
    v_mov_b32 v221, s15
    v_mov_b32 v222, s15
    v_mov_b32 v223, s15
    s_waitcnt vmcnt(0)
    s_barrier
    v_mul_u32_u24 v72, 1280, v2
    s_mov_b64 exec, 0xffff
    buffer_store_dword v39, v72, s[16:19], s55 offen sc1
    s_mov_b64 exec, -1
    v_add_u32 v9, s27, v5
    v_mov_b32 v24, 0
    v_mov_b32 v25, 0
    v_mov_b32 v26, 0
    v_mov_b32 v27, 0
    ds_write_b128 v9, v[24:27] offset:0
    ds_write_b128 v9, v[24:27] offset:1024
    ds_write_b128 v9, v[24:27] offset:2048
    ds_write_b128 v9, v[24:27] offset:3072
    ds_write_b128 v9, v[24:27] offset:4096
    ds_write_b128 v9, v[24:27] offset:5120
    ds_write_b128 v9, v[24:27] offset:6144
    ds_write_b128 v9, v[24:27] offset:7168
    s_waitcnt lgkmcnt(0)
k1_halo_done:
    v_mul_f32 v36, s14, v36
    v_mul_f32 v37, s14, v37
    v_mul_f32 v224, v224, v36
    v_mul_f32 v225, v225, v36
    v_mul_f32 v226, v226, v36
    v_mul_f32 v227, v227, v36
    v_mul_f32 v228, v228, v36
    v_mul_f32 v229, v229, v36
    v_mul_f32 v230, v230, v36
    v_mul_f32 v231, v231, v36
    v_mul_f32 v232, v232, v36
    v_mul_f32 v233, v233, v36
    v_mul_f32 v234, v234, v36
    v_mul_f32 v235, v235, v36
    v_mul_f32 v236, v236, v37
    v_mul_f32 v237, v237, v37
    v_mul_f32 v238, v238, v37
    v_mul_f32 v239, v239, v37
    v_cvt_pk_bf16_f32 v56, v224, v225
    v_cvt_pk_bf16_f32 v57, v226, v227
    v_cvt_pk_bf16_f32 v58, v228, v229
    v_cvt_pk_bf16_f32 v59, v230, v231
    v_cvt_pk_bf16_f32 v60, v232, v233
    v_cvt_pk_bf16_f32 v61, v234, v235
    v_cvt_pk_bf16_f32 v62, v236, v237
    v_cvt_pk_bf16_f32 v63, v238, v239
    v_add_u32 v21, 0, v20
    v_cmp_gt_u32 vcc, v21, v34
    s_nop 0
    s_nop 0
    v_cndmask_b32 v224, 0, v22, vcc
    v_add_u32 v21, 1, v20
    v_cmp_gt_u32 vcc, v21, v34
    s_nop 0
    s_nop 0
    v_cndmask_b32 v225, 0, v22, vcc
    v_add_u32 v21, 2, v20
    v_cmp_gt_u32 vcc, v21, v34
    s_nop 0
    s_nop 0
    v_cndmask_b32 v226, 0, v22, vcc
    v_add_u32 v21, 3, v20
    v_cmp_gt_u32 vcc, v21, v34
    s_nop 0
    s_nop 0
    v_cndmask_b32 v227, 0, v22, vcc
    v_add_u32 v21, 8, v20
    v_cmp_gt_u32 vcc, v21, v34
    s_nop 0
    s_nop 0
    v_cndmask_b32 v228, 0, v22, vcc
    v_add_u32 v21, 9, v20
    v_cmp_gt_u32 vcc, v21, v34
    s_nop 0
    s_nop 0
    v_cndmask_b32 v229, 0, v22, vcc
    v_add_u32 v21, 10, v20
    v_cmp_gt_u32 vcc, v21, v34
    s_nop 0
    s_nop 0
    v_cndmask_b32 v230, 0, v22, vcc
    v_add_u32 v21, 11, v20
    v_cmp_gt_u32 vcc, v21, v34
    s_nop 0
    s_nop 0
    v_cndmask_b32 v231, 0, v22, vcc
    v_add_u32 v21, 16, v20
    v_cmp_gt_u32 vcc, v21, v34
    s_nop 0
    s_nop 0
    v_cndmask_b32 v232, 0, v22, vcc
    v_add_u32 v21, 17, v20
    v_cmp_gt_u32 vcc, v21, v34
    s_nop 0
    s_nop 0
    v_cndmask_b32 v233, 0, v22, vcc
    v_add_u32 v21, 18, v20
    v_cmp_gt_u32 vcc, v21, v34
    s_nop 0
    s_nop 0
    v_cndmask_b32 v234, 0, v22, vcc
    v_add_u32 v21, 19, v20
    v_cmp_gt_u32 vcc, v21, v34
    s_nop 0
    s_nop 0
    v_cndmask_b32 v235, 0, v22, vcc
    v_add_u32 v21, 24, v20
    v_cmp_gt_u32 vcc, v21, v34
    s_nop 0
    s_nop 0
    v_cndmask_b32 v236, 0, v22, vcc
    v_add_u32 v21, 25, v20
    v_cmp_gt_u32 vcc, v21, v34
    s_nop 0
    s_nop 0
    v_cndmask_b32 v237, 0, v22, vcc
    v_add_u32 v21, 26, v20
    v_cmp_gt_u32 vcc, v21, v34
    s_nop 0
    s_nop 0
    v_cndmask_b32 v238, 0, v22, vcc
    v_add_u32 v21, 27, v20
    v_cmp_gt_u32 vcc, v21, v34
    s_nop 0
    s_nop 0
    v_cndmask_b32 v239, 0, v22, vcc
    s_add_u32 m0, s26, 32768
    s_nop 0
    buffer_load_dwordx4 v64, s[28:31], s24 offen offset:0 lds
    buffer_load_dwordx4 v65, s[28:31], s24 offen offset:1024 lds
    buffer_load_dwordx4 v66, s[28:31], s24 offen offset:2048 lds
    buffer_load_dwordx4 v67, s[28:31], s24 offen offset:3072 lds
    s_add_u32 s24, s24, 100352
    s_waitcnt vmcnt(5)
    s_barrier
    ds_read_b128 a[0:3], v7 offset:0
    ds_read_b128 a[8:11], v7 offset:4096
    ds_read_b128 a[4:7], v7 offset:1024
    ds_read_b128 a[12:15], v7 offset:5120
    ds_read_b128 a[16:19], v7 offset:8192
    ds_read_b128 a[20:23], v7 offset:9216
    ds_read_b128 a[24:27], v7 offset:12288
    ds_read_b128 a[28:31], v7 offset:13312
    s_waitcnt lgkmcnt(7)
    v_mfma_f32_32x32x16_bf16 v[96:111], a[0:3], v[56:59], v[96:111]
    s_waitcnt lgkmcnt(6)
    v_mfma_f32_32x32x16_bf16 v[112:127], a[8:11], v[56:59], v[112:127]
    s_waitcnt lgkmcnt(5)
    v_mfma_f32_32x32x16_bf16 v[96:111], a[4:7], v[60:63], v[96:111]
    s_waitcnt lgkmcnt(4)
    v_mfma_f32_32x32x16_bf16 v[112:127], a[12:15], v[60:63], v[112:127]
    ds_read_b128 a[32:35], v7 offset:2048
    ds_read_b128 a[36:39], v7 offset:3072
    ds_read_b128 a[40:43], v7 offset:6144
    ds_read_b128 a[44:47], v7 offset:7168
    s_add_u32 m0, s26, 49152
    s_nop 0
    buffer_load_dwordx4 v64, s[28:31], s24 offen offset:0 lds
    buffer_load_dwordx4 v65, s[28:31], s24 offen offset:1024 lds
    s_waitcnt lgkmcnt(7)
    v_mfma_f32_32x32x16_bf16 v[128:143], a[16:19], v[56:59], v[128:143]
    v_exp_f32 v96, v96
    v_exp_f32 v97, v97
    buffer_load_dwordx4 v66, s[28:31], s24 offen offset:2048 lds
    v_exp_f32 v98, v98
    ds_read_b128 a[0:3], v7 offset:16384
    v_exp_f32 v99, v99
    v_cvt_pk_bf16_f32 v96, v96, v97
    v_exp_f32 v100, v100
    v_exp_f32 v101, v101
    v_cvt_pk_bf16_f32 v97, v98, v99
    v_exp_f32 v102, v102
    ds_read_b128 a[48:51], v7 offset:10240
    v_exp_f32 v103, v103
    v_cvt_pk_bf16_f32 v98, v100, v101
    s_waitcnt lgkmcnt(8)
    v_mfma_f32_32x32x16_bf16 v[128:143], a[20:23], v[60:63], v[128:143]
    v_exp_f32 v104, v104
    v_exp_f32 v105, v105
    buffer_load_dwordx4 v67, s[28:31], s24 offen offset:3072 lds
    s_add_u32 s24, s24, 100352
    v_cvt_pk_bf16_f32 v99, v102, v103
    v_exp_f32 v106, v106
    ds_read_b128 a[4:7], v7 offset:17408
    v_exp_f32 v107, v107
    v_cvt_pk_bf16_f32 v100, v104, v105
    v_exp_f32 v108, v108
    v_exp_f32 v109, v109
    v_cvt_pk_bf16_f32 v101, v106, v107
    v_exp_f32 v110, v110
    ds_read_b128 a[52:55], v7 offset:11264
    v_exp_f32 v111, v111
    v_cvt_pk_bf16_f32 v102, v108, v109
    s_nop 0
    v_cvt_pk_bf16_f32 v103, v110, v111
    buffer_store_dwordx4 a[252:255], v8, s[16:19], s80 offen sc1
    s_bitset1_b32 s80, 13
    s_waitcnt lgkmcnt(9)
    v_mfma_f32_32x32x16_bf16 v[144:159], a[24:27], v[56:59], v[144:159]
    v_exp_f32 v112, v112
    v_exp_f32 v113, v113
    s_add_u32 m0, s26, 65536
    s_nop 0
    buffer_load_dwordx4 v64, s[28:31], s24 offen offset:0 lds
    v_exp_f32 v114, v114
    ds_read_b128 a[8:11], v7 offset:20480
    v_exp_f32 v115, v115
    v_cvt_pk_bf16_f32 v112, v112, v113
    s_waitcnt lgkmcnt(8)
    v_mfma_f32_32x32x16_bf16 v[40:55], a[32:35], v[96:99], 0
    v_exp_f32 v116, v116
    v_exp_f32 v117, v117
    v_cvt_pk_bf16_f32 v113, v114, v115
    v_exp_f32 v118, v118
    ds_read_b128 a[56:59], v7 offset:14336
    v_exp_f32 v119, v119
    v_cvt_pk_bf16_f32 v114, v116, v117
    s_waitcnt lgkmcnt(10)
    v_mfma_f32_32x32x16_bf16 v[144:159], a[28:31], v[60:63], v[144:159]
    v_exp_f32 v120, v120
    v_exp_f32 v121, v121
    buffer_load_dwordx4 v65, s[28:31], s24 offen offset:1024 lds
    v_cvt_pk_bf16_f32 v115, v118, v119
    v_exp_f32 v122, v122
    ds_read_b128 a[12:15], v7 offset:21504
    v_exp_f32 v123, v123
    v_cvt_pk_bf16_f32 v116, v120, v121
    s_waitcnt lgkmcnt(9)
    v_mfma_f32_32x32x16_bf16 v[40:55], a[36:39], v[100:103], v[40:55]
    v_exp_f32 v124, v124
    v_exp_f32 v125, v125
    v_cvt_pk_bf16_f32 v117, v122, v123
    v_exp_f32 v126, v126
    ds_read_b128 a[60:63], v7 offset:15360
    v_exp_f32 v127, v127
    v_cvt_pk_bf16_f32 v118, v124, v125
    s_nop 0
    v_cvt_pk_bf16_f32 v119, v126, v127
    buffer_store_dwordx4 a[252:255], v8, s[16:19], s80 offen sc1
    s_bitset1_b32 s80, 15
    s_waitcnt lgkmcnt(7)
    v_mfma_f32_32x32x16_bf16 v[160:175], a[0:3], v[56:59], v[160:175]
    v_exp_f32 v128, v128
    v_exp_f32 v129, v129
    buffer_load_dwordx4 v66, s[28:31], s24 offen offset:2048 lds
    v_exp_f32 v130, v130
    ds_read_b128 a[16:19], v7 offset:24576
    v_exp_f32 v131, v131
    v_cvt_pk_bf16_f32 v128, v128, v129
    s_waitcnt lgkmcnt(10)
    v_mfma_f32_32x32x16_bf16 v[40:55], a[40:43], v[112:115], v[40:55]
    v_exp_f32 v132, v132
    v_exp_f32 v133, v133
    v_cvt_pk_bf16_f32 v129, v130, v131
    v_exp_f32 v134, v134
    ds_read_b128 a[32:35], v7 offset:18432
    v_exp_f32 v135, v135
    v_cvt_pk_bf16_f32 v130, v132, v133
    s_waitcnt lgkmcnt(7)
    v_mfma_f32_32x32x16_bf16 v[160:175], a[4:7], v[60:63], v[160:175]
    v_exp_f32 v136, v136
    v_exp_f32 v137, v137
    buffer_load_dwordx4 v67, s[28:31], s24 offen offset:3072 lds
    s_add_u32 s24, s24, 100352
    v_cvt_pk_bf16_f32 v131, v134, v135
    v_exp_f32 v138, v138
    ds_read_b128 a[20:23], v7 offset:25600
    v_exp_f32 v139, v139
    v_cvt_pk_bf16_f32 v132, v136, v137
    s_waitcnt lgkmcnt(11)
    v_mfma_f32_32x32x16_bf16 v[40:55], a[44:47], v[116:119], v[40:55]
    v_exp_f32 v140, v140
    v_exp_f32 v141, v141
    v_cvt_pk_bf16_f32 v133, v138, v139
    v_exp_f32 v142, v142
    ds_read_b128 a[36:39], v7 offset:19456
    v_exp_f32 v143, v143
    v_cvt_pk_bf16_f32 v134, v140, v141
    s_nop 0
    v_cvt_pk_bf16_f32 v135, v142, v143
    buffer_store_dwordx4 a[252:255], v8, s[16:19], s80 offen sc1
    s_bitset0_b32 s80, 13
    s_waitcnt lgkmcnt(7)
    v_mfma_f32_32x32x16_bf16 v[176:191], a[8:11], v[56:59], v[176:191]
    v_exp_f32 v144, v144
    v_exp_f32 v145, v145
    s_add_u32 m0, s26, 81920
    s_nop 0
    buffer_load_dwordx4 v64, s[28:31], s24 offen offset:0 lds
    v_exp_f32 v146, v146
    ds_read_b128 a[24:27], v7 offset:28672
    v_exp_f32 v147, v147
    v_cvt_pk_bf16_f32 v144, v144, v145
    s_waitcnt lgkmcnt(11)
    v_mfma_f32_32x32x16_bf16 v[40:55], a[48:51], v[128:131], v[40:55]
    v_exp_f32 v148, v148
    v_exp_f32 v149, v149
    v_cvt_pk_bf16_f32 v145, v146, v147
    v_exp_f32 v150, v150
    ds_read_b128 a[40:43], v7 offset:22528
    v_exp_f32 v151, v151
    v_cvt_pk_bf16_f32 v146, v148, v149
    s_waitcnt lgkmcnt(7)
    v_mfma_f32_32x32x16_bf16 v[176:191], a[12:15], v[60:63], v[176:191]
    v_exp_f32 v152, v152
    v_exp_f32 v153, v153
    buffer_load_dwordx4 v65, s[28:31], s24 offen offset:1024 lds
    v_cvt_pk_bf16_f32 v147, v150, v151
    v_exp_f32 v154, v154
    ds_read_b128 a[28:31], v7 offset:29696
    v_exp_f32 v155, v155
    v_cvt_pk_bf16_f32 v148, v152, v153
    s_waitcnt lgkmcnt(11)
    v_mfma_f32_32x32x16_bf16 v[40:55], a[52:55], v[132:135], v[40:55]
    v_exp_f32 v156, v156
    v_exp_f32 v157, v157
    v_cvt_pk_bf16_f32 v149, v154, v155
    v_exp_f32 v158, v158
    ds_read_b128 a[44:47], v7 offset:23552
    v_exp_f32 v159, v159
    v_cvt_pk_bf16_f32 v150, v156, v157
    s_nop 0
    v_cvt_pk_bf16_f32 v151, v158, v159
    buffer_store_dwordx4 a[252:255], v8, s[16:19], s80 offen sc1
    s_bitset1_b32 s80, 16
    v_lshrrev_b32 v9, 1, v2
    v_and_b32 v1, 1, v2
    v_lshl_add_u32 v9, v9, 4, v1
    v_lshlrev_b32 v9, 7, v9
    s_mov_b32 s62, 0xff
    s_mov_b64 exec, s[62:63]
    buffer_load_dword v1, v9, s[16:19], s47 offen offset:0 sc1
    s_mov_b64 exec, -1
    s_waitcnt lgkmcnt(7)
    v_mfma_f32_32x32x16_bf16 v[192:207], a[16:19], v[56:59], v[192:207]
    v_exp_f32 v160, v160
    v_exp_f32 v161, v161
    buffer_load_dwordx4 v66, s[28:31], s24 offen offset:2048 lds
    v_exp_f32 v162, v162
    ds_read_b128 a[0:3], v7 offset:32768
    v_exp_f32 v163, v163
    v_cvt_pk_bf16_f32 v160, v160, v161
    s_waitcnt lgkmcnt(11)
    v_mfma_f32_32x32x16_bf16 v[40:55], a[56:59], v[144:147], v[40:55]
    v_exp_f32 v164, v164
    v_exp_f32 v165, v165
    v_cvt_pk_bf16_f32 v161, v162, v163
    v_exp_f32 v166, v166
    ds_read_b128 a[48:51], v7 offset:26624
    v_exp_f32 v167, v167
    v_cvt_pk_bf16_f32 v162, v164, v165
    s_waitcnt lgkmcnt(7)
    v_mfma_f32_32x32x16_bf16 v[192:207], a[20:23], v[60:63], v[192:207]
    v_exp_f32 v168, v168
    v_exp_f32 v169, v169
    buffer_load_dwordx4 v67, s[28:31], s24 offen offset:3072 lds
    v_cvt_pk_bf16_f32 v163, v166, v167
    v_exp_f32 v170, v170
    ds_read_b128 a[4:7], v7 offset:33792
    v_exp_f32 v171, v171
    v_cvt_pk_bf16_f32 v164, v168, v169
    s_waitcnt lgkmcnt(11)
    v_mfma_f32_32x32x16_bf16 v[40:55], a[60:63], v[148:151], v[40:55]
    v_exp_f32 v172, v172
    v_exp_f32 v173, v173
    v_cvt_pk_bf16_f32 v165, v170, v171
    v_exp_f32 v174, v174
    ds_read_b128 a[52:55], v7 offset:27648
    v_exp_f32 v175, v175
    v_cvt_pk_bf16_f32 v166, v172, v173
    s_nop 0
    v_cvt_pk_bf16_f32 v167, v174, v175
    buffer_store_dwordx4 a[252:255], v8, s[16:19], s80 offen sc1
    s_bitset0_b32 s80, 15
    s_waitcnt lgkmcnt(7)
    v_mfma_f32_32x32x16_bf16 v[208:223], a[24:27], v[56:59], v[208:223]
    v_exp_f32 v176, v176
    v_exp_f32 v177, v177
    v_exp_f32 v178, v178
    v_exp_f32 v179, v179
    v_cvt_pk_bf16_f32 v176, v176, v177
    s_waitcnt lgkmcnt(10)
    v_mfma_f32_32x32x16_bf16 v[40:55], a[32:35], v[160:163], v[40:55]
    v_exp_f32 v180, v180
    v_exp_f32 v181, v181
    v_cvt_pk_bf16_f32 v177, v178, v179
    v_exp_f32 v182, v182
    ds_read_b128 a[56:59], v7 offset:30720
    v_exp_f32 v183, v183
    v_cvt_pk_bf16_f32 v178, v180, v181
    s_waitcnt lgkmcnt(6)
    v_mfma_f32_32x32x16_bf16 v[208:223], a[28:31], v[60:63], v[208:223]
    v_exp_f32 v184, v184
    v_exp_f32 v185, v185
    v_cvt_pk_bf16_f32 v179, v182, v183
    v_exp_f32 v186, v186
    v_exp_f32 v187, v187
    v_cvt_pk_bf16_f32 v180, v184, v185
    s_waitcnt lgkmcnt(9)
    v_mfma_f32_32x32x16_bf16 v[40:55], a[36:39], v[164:167], v[40:55]
    v_exp_f32 v188, v188
    v_exp_f32 v189, v189
    v_cvt_pk_bf16_f32 v181, v186, v187
    v_exp_f32 v190, v190
    ds_read_b128 a[60:63], v7 offset:31744
    v_exp_f32 v191, v191
    v_cvt_pk_bf16_f32 v182, v188, v189
    s_nop 0
    v_cvt_pk_bf16_f32 v183, v190, v191
    buffer_store_dwordx4 a[252:255], v8, s[16:19], s80 offen sc1
    s_bitset1_b32 s80, 13
    s_waitcnt lgkmcnt(5)
    v_mfma_f32_32x32x16_bf16 v[224:239], a[0:3], v[56:59], v[224:239]
    v_exp_f32 v192, v192
    v_exp_f32 v193, v193
    v_exp_f32 v194, v194
    v_exp_f32 v195, v195
    v_cvt_pk_bf16_f32 v192, v192, v193
    s_waitcnt lgkmcnt(8)
    v_mfma_f32_32x32x16_bf16 v[40:55], a[40:43], v[176:179], v[40:55]
    v_exp_f32 v196, v196
    v_exp_f32 v197, v197
    v_cvt_pk_bf16_f32 v193, v194, v195
    v_exp_f32 v198, v198
    ds_read_b128 a[32:35], v7 offset:34816
    v_exp_f32 v199, v199
    v_cvt_pk_bf16_f32 v194, v196, v197
    s_waitcnt lgkmcnt(4)
    v_mfma_f32_32x32x16_bf16 v[224:239], a[4:7], v[60:63], v[224:239]
    v_exp_f32 v200, v200
    v_exp_f32 v201, v201
    v_cvt_pk_bf16_f32 v195, v198, v199
    v_exp_f32 v202, v202
    v_exp_f32 v203, v203
    v_cvt_pk_bf16_f32 v196, v200, v201
    s_waitcnt lgkmcnt(7)
    v_mfma_f32_32x32x16_bf16 v[40:55], a[44:47], v[180:183], v[40:55]
    v_exp_f32 v204, v204
    v_exp_f32 v205, v205
    v_cvt_pk_bf16_f32 v197, v202, v203
    v_exp_f32 v206, v206
    ds_read_b128 a[36:39], v7 offset:35840
    v_exp_f32 v207, v207
    v_cvt_pk_bf16_f32 v198, v204, v205
    s_nop 0
    v_cvt_pk_bf16_f32 v199, v206, v207
    buffer_store_dwordx4 a[252:255], v8, s[16:19], s80 offen sc1
    s_bitset0_b32 s80, 13
    s_bitset0_b32 s80, 16
    v_exp_f32 v208, v208
    v_exp_f32 v209, v209
    v_exp_f32 v210, v210
    v_exp_f32 v211, v211
    v_cvt_pk_bf16_f32 v208, v208, v209
    s_waitcnt lgkmcnt(6)
    v_mfma_f32_32x32x16_bf16 v[40:55], a[48:51], v[192:195], v[40:55]
    v_exp_f32 v212, v212
    v_exp_f32 v213, v213
    v_cvt_pk_bf16_f32 v209, v210, v211
    v_exp_f32 v214, v214
    v_exp_f32 v215, v215
    v_cvt_pk_bf16_f32 v210, v212, v213
    v_exp_f32 v216, v216
    v_exp_f32 v217, v217
    v_cvt_pk_bf16_f32 v211, v214, v215
    v_exp_f32 v218, v218
    v_exp_f32 v219, v219
    v_cvt_pk_bf16_f32 v212, v216, v217
    s_waitcnt lgkmcnt(4)
    v_mfma_f32_32x32x16_bf16 v[40:55], a[52:55], v[196:199], v[40:55]
    v_exp_f32 v220, v220
    v_exp_f32 v221, v221
    v_cvt_pk_bf16_f32 v213, v218, v219
    v_exp_f32 v222, v222
    v_exp_f32 v223, v223
    v_cvt_pk_bf16_f32 v214, v220, v221
    s_nop 0
    v_cvt_pk_bf16_f32 v215, v222, v223
    buffer_load_dwordx4 v[28:31], v5, s[16:19], s51 offen offset:0 sc1
    v_exp_f32 v224, v224
    v_exp_f32 v225, v225
    v_exp_f32 v226, v226
    v_exp_f32 v227, v227
    v_cvt_pk_bf16_f32 v224, v224, v225
    s_waitcnt lgkmcnt(3)
    v_mfma_f32_32x32x16_bf16 v[40:55], a[56:59], v[208:211], v[40:55]
    v_exp_f32 v228, v228
    v_exp_f32 v229, v229
    v_cvt_pk_bf16_f32 v225, v226, v227
    v_exp_f32 v230, v230
    v_exp_f32 v231, v231
    v_cvt_pk_bf16_f32 v226, v228, v229
    v_exp_f32 v232, v232
    v_exp_f32 v233, v233
    v_cvt_pk_bf16_f32 v227, v230, v231
    v_exp_f32 v234, v234
    v_exp_f32 v235, v235
    v_cvt_pk_bf16_f32 v228, v232, v233
    s_waitcnt lgkmcnt(2)
    v_mfma_f32_32x32x16_bf16 v[40:55], a[60:63], v[212:215], v[40:55]
    v_exp_f32 v236, v236
    v_exp_f32 v237, v237
    v_cvt_pk_bf16_f32 v229, v234, v235
    v_exp_f32 v238, v238
    v_exp_f32 v239, v239
    v_cvt_pk_bf16_f32 v230, v236, v237
    s_nop 0
    v_cvt_pk_bf16_f32 v231, v238, v239
    s_nop 0
    s_waitcnt lgkmcnt(1)
    v_mfma_f32_32x32x16_bf16 v[40:55], a[32:35], v[224:227], v[40:55]
    s_waitcnt lgkmcnt(0)
    v_mfma_f32_32x32x16_bf16 v[40:55], a[36:39], v[228:231], v[40:55]
    s_nop 13
k2_norm:
    v_mov_b32 v20, v52
    v_mov_b32 v21, v52
    s_nop 1
    v_permlane32_swap_b32 v20, v21
    s_nop 1
    v_subrev_u32 v20, 0x21800000, v21
    v_rcp_f32 v21, v21
    v_cmp_lt_u32 vcc, 0x50000000, v20
    s_nop 4
    s_cbranch_vccnz k2_slow
k2_ok:
    v_mul_f32 v40, v40, v21
    v_mul_f32 v41, v41, v21
    v_mul_f32 v42, v42, v21
    v_mul_f32 v43, v43, v21
    v_mul_f32 v44, v44, v21
    v_mul_f32 v45, v45, v21
    v_mul_f32 v46, v46, v21
    v_mul_f32 v47, v47, v21
    v_mul_f32 v48, v48, v21
    v_mul_f32 v49, v49, v21
    v_mul_f32 v50, v50, v21
    v_mul_f32 v51, v51, v21
    v_mul_f32 v52, v52, v21
    v_mul_f32 v53, v53, v21
    v_mul_f32 v54, v54, v21
    v_mul_f32 v55, v55, v21
    v_cvt_pk_bf16_f32 v40, v40, v41
    v_cvt_pk_bf16_f32 v41, v42, v43
    v_cvt_pk_bf16_f32 v42, v44, v45
    v_cvt_pk_bf16_f32 v43, v46, v47
    v_cvt_pk_bf16_f32 v44, v48, v49
    v_cvt_pk_bf16_f32 v45, v50, v51
    v_cvt_pk_bf16_f32 v46, v52, v53
    v_cvt_pk_bf16_f32 v47, v54, v55
    buffer_store_dwordx4 v[40:43], v8, s[16:19], s54 offen sc1
    buffer_store_dwordx4 v[44:47], v8, s[16:19], s54 offen offset:512 sc1
    s_waitcnt vmcnt(2)
    v_subrev_u32 v28, s61, v28
    v_subrev_u32 v29, s61, v29
    v_subrev_u32 v30, s61, v30
    v_subrev_u32 v31, s61, v31
    v_max3_u32 v28, v28, v29, v30
    v_max_u32 v28, v28, v31
    v_cmp_gt_u32 vcc, 64, v28
    s_cmp_eq_u64 vcc, -1
    s_cbranch_scc0 slow_5
back_6:
    s_mov_b32 m0, s26
    s_nop 0
    buffer_load_dwordx4 v5, s[16:19], s22 offen offset:0 sc1 lds
    buffer_load_dwordx4 v5, s[16:19], s22 offen offset:1024 sc1 lds
    buffer_load_dwordx4 v5, s[16:19], s22 offen offset:2048 sc1 lds
    buffer_load_dwordx4 v5, s[16:19], s22 offen offset:3072 sc1 lds
    s_add_u32 s22, s22, 16384
    s_add_u32 s26, s26, 16384
    s_mov_b32 m0, s26
    s_nop 0
    buffer_load_dwordx4 v5, s[16:19], s22 offen offset:0 sc1 lds
    buffer_load_dwordx4 v5, s[16:19], s22 offen offset:1024 sc1 lds
    buffer_load_dwordx4 v5, s[16:19], s22 offen offset:2048 sc1 lds
    buffer_load_dwordx4 v5, s[16:19], s22 offen offset:3072 sc1 lds
    s_add_u32 s22, s22, 16384
    s_add_u32 s26, s26, 16384
    s_waitcnt vmcnt(31)
    ds_read_b64_tr_b16 a[64:65], v68 offset:0
    ds_read_b64_tr_b16 a[66:67], v68 offset:512
    ds_read_b64_tr_b16 a[68:69], v69 offset:0
    ds_read_b64_tr_b16 a[70:71], v69 offset:512
    ds_read_b64_tr_b16 a[72:73], v70 offset:0
    ds_read_b64_tr_b16 a[74:75], v70 offset:512
    ds_read_b64_tr_b16 a[76:77], v71 offset:0
    ds_read_b64_tr_b16 a[78:79], v71 offset:512
    s_waitcnt vmcnt(27)
    ds_read_b64_tr_b16 a[80:81], v68 offset:16384
    ds_read_b64_tr_b16 a[82:83], v68 offset:16896
    ds_read_b64_tr_b16 a[84:85], v69 offset:16384
    ds_read_b64_tr_b16 a[86:87], v69 offset:16896
    ds_read_b64_tr_b16 a[88:89], v70 offset:16384
    ds_read_b64_tr_b16 a[90:91], v70 offset:16896
    ds_read_b64_tr_b16 a[92:93], v71 offset:16384
    ds_read_b64_tr_b16 a[94:95], v71 offset:16896
    s_waitcnt vmcnt(21)
    ds_read_b64_tr_b16 a[96:97], v68 offset:32768
    ds_read_b64_tr_b16 a[98:99], v68 offset:33280
    ds_read_b64_tr_b16 a[100:101], v69 offset:32768
    ds_read_b64_tr_b16 a[102:103], v69 offset:33280
    ds_read_b64_tr_b16 a[104:105], v70 offset:32768
    ds_read_b64_tr_b16 a[106:107], v70 offset:33280
    ds_read_b64_tr_b16 a[108:109], v71 offset:32768
    ds_read_b64_tr_b16 a[110:111], v71 offset:33280
    s_waitcnt vmcnt(14)
    ds_read_b64_tr_b16 a[112:113], v68 offset:49152
    ds_read_b64_tr_b16 a[114:115], v68 offset:49664
    ds_read_b64_tr_b16 a[116:117], v69 offset:49152
    ds_read_b64_tr_b16 a[118:119], v69 offset:49664
    ds_read_b64_tr_b16 a[120:121], v70 offset:49152
    ds_read_b64_tr_b16 a[122:123], v70 offset:49664
    ds_read_b64_tr_b16 a[124:125], v71 offset:49152
    ds_read_b64_tr_b16 a[126:127], v71 offset:49664
    s_waitcnt lgkmcnt(15)
    s_mov_b32 m0, s26
    s_nop 0
    buffer_load_dwordx4 v5, s[16:19], s22 offen offset:0 sc1 lds
    buffer_load_dwordx4 v5, s[16:19], s22 offen offset:1024 sc1 lds
    buffer_load_dwordx4 v5, s[16:19], s22 offen offset:2048 sc1 lds
    buffer_load_dwordx4 v5, s[16:19], s22 offen offset:3072 sc1 lds
    s_add_u32 s22, s22, 16384
    s_add_u32 s26, s26, 16384
    s_waitcnt lgkmcnt(15)
    s_mov_b32 m0, s26
    s_nop 0
    buffer_load_dwordx4 v5, s[16:19], s22 offen offset:0 sc1 lds
    buffer_load_dwordx4 v5, s[16:19], s22 offen offset:1024 sc1 lds
    buffer_load_dwordx4 v5, s[16:19], s22 offen offset:2048 sc1 lds
    buffer_load_dwordx4 v5, s[16:19], s22 offen offset:3072 sc1 lds
    s_add_u32 s22, s22, 16384
    s_add_u32 s26, s26, 16384
    s_waitcnt lgkmcnt(8)
    s_mov_b32 m0, s26
    s_nop 0
    buffer_load_dwordx4 v5, s[16:19], s22 offen offset:0 sc1 lds
    buffer_load_dwordx4 v5, s[16:19], s22 offen offset:1024 sc1 lds
    buffer_load_dwordx4 v5, s[16:19], s22 offen offset:2048 sc1 lds
    buffer_load_dwordx4 v5, s[16:19], s22 offen offset:3072 sc1 lds
    s_add_u32 s22, s22, 16384
    s_add_u32 s26, s26, 16384
    s_waitcnt lgkmcnt(0)
    s_mov_b32 m0, s26
    s_nop 0
    buffer_load_dwordx4 v5, s[16:19], s22 offen offset:0 sc1 lds
    buffer_load_dwordx4 v5, s[16:19], s22 offen offset:1024 sc1 lds
    buffer_load_dwordx4 v5, s[16:19], s22 offen offset:2048 sc1 lds
    buffer_load_dwordx4 v5, s[16:19], s22 offen offset:3072 sc1 lds
    s_add_u32 s22, s22, 16384
    s_add_u32 s26, s26, 16384
    s_waitcnt vmcnt(32)
    v_subrev_u32 v1, s61, v1
    v_cmp_gt_u32 vcc, 64, v1
    s_and_b64 s[42:43], vcc, s[62:63]
    s_cmp_eq_u64 s[42:43], s[62:63]
    s_cbranch_scc0 slow_7
back_8:
    s_cmp_eq_u32 s8, 7
    s_cbranch_scc1 k3_aug
    s_mov_b32 s12, s4
    s_and_b32 s13, s5, 0xffff
    s_mov_b32 s14, 0x1c0000
    s_mov_b32 s15, 0x00020000
    s_lshl_b32 s36, s9, 6
    s_lshl_b32 s27, s3, 4
    s_add_u32 s36, s36, s27
    v_add_u32 v6, s36, v3
    v_mul_u32_u24 v6, 896, v6
    v_lshlrev_b32 v7, 4, v4
    s_lshl_b32 s28, s8, 7
    v_add3_u32 v6, v6, v7, s28
    v_lshlrev_b32 v37, 5, v4
    s_lshl_b32 s30, s8, 8
    s_add_u32 s30, s30, 3584
    buffer_load_dwordx4 v[16:19], v6, s[12:15], 0 offen
    buffer_load_dwordx4 v[20:23], v6, s[12:15], 0 offen offset:64
    buffer_load_dwordx4 v[240:243], v37, s[16:19], s30 offen offset:0 sc1
    buffer_load_dwordx4 v[244:247], v37, s[16:19], s30 offen offset:16 sc1
    buffer_load_dwordx4 v[248:251], v37, s[16:19], s30 offen offset:128 sc1
    buffer_load_dwordx4 v[252:255], v37, s[16:19], s30 offen offset:144 sc1
    buffer_load_dwordx4 v[144:147], v37, s[16:19], s30 offen offset:3584 sc1
    buffer_load_dwordx4 v[148:151], v37, s[16:19], s30 offen offset:3600 sc1
    buffer_load_dwordx4 v[152:155], v37, s[16:19], s30 offen offset:3712 sc1
    buffer_load_dwordx4 v[156:159], v37, s[16:19], s30 offen offset:3728 sc1
    s_add_u32 s30, s30, 5376
    s_lshl_b32 s29, s9, 1
    s_lshr_b32 s27, s3, 1
    s_add_u32 s29, s29, s27
    s_mul_i32 s29, s29, 28672
    s_lshl_b32 s27, s8, 12
    s_add_u32 s29, s29, s27
    s_and_b32 s27, s3, 1
    s_lshl_b32 s27, s27, 8
    s_add_u32 s29, s29, s27
    s_add_u32 s29, s29, 0x2000000
    v_lshlrev_b32 v10, 9, v4
    v_lshl_add_u32 v10, v3, 4, v10
    s_mul_i32 s21, s32, 12288
    s_add_u32 s21, s21, 114688
    v_add_u32 v112, s21, v5
    s_mul_i32 s21, s33, 12288
    s_add_u32 s21, s21, 114688
    v_add_u32 v113, s21, v5
    s_mul_i32 s21, s34, 12288
    s_add_u32 s21, s21, 118784
    v_add_u32 v114, s21, v5
    s_mul_i32 s21, s35, 12288
    s_add_u32 s21, s21, 122880
    v_add_u32 v115, s21, v5
    buffer_load_dwordx4 v[52:55], v13, s[16:19], s20 offen sc1
    buffer_load_dwordx4 v[56:59], v14, s[16:19], s20 offen sc1
    buffer_load_dwordx4 v[60:63], v15, s[16:19], s20 offen sc1
    buffer_load_dwordx4 v[48:51], v12, s[16:19], s20 offen sc1
    s_add_u32 s20, s20, 4096
    buffer_load_dwordx4 v[76:79], v13, s[16:19], s20 offen sc1
    buffer_load_dwordx4 v[80:83], v14, s[16:19], s20 offen sc1
    buffer_load_dwordx4 v[84:87], v15, s[16:19], s20 offen sc1
    buffer_load_dwordx4 v[72:75], v12, s[16:19], s20 offen sc1
    s_add_u32 s20, s20, 4096
    buffer_load_dwordx4 v[92:95], v13, s[16:19], s20 offen sc1
    buffer_load_dwordx4 v[96:99], v14, s[16:19], s20 offen sc1
    buffer_load_dwordx4 v[100:103], v15, s[16:19], s20 offen sc1
    buffer_load_dwordx4 v[88:91], v12, s[16:19], s20 offen sc1
    s_add_u32 s20, s20, 4096
    buffer_load_dwordx4 v[164:167], v13, s[16:19], s20 offen sc1
    buffer_load_dwordx4 v[168:171], v14, s[16:19], s20 offen sc1
    buffer_load_dwordx4 v[172:175], v15, s[16:19], s20 offen sc1
    buffer_load_dwordx4 v[160:163], v12, s[16:19], s20 offen sc1
    s_mov_b32 m0, s26
    s_nop 0
    buffer_load_dwordx4 v5, s[16:19], s22 offen offset:0 sc1 lds
    buffer_load_dwordx4 v5, s[16:19], s22 offen offset:1024 sc1 lds
    buffer_load_dwordx4 v5, s[16:19], s22 offen offset:2048 sc1 lds
    buffer_load_dwordx4 v5, s[16:19], s22 offen offset:3072 sc1 lds
    s_add_u32 s22, s22, 16384
    s_add_u32 s26, s26, 16384
    s_waitcnt vmcnt(16)
    v_max3_u32 v1, v48, v52, v56
    v_max_u32 v1, v1, v60
    v_cmp_eq_u32 vcc, -1, v1
    s_nop 1
    s_cbranch_vccnz ot_9
ob_10:
    s_waitcnt lgkmcnt(15)
    v_mfma_f32_16x16x32_bf16 v[192:195], a[64:67], v[52:55], 0
    s_waitcnt lgkmcnt(15)
    v_mfma_f32_16x16x32_bf16 v[196:199], a[68:71], v[52:55], 0
    s_waitcnt lgkmcnt(15)
    v_mfma_f32_16x16x32_bf16 v[200:203], a[72:75], v[52:55], 0
    s_waitcnt lgkmcnt(15)
    v_mfma_f32_16x16x32_bf16 v[204:207], a[76:79], v[52:55], 0
    buffer_load_dwordx4 a[128:131], v5, s[16:19], s41 offen offset:0 sc1
    v_mfma_f32_16x16x32_bf16 v[208:211], a[64:67], v[56:59], 0
    v_mfma_f32_16x16x32_bf16 v[212:215], a[68:71], v[56:59], 0
    v_mfma_f32_16x16x32_bf16 v[216:219], a[72:75], v[56:59], 0
    v_mfma_f32_16x16x32_bf16 v[220:223], a[76:79], v[56:59], 0
    buffer_load_dwordx4 a[132:135], v5, s[16:19], s41 offen offset:1024 sc1
    v_mfma_f32_16x16x32_bf16 v[224:227], a[64:67], v[60:63], 0
    v_mfma_f32_16x16x32_bf16 v[228:231], a[68:71], v[60:63], 0
    v_mfma_f32_16x16x32_bf16 v[232:235], a[72:75], v[60:63], 0
    v_mfma_f32_16x16x32_bf16 v[236:239], a[76:79], v[60:63], 0
    s_waitcnt vmcnt(14)
    v_max3_u32 v1, v72, v76, v80
    buffer_load_dwordx4 a[136:139], v5, s[16:19], s41 offen offset:2048 sc1
    v_mfma_f32_16x16x32_bf16 v[176:179], a[64:67], v[48:51], 0
    v_max_u32 v1, v1, v84
    v_mfma_f32_16x16x32_bf16 v[180:183], a[68:71], v[48:51], 0
    v_cmp_eq_u32 vcc, -1, v1
    v_mfma_f32_16x16x32_bf16 v[184:187], a[72:75], v[48:51], 0
    v_mfma_f32_16x16x32_bf16 v[188:191], a[76:79], v[48:51], 0
    s_cbranch_vccnz ot_11
ob_12:
    buffer_load_dwordx4 a[140:143], v5, s[16:19], s41 offen offset:3072 sc1
    s_add_u32 s41, s41, 16384
    s_waitcnt lgkmcnt(15)
    v_mfma_f32_16x16x32_bf16 v[192:195], a[80:83], v[76:79], v[192:195]
    s_waitcnt lgkmcnt(15)
    v_mfma_f32_16x16x32_bf16 v[196:199], a[84:87], v[76:79], v[196:199]
    s_waitcnt lgkmcnt(15)
    v_mfma_f32_16x16x32_bf16 v[200:203], a[88:91], v[76:79], v[200:203]
    s_waitcnt lgkmcnt(15)
    v_mfma_f32_16x16x32_bf16 v[204:207], a[92:95], v[76:79], v[204:207]
    buffer_load_dwordx4 a[144:147], v5, s[16:19], s41 offen offset:0 sc1
    v_mfma_f32_16x16x32_bf16 v[208:211], a[80:83], v[80:83], v[208:211]
    v_mfma_f32_16x16x32_bf16 v[212:215], a[84:87], v[80:83], v[212:215]
    v_mfma_f32_16x16x32_bf16 v[216:219], a[88:91], v[80:83], v[216:219]
    v_mfma_f32_16x16x32_bf16 v[220:223], a[92:95], v[80:83], v[220:223]
    buffer_load_dwordx4 a[148:151], v5, s[16:19], s41 offen offset:1024 sc1
    v_mfma_f32_16x16x32_bf16 v[224:227], a[80:83], v[84:87], v[224:227]
    v_mfma_f32_16x16x32_bf16 v[228:231], a[84:87], v[84:87], v[228:231]
    v_mfma_f32_16x16x32_bf16 v[232:235], a[88:91], v[84:87], v[232:235]
    v_mfma_f32_16x16x32_bf16 v[236:239], a[92:95], v[84:87], v[236:239]
    s_waitcnt vmcnt(14)
    v_max3_u32 v1, v88, v92, v96
    buffer_load_dwordx4 a[152:155], v5, s[16:19], s41 offen offset:2048 sc1
    v_mfma_f32_16x16x32_bf16 v[176:179], a[80:83], v[72:75], v[176:179]
    v_max_u32 v1, v1, v100
    v_mfma_f32_16x16x32_bf16 v[180:183], a[84:87], v[72:75], v[180:183]
    v_cmp_eq_u32 vcc, -1, v1
    v_mfma_f32_16x16x32_bf16 v[184:187], a[88:91], v[72:75], v[184:187]
    v_mfma_f32_16x16x32_bf16 v[188:191], a[92:95], v[72:75], v[188:191]
    s_cbranch_vccnz ot_13
ob_14:
    buffer_load_dwordx4 a[156:159], v5, s[16:19], s41 offen offset:3072 sc1
    s_add_u32 s41, s41, 16384
    s_waitcnt lgkmcnt(14)
    v_mfma_f32_16x16x32_bf16 v[192:195], a[96:99], v[92:95], v[192:195]
    s_waitcnt lgkmcnt(12)
    v_mfma_f32_16x16x32_bf16 v[196:199], a[100:103], v[92:95], v[196:199]
    s_waitcnt lgkmcnt(10)
    v_mfma_f32_16x16x32_bf16 v[200:203], a[104:107], v[92:95], v[200:203]
    s_waitcnt lgkmcnt(8)
    v_mfma_f32_16x16x32_bf16 v[204:207], a[108:111], v[92:95], v[204:207]
    buffer_load_dwordx4 a[160:163], v5, s[16:19], s41 offen offset:0 sc1
    v_mfma_f32_16x16x32_bf16 v[208:211], a[96:99], v[96:99], v[208:211]
    v_mfma_f32_16x16x32_bf16 v[212:215], a[100:103], v[96:99], v[212:215]
    v_mfma_f32_16x16x32_bf16 v[216:219], a[104:107], v[96:99], v[216:219]
    v_mfma_f32_16x16x32_bf16 v[220:223], a[108:111], v[96:99], v[220:223]
    buffer_load_dwordx4 a[164:167], v5, s[16:19], s41 offen offset:1024 sc1
    v_mfma_f32_16x16x32_bf16 v[224:227], a[96:99], v[100:103], v[224:227]
    v_mfma_f32_16x16x32_bf16 v[228:231], a[100:103], v[100:103], v[228:231]
    v_mfma_f32_16x16x32_bf16 v[232:235], a[104:107], v[100:103], v[232:235]
    v_mfma_f32_16x16x32_bf16 v[236:239], a[108:111], v[100:103], v[236:239]
    s_waitcnt vmcnt(14)
    v_max3_u32 v1, v160, v164, v168
    buffer_load_dwordx4 a[168:171], v5, s[16:19], s41 offen offset:2048 sc1
    v_mfma_f32_16x16x32_bf16 v[176:179], a[96:99], v[88:91], v[176:179]
    v_max_u32 v1, v1, v172
    v_mfma_f32_16x16x32_bf16 v[180:183], a[100:103], v[88:91], v[180:183]
    v_cmp_eq_u32 vcc, -1, v1
    v_mfma_f32_16x16x32_bf16 v[184:187], a[104:107], v[88:91], v[184:187]
    v_mfma_f32_16x16x32_bf16 v[188:191], a[108:111], v[88:91], v[188:191]
    s_cbranch_vccnz ot_15
ob_16:
    buffer_load_dwordx4 a[172:175], v5, s[16:19], s41 offen offset:3072 sc1
    s_add_u32 s41, s41, 16384
    s_waitcnt vmcnt(32)
    v_lshlrev_b32 v128, 16, v16
    v_and_b32 v129, 0xffff0000, v16
    v_lshlrev_b32 v130, 16, v17
    v_and_b32 v131, 0xffff0000, v17
    v_lshlrev_b32 v132, 16, v18
    v_and_b32 v133, 0xffff0000, v18
    v_lshlrev_b32 v134, 16, v19
    v_and_b32 v135, 0xffff0000, v19
    v_lshlrev_b32 v136, 16, v20
    v_and_b32 v137, 0xffff0000, v20
    v_lshlrev_b32 v138, 16, v21
    v_and_b32 v139, 0xffff0000, v21
    v_lshlrev_b32 v140, 16, v22
    v_and_b32 v141, 0xffff0000, v22
    v_lshlrev_b32 v142, 16, v23
    v_and_b32 v143, 0xffff0000, v23
    s_barrier
    s_waitcnt lgkmcnt(6)
    v_mfma_f32_16x16x32_bf16 v[192:195], a[112:115], v[164:167], v[192:195]
    s_waitcnt lgkmcnt(4)
    v_mfma_f32_16x16x32_bf16 v[196:199], a[116:119], v[164:167], v[196:199]
    s_waitcnt lgkmcnt(2)
    v_mfma_f32_16x16x32_bf16 v[200:203], a[120:123], v[164:167], v[200:203]
    s_waitcnt lgkmcnt(0)
    v_mfma_f32_16x16x32_bf16 v[204:207], a[124:127], v[164:167], v[204:207]
    buffer_load_dwordx4 a[176:179], v5, s[16:19], s41 offen offset:0 sc1
    v_mfma_f32_16x16x32_bf16 v[208:211], a[112:115], v[168:171], v[208:211]
    v_mfma_f32_16x16x32_bf16 v[212:215], a[116:119], v[168:171], v[212:215]
    v_mfma_f32_16x16x32_bf16 v[216:219], a[120:123], v[168:171], v[216:219]
    ds_write_b128 v113, v[192:195] offset:0
    ds_write_b128 v113, v[196:199] offset:1024
    v_mfma_f32_16x16x32_bf16 v[220:223], a[124:127], v[168:171], v[220:223]
    buffer_load_dwordx4 a[180:183], v5, s[16:19], s41 offen offset:1024 sc1
    ds_write_b128 v113, v[200:203] offset:2048
    ds_write_b128 v113, v[204:207] offset:3072
    v_mfma_f32_16x16x32_bf16 v[224:227], a[112:115], v[172:175], v[224:227]
    v_mfma_f32_16x16x32_bf16 v[228:231], a[116:119], v[172:175], v[228:231]
    v_mfma_f32_16x16x32_bf16 v[232:235], a[120:123], v[172:175], v[232:235]
    ds_write_b128 v114, v[208:211] offset:0
    ds_write_b128 v114, v[212:215] offset:1024
    v_mfma_f32_16x16x32_bf16 v[236:239], a[124:127], v[172:175], v[236:239]
    buffer_load_dwordx4 a[184:187], v5, s[16:19], s41 offen offset:2048 sc1
    ds_write_b128 v114, v[216:219] offset:2048
    ds_write_b128 v114, v[220:223] offset:3072
    v_mfma_f32_16x16x32_bf16 v[176:179], a[112:115], v[160:163], v[176:179]
    v_mfma_f32_16x16x32_bf16 v[180:183], a[116:119], v[160:163], v[180:183]
    v_mfma_f32_16x16x32_bf16 v[184:187], a[120:123], v[160:163], v[184:187]
    ds_write_b128 v115, v[224:227] offset:0
    ds_write_b128 v115, v[228:231] offset:1024
    v_mfma_f32_16x16x32_bf16 v[188:191], a[124:127], v[160:163], v[188:191]
    buffer_load_dwordx4 a[188:191], v5, s[16:19], s41 offen offset:3072 sc1
    s_add_u32 s41, s41, 16384
    ds_write_b128 v115, v[232:235] offset:2048
    ds_write_b128 v115, v[236:239] offset:3072
    s_waitcnt lgkmcnt(0)
    s_barrier
    ds_read_b128 v[64:67], v112 offset:0
    ds_read_b128 v[80:83], v112 offset:4096
    ds_read_b128 v[96:99], v112 offset:8192
    ds_read_b128 v[68:71], v112 offset:1024
    ds_read_b128 v[84:87], v112 offset:5120
    ds_read_b128 v[100:103], v112 offset:9216
    ds_read_b128 v[72:75], v112 offset:2048
    ds_read_b128 v[88:91], v112 offset:6144
    ds_read_b128 v[104:107], v112 offset:10240
    ds_read_b128 v[76:79], v112 offset:3072
    ds_read_b128 v[92:95], v112 offset:7168
    ds_read_b128 v[108:111], v112 offset:11264
    s_waitcnt lgkmcnt(9)
    v_pk_add_f32 v[64:65], v[64:65], v[80:81]
    v_pk_add_f32 v[176:177], v[176:177], v[96:97]
    v_pk_add_f32 v[66:67], v[66:67], v[82:83]
    v_pk_add_f32 v[178:179], v[178:179], v[98:99]
    v_pk_add_f32 v[176:177], v[176:177], v[64:65]
    v_pk_add_f32 v[178:179], v[178:179], v[66:67]
    s_waitcnt lgkmcnt(6)
    v_pk_add_f32 v[68:69], v[68:69], v[84:85]
    v_pk_add_f32 v[180:181], v[180:181], v[100:101]
    v_pk_add_f32 v[70:71], v[70:71], v[86:87]
    v_pk_add_f32 v[182:183], v[182:183], v[102:103]
    v_pk_add_f32 v[180:181], v[180:181], v[68:69]
    v_pk_add_f32 v[182:183], v[182:183], v[70:71]
    s_waitcnt lgkmcnt(3)
    v_pk_add_f32 v[72:73], v[72:73], v[88:89]
    v_pk_add_f32 v[184:185], v[184:185], v[104:105]
    v_pk_add_f32 v[74:75], v[74:75], v[90:91]
    v_pk_add_f32 v[186:187], v[186:187], v[106:107]
    v_pk_add_f32 v[184:185], v[184:185], v[72:73]
    v_pk_add_f32 v[186:187], v[186:187], v[74:75]
    s_waitcnt lgkmcnt(0)
    v_pk_add_f32 v[76:77], v[76:77], v[92:93]
    v_pk_add_f32 v[188:189], v[188:189], v[108:109]
    v_pk_add_f32 v[78:79], v[78:79], v[94:95]
    v_pk_add_f32 v[190:191], v[190:191], v[110:111]
    v_pk_add_f32 v[188:189], v[188:189], v[76:77]
    v_pk_add_f32 v[190:191], v[190:191], v[78:79]
    s_waitcnt vmcnt(36)
    v_pk_fma_f32 v[128:129], v[176:177], v[240:241], v[128:129]
    v_pk_fma_f32 v[130:131], v[178:179], v[242:243], v[130:131]
    v_pk_fma_f32 v[132:133], v[180:181], v[244:245], v[132:133]
    v_pk_fma_f32 v[134:135], v[182:183], v[246:247], v[134:135]
    v_pk_fma_f32 v[136:137], v[184:185], v[248:249], v[136:137]
    v_pk_fma_f32 v[138:139], v[186:187], v[250:251], v[138:139]
    v_pk_fma_f32 v[140:141], v[188:189], v[252:253], v[140:141]
    v_pk_fma_f32 v[142:143], v[190:191], v[254:255], v[142:143]
    v_cvt_pk_bf16_f32 v120, v128, v129
    v_cvt_pk_bf16_f32 v121, v130, v131
    v_cvt_pk_bf16_f32 v122, v132, v133
    v_cvt_pk_bf16_f32 v123, v134, v135
    v_cvt_pk_bf16_f32 v124, v136, v137
    v_cvt_pk_bf16_f32 v125, v138, v139
    v_cvt_pk_bf16_f32 v126, v140, v141
    v_cvt_pk_bf16_f32 v127, v142, v143
    v_lshlrev_b32 v160, 16, v120
    v_and_b32 v161, 0xffff0000, v120
    v_lshlrev_b32 v162, 16, v121
    v_and_b32 v163, 0xffff0000, v121
    v_lshlrev_b32 v164, 16, v122
    v_and_b32 v165, 0xffff0000, v122
    v_lshlrev_b32 v166, 16, v123
    v_and_b32 v167, 0xffff0000, v123
    v_lshlrev_b32 v168, 16, v124
    v_and_b32 v169, 0xffff0000, v124
    v_lshlrev_b32 v170, 16, v125
    v_and_b32 v171, 0xffff0000, v125
    v_lshlrev_b32 v172, 16, v126
    v_and_b32 v173, 0xffff0000, v126
    v_lshlrev_b32 v174, 16, v127
    v_and_b32 v175, 0xffff0000, v127
    v_pk_mul_f32 v[160:161], v[160:161], v[144:145]
    v_pk_mul_f32 v[162:163], v[162:163], v[146:147]
    v_pk_mul_f32 v[164:165], v[164:165], v[148:149]
    v_pk_mul_f32 v[166:167], v[166:167], v[150:151]
    v_pk_mul_f32 v[168:169], v[168:169], v[152:153]
    v_pk_mul_f32 v[170:171], v[170:171], v[154:155]
    v_pk_mul_f32 v[172:173], v[172:173], v[156:157]
    v_pk_mul_f32 v[174:175], v[174:175], v[158:159]
    v_cvt_pk_bf16_f32 v56, v160, v161
    v_cvt_pk_bf16_f32 v57, v162, v163
    v_cvt_pk_bf16_f32 v58, v164, v165
    v_cvt_pk_bf16_f32 v59, v166, v167
    v_cvt_pk_bf16_f32 v60, v168, v169
    v_cvt_pk_bf16_f32 v61, v170, v171
    v_cvt_pk_bf16_f32 v62, v172, v173
    v_cvt_pk_bf16_f32 v63, v174, v175
    buffer_store_dwordx4 v[56:59], v10, s[16:19], s29 offen sc1
    buffer_store_dwordx4 v[60:63], v10, s[16:19], s29 offen offset:2048 sc1
    v_mov_b32 v40, 0x3f803f80
    v_mov_b32 v41, 0
    v_mov_b32 v42, 0
    v_mov_b32 v43, 0
    v_mov_b32 v44, 0
    s_nop 0
    v_dot2_f32_bf16 v41, v120, v40, v41
    v_dot2_f32_bf16 v43, v120, v120, v43
    v_dot2_f32_bf16 v42, v121, v40, v42
    v_dot2_f32_bf16 v44, v121, v121, v44
    v_dot2_f32_bf16 v41, v122, v40, v41
    v_dot2_f32_bf16 v43, v122, v122, v43
    v_dot2_f32_bf16 v42, v123, v40, v42
    v_dot2_f32_bf16 v44, v123, v123, v44
    v_dot2_f32_bf16 v41, v124, v40, v41
    v_dot2_f32_bf16 v43, v124, v124, v43
    v_dot2_f32_bf16 v42, v125, v40, v42
    v_dot2_f32_bf16 v44, v125, v125, v44
    v_dot2_f32_bf16 v41, v126, v40, v41
    v_dot2_f32_bf16 v43, v126, v126, v43
    v_dot2_f32_bf16 v42, v127, v40, v42
    v_dot2_f32_bf16 v44, v127, v127, v44
    s_lshl_b32 s27, s36, 6
    s_lshl_b32 s28, s8, 3
    s_add_u32 s27, s27, s28
    v_add_f32 v46, v41, v42
    v_add_f32 v47, v43, v44
    v_mov_b32 v41, v46
    v_mov_b32 v42, v47
    s_nop 1
    v_permlane16_swap_b32 v46, v41
    v_permlane16_swap_b32 v47, v42
    s_nop 1
    v_add_f32 v46, v46, v41
    v_add_f32 v47, v47, v42
    v_mov_b32 v41, v46
    v_mov_b32 v42, v47
    s_nop 1
    v_permlane32_swap_b32 v46, v41
    v_permlane32_swap_b32 v47, v42
    s_nop 1
    v_add_f32 v46, v46, v41
    v_add_f32 v47, v47, v42
    v_lshlrev_b32 v41, 6, v3
    s_add_u32 s27, s27, 0x1e00000
    s_mov_b64 exec, 0xffff
    buffer_store_dwordx2 v[46:47], v41, s[16:19], s27 offen sc1
    s_mov_b64 exec, -1
    buffer_load_dwordx4 a[192:195], v5, s[16:19], s41 offen offset:0 sc1
    buffer_load_dwordx4 a[196:199], v5, s[16:19], s41 offen offset:1024 sc1
    buffer_load_dwordx4 a[200:203], v5, s[16:19], s41 offen offset:2048 sc1
    buffer_load_dwordx4 a[204:207], v5, s[16:19], s41 offen offset:3072 sc1
    s_add_u32 s41, s41, 16384
    buffer_load_dwordx4 a[208:211], v5, s[16:19], s41 offen offset:0 sc1
    buffer_load_dwordx4 a[212:215], v5, s[16:19], s41 offen offset:1024 sc1
    buffer_load_dwordx4 a[216:219], v5, s[16:19], s41 offen offset:2048 sc1
    buffer_load_dwordx4 a[220:223], v5, s[16:19], s41 offen offset:3072 sc1
    s_add_u32 s41, s41, 16384
    s_waitcnt vmcnt(27)
    s_barrier
    s_waitcnt vmcnt(8)
    buffer_store_dword v39, v38, s[16:19], s60 offen offset:8 sc1
    s_branch k3_sig
k3_aug:
    s_lshl_b32 s20, s9, 2
    s_add_u32 s20, s20, s3
    s_mul_i32 s27, s20, 149797
    s_lshr_b32 s21, s27, 20
    s_mul_i32 s27, s21, 7
    s_sub_u32 s25, s20, s27
    s_mov_b32 s28, 3
    s_mov_b32 s29, 0
    s_cmp_ge_u32 s25, 3
    s_cselect_b32 s28, 1, s28
    s_cselect_b32 s29, 81, s29
    s_cmp_ge_u32 s25, 4
    s_cselect_b32 s28, 1, s28
    s_cselect_b32 s29, 108, s29
    s_cmp_ge_u32 s25, 5
    s_cselect_b32 s28, 1, s28
    s_cselect_b32 s29, 135, s29
    s_cmp_ge_u32 s25, 6
    s_cselect_b32 s28, 1, s28
    s_cselect_b32 s29, 162, s29
    s_add_u32 s29, s29, s25
    s_lshl_b32 s28, s28, 10
    s_lshl_b32 s29, s29, 10
    s_mul_i32 s24, s21, 207872
    s_add_u32 s24, s24, 0x400000
    s_lshl_b32 s25, s25, 10
    s_add_u32 s25, s25, s24
    s_add_u32 s25, s25, 200704
    s_add_u32 s24, s24, s29
    s_cmp_lt_u32 s9, 28
    s_cselect_b32 s24, s24, 0x7f000000
    s_cselect_b32 s25, s25, 0x7f000000
    v_lshlrev_b32 v7, 4, v35
    v_add_u32 v8, 36352, v7
    v_add_u32 v9, 35456, v7
    v_mov_b32 v10, 0x7fffffff
    v_cmp_eq_u32 vcc, 0, v34
    s_nop 1
    v_cndmask_b32 v10, v10, v8, vcc
    v_cmp_eq_u32 vcc, 1, v34
    s_nop 1
    v_cndmask_b32 v10, v10, v9, vcc
    buffer_load_dwordx4 a[0:3], v5, s[16:19], s24 offen sc1
    s_add_u32 s24, s24, s28
    buffer_load_dwordx4 v[64:67], v10, s[16:19], 0 offen offset:0 sc1
    buffer_load_dwordx4 a[4:7], v5, s[16:19], s24 offen sc1
    s_add_u32 s24, s24, s28
    buffer_load_dwordx4 v[68:71], v10, s[16:19], 0 offen offset:32 sc1
    buffer_load_dwordx4 a[8:11], v5, s[16:19], s24 offen sc1
    s_add_u32 s24, s24, s28
    buffer_load_dwordx4 v[72:75], v10, s[16:19], 0 offen offset:64 sc1
    buffer_load_dwordx4 a[12:15], v5, s[16:19], s24 offen sc1
    s_add_u32 s24, s24, s28
    buffer_load_dwordx4 v[76:79], v10, s[16:19], 0 offen offset:96 sc1
    buffer_load_dwordx4 a[16:19], v5, s[16:19], s24 offen sc1
    s_add_u32 s24, s24, s28
    buffer_load_dwordx4 v[80:83], v10, s[16:19], 0 offen offset:128 sc1
    buffer_load_dwordx4 a[20:23], v5, s[16:19], s24 offen sc1
    s_add_u32 s24, s24, s28
    buffer_load_dwordx4 v[84:87], v10, s[16:19], 0 offen offset:160 sc1
    buffer_load_dwordx4 a[24:27], v5, s[16:19], s24 offen sc1
    s_add_u32 s24, s24, s28
    buffer_load_dwordx4 v[88:91], v10, s[16:19], 0 offen offset:192 sc1
    buffer_load_dwordx4 a[28:31], v5, s[16:19], s24 offen sc1
    s_add_u32 s24, s24, s28
    buffer_load_dwordx4 v[92:95], v10, s[16:19], 0 offen offset:224 sc1
    buffer_load_dwordx4 a[32:35], v5, s[16:19], s24 offen sc1
    s_add_u32 s24, s24, s28
    buffer_load_dwordx4 v[96:99], v10, s[16:19], 0 offen offset:256 sc1
    buffer_load_dwordx4 a[36:39], v5, s[16:19], s24 offen sc1
    s_add_u32 s24, s24, s28
    buffer_load_dwordx4 v[100:103], v10, s[16:19], 0 offen offset:288 sc1
    buffer_load_dwordx4 a[40:43], v5, s[16:19], s24 offen sc1
    s_add_u32 s24, s24, s28
    buffer_load_dwordx4 v[104:107], v10, s[16:19], 0 offen offset:320 sc1
    buffer_load_dwordx4 a[44:47], v5, s[16:19], s24 offen sc1
    s_add_u32 s24, s24, s28
    buffer_load_dwordx4 v[108:111], v10, s[16:19], 0 offen offset:352 sc1
    buffer_load_dwordx4 a[48:51], v5, s[16:19], s24 offen sc1
    s_add_u32 s24, s24, s28
    buffer_load_dwordx4 v[112:115], v10, s[16:19], 0 offen offset:384 sc1
    buffer_load_dwordx4 a[52:55], v5, s[16:19], s24 offen sc1
    s_add_u32 s24, s24, s28
    buffer_load_dwordx4 v[116:119], v10, s[16:19], 0 offen offset:416 sc1
    buffer_load_dwordx4 a[56:59], v5, s[16:19], s24 offen sc1
    s_add_u32 s24, s24, s28
    buffer_load_dwordx4 v[120:123], v10, s[16:19], 0 offen offset:448 sc1
    buffer_load_dwordx4 a[60:63], v5, s[16:19], s24 offen sc1
    s_add_u32 s24, s24, s28
    buffer_load_dwordx4 v[124:127], v10, s[16:19], 0 offen offset:480 sc1
    buffer_load_dwordx4 a[64:67], v5, s[16:19], s24 offen sc1
    s_add_u32 s24, s24, s28
    buffer_load_dwordx4 v[128:131], v10, s[16:19], 0 offen offset:512 sc1
    buffer_load_dwordx4 a[68:71], v5, s[16:19], s24 offen sc1
    s_add_u32 s24, s24, s28
    buffer_load_dwordx4 v[132:135], v10, s[16:19], 0 offen offset:544 sc1
    buffer_load_dwordx4 a[72:75], v5, s[16:19], s24 offen sc1
    s_add_u32 s24, s24, s28
    buffer_load_dwordx4 v[136:139], v10, s[16:19], 0 offen offset:576 sc1
    buffer_load_dwordx4 a[76:79], v5, s[16:19], s24 offen sc1
    s_add_u32 s24, s24, s28
    buffer_load_dwordx4 v[140:143], v10, s[16:19], 0 offen offset:608 sc1
    buffer_load_dwordx4 a[80:83], v5, s[16:19], s24 offen sc1
    s_add_u32 s24, s24, s28
    buffer_load_dwordx4 v[144:147], v10, s[16:19], 0 offen offset:640 sc1
    buffer_load_dwordx4 a[84:87], v5, s[16:19], s24 offen sc1
    s_add_u32 s24, s24, s28
    buffer_load_dwordx4 v[148:151], v10, s[16:19], 0 offen offset:672 sc1
    buffer_load_dwordx4 a[88:91], v5, s[16:19], s24 offen sc1
    s_add_u32 s24, s24, s28
    buffer_load_dwordx4 v[152:155], v10, s[16:19], 0 offen offset:704 sc1
    buffer_load_dwordx4 a[92:95], v5, s[16:19], s24 offen sc1
    s_add_u32 s24, s24, s28
    buffer_load_dwordx4 v[156:159], v10, s[16:19], 0 offen offset:736 sc1
    buffer_load_dwordx4 a[96:99], v5, s[16:19], s24 offen sc1
    s_add_u32 s24, s24, s28
    buffer_load_dwordx4 v[160:163], v10, s[16:19], 0 offen offset:768 sc1
    buffer_load_dwordx4 a[100:103], v5, s[16:19], s24 offen sc1
    s_add_u32 s24, s24, s28
    buffer_load_dwordx4 v[164:167], v10, s[16:19], 0 offen offset:800 sc1
    buffer_load_dwordx4 a[104:107], v5, s[16:19], s24 offen sc1
    s_add_u32 s24, s24, s28
    buffer_load_dwordx4 v[168:171], v10, s[16:19], 0 offen offset:832 sc1
    buffer_load_dwordx4 a[108:111], v5, s[16:19], s24 offen sc1
    s_add_u32 s24, s24, s28
    buffer_load_dwordx4 v[172:175], v10, s[16:19], 0 offen offset:864 sc1
    s_waitcnt vmcnt(54)
    v_mfma_f32_32x32x16_bf16 v[16:31], v[64:67], a[0:3], 0
    s_mov_b32 m0, s26
    s_nop 0
    buffer_load_dwordx4 v5, s[16:19], s22 offen offset:0 sc1 lds
    s_waitcnt vmcnt(53)
    v_mfma_f32_32x32x16_bf16 v[16:31], v[68:71], a[4:7], v[16:31]
    buffer_load_dwordx4 v5, s[16:19], s22 offen offset:1024 sc1 lds
    s_waitcnt vmcnt(52)
    v_mfma_f32_32x32x16_bf16 v[16:31], v[72:75], a[8:11], v[16:31]
    buffer_load_dwordx4 v5, s[16:19], s22 offen offset:2048 sc1 lds
    s_waitcnt vmcnt(51)
    v_mfma_f32_32x32x16_bf16 v[16:31], v[76:79], a[12:15], v[16:31]
    buffer_load_dwordx4 v5, s[16:19], s22 offen offset:3072 sc1 lds
    s_add_u32 s22, s22, 16384
    s_add_u32 s26, s26, 16384
    s_waitcnt vmcnt(50)
    v_mfma_f32_32x32x16_bf16 v[16:31], v[80:83], a[16:19], v[16:31]
    buffer_load_dwordx4 a[128:131], v5, s[16:19], s41 offen offset:0 sc1
    s_waitcnt vmcnt(49)
    v_mfma_f32_32x32x16_bf16 v[16:31], v[84:87], a[20:23], v[16:31]
    buffer_load_dwordx4 a[132:135], v5, s[16:19], s41 offen offset:1024 sc1
    s_waitcnt vmcnt(48)
    v_mfma_f32_32x32x16_bf16 v[16:31], v[88:91], a[24:27], v[16:31]
    buffer_load_dwordx4 a[136:139], v5, s[16:19], s41 offen offset:2048 sc1
    s_waitcnt vmcnt(47)
    v_mfma_f32_32x32x16_bf16 v[16:31], v[92:95], a[28:31], v[16:31]
    buffer_load_dwordx4 a[140:143], v5, s[16:19], s41 offen offset:3072 sc1
    s_add_u32 s41, s41, 16384
    s_waitcnt vmcnt(46)
    v_mfma_f32_32x32x16_bf16 v[16:31], v[96:99], a[32:35], v[16:31]
    buffer_load_dwordx4 a[144:147], v5, s[16:19], s41 offen offset:0 sc1
    s_waitcnt vmcnt(45)
    v_mfma_f32_32x32x16_bf16 v[16:31], v[100:103], a[36:39], v[16:31]
    buffer_load_dwordx4 a[148:151], v5, s[16:19], s41 offen offset:1024 sc1
    s_waitcnt vmcnt(44)
    v_mfma_f32_32x32x16_bf16 v[16:31], v[104:107], a[40:43], v[16:31]
    buffer_load_dwordx4 a[152:155], v5, s[16:19], s41 offen offset:2048 sc1
    s_waitcnt vmcnt(43)
    v_mfma_f32_32x32x16_bf16 v[16:31], v[108:111], a[44:47], v[16:31]
    buffer_load_dwordx4 a[156:159], v5, s[16:19], s41 offen offset:3072 sc1
    s_add_u32 s41, s41, 16384
    s_waitcnt vmcnt(42)
    v_mfma_f32_32x32x16_bf16 v[16:31], v[112:115], a[48:51], v[16:31]
    buffer_load_dwordx4 a[160:163], v5, s[16:19], s41 offen offset:0 sc1
    s_waitcnt vmcnt(41)
    v_mfma_f32_32x32x16_bf16 v[16:31], v[116:119], a[52:55], v[16:31]
    buffer_load_dwordx4 a[164:167], v5, s[16:19], s41 offen offset:1024 sc1
    s_waitcnt vmcnt(40)
    v_mfma_f32_32x32x16_bf16 v[16:31], v[120:123], a[56:59], v[16:31]
    buffer_load_dwordx4 a[168:171], v5, s[16:19], s41 offen offset:2048 sc1
    s_waitcnt vmcnt(39)
    v_mfma_f32_32x32x16_bf16 v[16:31], v[124:127], a[60:63], v[16:31]
    buffer_load_dwordx4 a[172:175], v5, s[16:19], s41 offen offset:3072 sc1
    s_add_u32 s41, s41, 16384
    s_waitcnt vmcnt(38)
    v_mfma_f32_32x32x16_bf16 v[16:31], v[128:131], a[64:67], v[16:31]
    buffer_load_dwordx4 a[176:179], v5, s[16:19], s41 offen offset:0 sc1
    s_waitcnt vmcnt(37)
    v_mfma_f32_32x32x16_bf16 v[16:31], v[132:135], a[68:71], v[16:31]
    buffer_load_dwordx4 a[180:183], v5, s[16:19], s41 offen offset:1024 sc1
    s_waitcnt vmcnt(36)
    v_mfma_f32_32x32x16_bf16 v[16:31], v[136:139], a[72:75], v[16:31]
    buffer_load_dwordx4 a[184:187], v5, s[16:19], s41 offen offset:2048 sc1
    s_waitcnt vmcnt(35)
    v_mfma_f32_32x32x16_bf16 v[16:31], v[140:143], a[76:79], v[16:31]
    buffer_load_dwordx4 a[188:191], v5, s[16:19], s41 offen offset:3072 sc1
    s_add_u32 s41, s41, 16384
    s_waitcnt vmcnt(34)
    v_mfma_f32_32x32x16_bf16 v[16:31], v[144:147], a[80:83], v[16:31]
    buffer_load_dwordx4 a[192:195], v5, s[16:19], s41 offen offset:0 sc1
    s_waitcnt vmcnt(33)
    v_mfma_f32_32x32x16_bf16 v[16:31], v[148:151], a[84:87], v[16:31]
    buffer_load_dwordx4 a[196:199], v5, s[16:19], s41 offen offset:1024 sc1
    s_waitcnt vmcnt(32)
    v_mfma_f32_32x32x16_bf16 v[16:31], v[152:155], a[88:91], v[16:31]
    buffer_load_dwordx4 a[200:203], v5, s[16:19], s41 offen offset:2048 sc1
    s_waitcnt vmcnt(31)
    v_mfma_f32_32x32x16_bf16 v[16:31], v[156:159], a[92:95], v[16:31]
    buffer_load_dwordx4 a[204:207], v5, s[16:19], s41 offen offset:3072 sc1
    s_add_u32 s41, s41, 16384
    s_waitcnt vmcnt(30)
    v_mfma_f32_32x32x16_bf16 v[16:31], v[160:163], a[96:99], v[16:31]
    buffer_load_dwordx4 a[208:211], v5, s[16:19], s41 offen offset:0 sc1
    s_waitcnt vmcnt(29)
    v_mfma_f32_32x32x16_bf16 v[16:31], v[164:167], a[100:103], v[16:31]
    buffer_load_dwordx4 a[212:215], v5, s[16:19], s41 offen offset:1024 sc1
    s_waitcnt vmcnt(28)
    v_mfma_f32_32x32x16_bf16 v[16:31], v[168:171], a[104:107], v[16:31]
    buffer_load_dwordx4 a[216:219], v5, s[16:19], s41 offen offset:2048 sc1
    s_waitcnt vmcnt(27)
    v_mfma_f32_32x32x16_bf16 v[16:31], v[172:175], a[108:111], v[16:31]
    buffer_load_dwordx4 a[220:223], v5, s[16:19], s41 offen offset:3072 sc1
    s_add_u32 s41, s41, 16384
    v_cmp_gt_u32 vcc, 32, v2
    s_nop 13
    v_cvt_pk_bf16_f32 v40, v16, v16
    v_lshlrev_b32 v40, 16, v40
    v_sub_f32 v40, v16, v40
    v_cvt_pk_bf16_f32 v40, v16, v40
    v_cndmask_b32 v40, 0, v40, vcc
    v_cvt_pk_bf16_f32 v41, v17, v17
    v_lshlrev_b32 v41, 16, v41
    v_sub_f32 v41, v17, v41
    v_cvt_pk_bf16_f32 v41, v17, v41
    v_cndmask_b32 v41, 0, v41, vcc
    v_mov_b32 v42, 0
    v_mov_b32 v43, 0
    buffer_store_dwordx4 v[40:43], v5, s[16:19], s25 offen sc1
    s_mov_b32 s30, 0x7f000000
    v_mov_b32 v37, 0
    v_mov_b32 v6, 0x7fffffff
    s_waitcnt vmcnt(25)
    s_barrier
    s_waitcnt vmcnt(0)
    buffer_store_dword v39, v38, s[16:19], s60 offen offset:8 sc1
k3_sig:
    s_lshr_b32 s39, s59, 1
    s_lshl_b32 s39, s39, 4
    s_and_b32 s27, s3, 1
    s_add_u32 s39, s39, s27
    s_lshl_b32 s39, s39, 8
    s_add_u32 s39, s39, 0x20000
    s_mov_b32 s62, 0xffff
    s_mul_i32 s37, s59, 28672
    s_add_u32 s37, s37, 0x2000000
    buffer_load_dwordx4 a[0:3], v5, s[16:19], s37 offen offset:0 sc1
    buffer_load_dwordx4 a[4:7], v5, s[16:19], s37 offen offset:1024 sc1
    buffer_load_dwordx4 a[8:11], v5, s[16:19], s37 offen offset:2048 sc1
    buffer_load_dwordx4 a[12:15], v5, s[16:19], s37 offen offset:3072 sc1
    s_add_u32 s37, s37, 4096
    buffer_load_dwordx4 a[16:19], v5, s[16:19], s37 offen offset:0 sc1
    buffer_load_dwordx4 a[20:23], v5, s[16:19], s37 offen offset:1024 sc1
    buffer_load_dwordx4 a[24:27], v5, s[16:19], s37 offen offset:2048 sc1
    buffer_load_dwordx4 a[28:31], v5, s[16:19], s37 offen offset:3072 sc1
    s_add_u32 s37, s37, 4096
    s_mov_b32 m0, s26
    s_nop 0
    buffer_load_dwordx4 v5, s[16:19], s22 offen offset:0 sc1 lds
    buffer_load_dwordx4 v5, s[16:19], s22 offen offset:1024 sc1 lds
    buffer_load_dwordx4 v5, s[16:19], s22 offen offset:2048 sc1 lds
    buffer_load_dwordx4 v5, s[16:19], s22 offen offset:3072 sc1 lds
    s_add_u32 s22, s22, 16384
    s_add_u32 s26, s26, 16384
    s_mov_b32 m0, s26
    s_nop 0
    buffer_load_dwordx4 v5, s[16:19], s22 offen offset:0 sc1 lds
    buffer_load_dwordx4 v5, s[16:19], s22 offen offset:1024 sc1 lds
    buffer_load_dwordx4 v5, s[16:19], s22 offen offset:2048 sc1 lds
    buffer_load_dwordx4 v5, s[16:19], s22 offen offset:3072 sc1 lds
    s_add_u32 s22, s22, 16384
    s_add_u32 s26, s26, 16384
    s_lshl_b32 s38, s59, 11
    s_add_u32 s38, s38, 0x1e00000
    v_lshlrev_b32 v36, 6, v34
    v_lshl_add_u32 v36, v35, 5, v36
    v_add_u32 v7, 57344, v5
    v_add_u32 v8, 114688, v5
    s_mul_i32 s27, s57, 7
    v_add_u32 v10, s27, v2
    v_and_b32 v9, 3, v10
    v_lshrrev_b32 v10, 2, v10
    v_lshl_add_u32 v10, v10, 5, v9
    v_lshlrev_b32 v10, 7, v10
    s_mov_b32 s47, 0x20e00
    s_mov_b32 s64, 0x7f
    s_mov_b32 s65, 0
    ds_read_b128 v[64:67], v5 offset:0
    ds_read_b128 v[68:71], v5 offset:1024
    ds_read_b128 v[72:75], v5 offset:2048
    ds_read_b128 v[76:79], v5 offset:3072
    ds_read_b128 v[80:83], v5 offset:4096
    ds_read_b128 v[84:87], v5 offset:5120
    s_waitcnt vmcnt(15)
    v_accvgpr_read_b32 v224, a0
    s_waitcnt vmcnt(14)
    v_accvgpr_read_b32 v225, a4
    s_waitcnt vmcnt(13)
    v_accvgpr_read_b32 v226, a8
    s_waitcnt vmcnt(12)
    v_accvgpr_read_b32 v227, a12
    v_max3_u32 v224, v224, v225, v226
    v_max_u32 v224, v224, v227
    v_cmp_eq_u32 s[10:11], -1, v224
    s_cmp_lg_u64 s[10:11], 0
    s_cbranch_scc1 xt_17
xb_18:
    s_waitcnt vmcnt(15) lgkmcnt(5)
    v_mfma_f32_32x32x16_bf16 v[128:143], v[64:67], a[0:3], 0
    ds_read_b128 v[88:91], v5 offset:6144
    buffer_load_dwordx4 a[32:35], v5, s[16:19], s37 offen offset:0 sc1
    s_waitcnt lgkmcnt(5)
    v_mfma_f32_32x32x16_bf16 v[144:159], v[68:71], a[0:3], 0
    ds_read_b128 v[92:95], v5 offset:7168
    s_waitcnt lgkmcnt(5)
    v_mfma_f32_32x32x16_bf16 v[160:175], v[72:75], a[0:3], 0
    ds_read_b128 v[64:67], v5 offset:8192
    buffer_load_dwordx4 a[36:39], v5, s[16:19], s37 offen offset:1024 sc1
    s_waitcnt vmcnt(16) lgkmcnt(5)
    v_mfma_f32_32x32x16_bf16 v[128:143], v[76:79], a[4:7], v[128:143]
    ds_read_b128 v[68:71], v5 offset:9216
    s_waitcnt lgkmcnt(5)
    v_mfma_f32_32x32x16_bf16 v[144:159], v[80:83], a[4:7], v[144:159]
    ds_read_b128 v[72:75], v5 offset:10240
    buffer_load_dwordx4 a[40:43], v5, s[16:19], s37 offen offset:2048 sc1
    s_waitcnt lgkmcnt(5)
    v_mfma_f32_32x32x16_bf16 v[160:175], v[84:87], a[4:7], v[160:175]
    ds_read_b128 v[76:79], v5 offset:11264
    s_waitcnt vmcnt(16) lgkmcnt(5)
    v_mfma_f32_32x32x16_bf16 v[128:143], v[88:91], a[8:11], v[128:143]
    ds_read_b128 v[80:83], v5 offset:12288
    s_waitcnt vmcnt(14)
    v_accvgpr_read_b32 v224, a16
    buffer_load_dwordx4 a[44:47], v5, s[16:19], s37 offen offset:3072 sc1
    s_add_u32 s37, s37, 4096
    s_waitcnt lgkmcnt(5)
    v_mfma_f32_32x32x16_bf16 v[144:159], v[92:95], a[8:11], v[144:159]
    ds_read_b128 v[84:87], v5 offset:13312
    s_waitcnt vmcnt(14)
    v_accvgpr_read_b32 v225, a20
    s_waitcnt lgkmcnt(5)
    v_mfma_f32_32x32x16_bf16 v[160:175], v[64:67], a[8:11], v[160:175]
    ds_read_b128 v[88:91], v5 offset:14336
    s_waitcnt vmcnt(13)
    v_accvgpr_read_b32 v226, a24
    buffer_load_dwordx4 a[48:51], v5, s[16:19], s37 offen offset:0 sc1
    s_waitcnt vmcnt(17) lgkmcnt(5)
    v_mfma_f32_32x32x16_bf16 v[128:143], v[68:71], a[12:15], v[128:143]
    ds_read_b128 v[92:95], v5 offset:15360
    s_waitcnt vmcnt(13)
    v_accvgpr_read_b32 v227, a28
    v_max3_u32 v224, v224, v225, v226
    v_max_u32 v224, v224, v227
    s_waitcnt lgkmcnt(5)
    v_mfma_f32_32x32x16_bf16 v[144:159], v[72:75], a[12:15], v[144:159]
    ds_read_b128 v[64:67], v5 offset:16384
    v_cmp_eq_u32 s[10:11], -1, v224
    buffer_load_dwordx4 a[52:55], v5, s[16:19], s37 offen offset:1024 sc1
    s_waitcnt lgkmcnt(5)
    v_mfma_f32_32x32x16_bf16 v[160:175], v[76:79], a[12:15], v[160:175]
    ds_read_b128 v[68:71], v5 offset:17408
    s_cmp_lg_u64 s[10:11], 0
    s_cbranch_scc1 xt_19
xb_20:
    s_waitcnt vmcnt(17) lgkmcnt(5)
    v_mfma_f32_32x32x16_bf16 v[128:143], v[80:83], a[16:19], v[128:143]
    ds_read_b128 v[72:75], v5 offset:18432
    buffer_load_dwordx4 a[56:59], v5, s[16:19], s37 offen offset:2048 sc1
    s_waitcnt lgkmcnt(5)
    v_mfma_f32_32x32x16_bf16 v[144:159], v[84:87], a[16:19], v[144:159]
    ds_read_b128 v[76:79], v5 offset:19456
    s_waitcnt lgkmcnt(5)
    v_mfma_f32_32x32x16_bf16 v[160:175], v[88:91], a[16:19], v[160:175]
    ds_read_b128 v[80:83], v5 offset:20480
    buffer_load_dwordx4 a[60:63], v5, s[16:19], s37 offen offset:3072 sc1
    s_add_u32 s37, s37, 4096
    s_waitcnt vmcnt(18) lgkmcnt(5)
    v_mfma_f32_32x32x16_bf16 v[128:143], v[92:95], a[20:23], v[128:143]
    ds_read_b128 v[84:87], v5 offset:21504
    s_waitcnt lgkmcnt(5)
    v_mfma_f32_32x32x16_bf16 v[144:159], v[64:67], a[20:23], v[144:159]
    ds_read_b128 v[88:91], v5 offset:22528
    buffer_load_dwordx4 a[64:67], v5, s[16:19], s37 offen offset:0 sc1
    s_waitcnt lgkmcnt(5)
    v_mfma_f32_32x32x16_bf16 v[160:175], v[68:71], a[20:23], v[160:175]
    ds_read_b128 v[92:95], v5 offset:23552
    s_waitcnt vmcnt(18) lgkmcnt(5)
    v_mfma_f32_32x32x16_bf16 v[128:143], v[72:75], a[24:27], v[128:143]
    ds_read_b128 v[64:67], v5 offset:24576
    s_waitcnt vmcnt(8)
    v_accvgpr_read_b32 v224, a32
    buffer_load_dwordx4 a[68:71], v5, s[16:19], s37 offen offset:1024 sc1
    s_waitcnt lgkmcnt(5)
    v_mfma_f32_32x32x16_bf16 v[144:159], v[76:79], a[24:27], v[144:159]
    ds_read_b128 v[68:71], v5 offset:25600
    s_waitcnt vmcnt(8)
    v_accvgpr_read_b32 v225, a36
    s_waitcnt lgkmcnt(5)
    v_mfma_f32_32x32x16_bf16 v[160:175], v[80:83], a[24:27], v[160:175]
    ds_read_b128 v[72:75], v5 offset:26624
    s_waitcnt vmcnt(7)
    v_accvgpr_read_b32 v226, a40
    s_mov_b64 exec, s[62:63]
    buffer_load_dword v1, v11, s[16:19], s39 offen offset:8 sc1
    s_mov_b64 exec, -1
    s_waitcnt vmcnt(19) lgkmcnt(5)
    v_mfma_f32_32x32x16_bf16 v[128:143], v[84:87], a[28:31], v[128:143]
    ds_read_b128 v[76:79], v5 offset:27648
    s_waitcnt vmcnt(7)
    v_accvgpr_read_b32 v227, a44
    v_max3_u32 v224, v224, v225, v226
    v_max_u32 v224, v224, v227
    s_waitcnt lgkmcnt(5)
    v_mfma_f32_32x32x16_bf16 v[144:159], v[88:91], a[28:31], v[144:159]
    ds_read_b128 v[80:83], v5 offset:28672
    v_cmp_eq_u32 s[10:11], -1, v224
    s_mov_b64 exec, s[64:65]
    buffer_load_dword v40, v10, s[16:19], s47 offen offset:8 sc1
    s_mov_b64 exec, -1
    s_waitcnt lgkmcnt(5)
    v_mfma_f32_32x32x16_bf16 v[160:175], v[92:95], a[28:31], v[160:175]
    ds_read_b128 v[84:87], v5 offset:29696
    s_cmp_lg_u64 s[10:11], 0
    s_cbranch_scc1 xt_21
xb_22:
    s_waitcnt vmcnt(11) lgkmcnt(5)
    v_mfma_f32_32x32x16_bf16 v[128:143], v[64:67], a[32:35], v[128:143]
    ds_read_b128 v[88:91], v5 offset:30720
    buffer_load_dwordx4 a[72:75], v5, s[16:19], s37 offen offset:2048 sc1
    s_waitcnt lgkmcnt(5)
    v_mfma_f32_32x32x16_bf16 v[144:159], v[68:71], a[32:35], v[144:159]
    ds_read_b128 v[92:95], v5 offset:31744
    s_waitcnt lgkmcnt(5)
    v_mfma_f32_32x32x16_bf16 v[160:175], v[72:75], a[32:35], v[160:175]
    ds_read_b128 v[64:67], v5 offset:32768
    buffer_load_dwordx4 a[76:79], v5, s[16:19], s37 offen offset:3072 sc1
    s_add_u32 s37, s37, 4096
    s_waitcnt vmcnt(12) lgkmcnt(5)
    v_mfma_f32_32x32x16_bf16 v[128:143], v[76:79], a[36:39], v[128:143]
    ds_read_b128 v[68:71], v5 offset:33792
    s_waitcnt lgkmcnt(5)
    v_mfma_f32_32x32x16_bf16 v[144:159], v[80:83], a[36:39], v[144:159]
    ds_read_b128 v[72:75], v5 offset:34816
    buffer_load_dwordx4 a[80:83], v5, s[16:19], s37 offen offset:0 sc1
    s_waitcnt lgkmcnt(5)
    v_mfma_f32_32x32x16_bf16 v[160:175], v[84:87], a[36:39], v[160:175]
    ds_read_b128 v[76:79], v5 offset:35840
    s_waitcnt vmcnt(12) lgkmcnt(5)
    v_mfma_f32_32x32x16_bf16 v[128:143], v[88:91], a[40:43], v[128:143]
    ds_read_b128 v[80:83], v5 offset:36864
    s_waitcnt vmcnt(10)
    v_accvgpr_read_b32 v224, a48
    buffer_load_dwordx4 a[84:87], v5, s[16:19], s37 offen offset:1024 sc1
    s_waitcnt lgkmcnt(5)
    v_mfma_f32_32x32x16_bf16 v[144:159], v[92:95], a[40:43], v[144:159]
    ds_read_b128 v[84:87], v5 offset:37888
    s_waitcnt vmcnt(10)
    v_accvgpr_read_b32 v225, a52
    s_waitcnt lgkmcnt(5)
    v_mfma_f32_32x32x16_bf16 v[160:175], v[64:67], a[40:43], v[160:175]
    ds_read_b128 v[88:91], v5 offset:38912
    s_waitcnt vmcnt(9)
    v_accvgpr_read_b32 v226, a56
    buffer_load_dwordx4 a[88:91], v5, s[16:19], s37 offen offset:2048 sc1
    s_waitcnt vmcnt(13) lgkmcnt(5)
    v_mfma_f32_32x32x16_bf16 v[128:143], v[68:71], a[44:47], v[128:143]
    ds_read_b128 v[92:95], v5 offset:39936
    s_waitcnt vmcnt(9)
    v_accvgpr_read_b32 v227, a60
    v_max3_u32 v224, v224, v225, v226
    v_max_u32 v224, v224, v227
    s_waitcnt lgkmcnt(5)
    v_mfma_f32_32x32x16_bf16 v[144:159], v[72:75], a[44:47], v[144:159]
    ds_read_b128 v[64:67], v5 offset:40960
    v_cmp_eq_u32 s[10:11], -1, v224
    buffer_load_dwordx4 a[92:95], v5, s[16:19], s37 offen offset:3072 sc1
    s_add_u32 s37, s37, 4096
    s_waitcnt lgkmcnt(5)
    v_mfma_f32_32x32x16_bf16 v[160:175], v[76:79], a[44:47], v[160:175]
    ds_read_b128 v[68:71], v5 offset:41984
    s_cmp_lg_u64 s[10:11], 0
    s_cbranch_scc1 xt_23
xb_24:
    s_waitcnt vmcnt(13) lgkmcnt(5)
    v_mfma_f32_32x32x16_bf16 v[128:143], v[80:83], a[48:51], v[128:143]
    ds_read_b128 v[72:75], v5 offset:43008
    buffer_load_dwordx4 a[96:99], v5, s[16:19], s37 offen offset:0 sc1
    s_waitcnt lgkmcnt(5)
    v_mfma_f32_32x32x16_bf16 v[144:159], v[84:87], a[48:51], v[144:159]
    ds_read_b128 v[76:79], v5 offset:44032
    s_waitcnt lgkmcnt(5)
    v_mfma_f32_32x32x16_bf16 v[160:175], v[88:91], a[48:51], v[160:175]
    ds_read_b128 v[80:83], v5 offset:45056
    buffer_load_dwordx4 a[100:103], v5, s[16:19], s37 offen offset:1024 sc1
    s_waitcnt vmcnt(14) lgkmcnt(5)
    v_mfma_f32_32x32x16_bf16 v[128:143], v[92:95], a[52:55], v[128:143]
    ds_read_b128 v[84:87], v5 offset:46080
    s_waitcnt lgkmcnt(5)
    v_mfma_f32_32x32x16_bf16 v[144:159], v[64:67], a[52:55], v[144:159]
    ds_read_b128 v[88:91], v5 offset:47104
    buffer_load_dwordx4 a[104:107], v5, s[16:19], s37 offen offset:2048 sc1
    s_barrier
    s_waitcnt lgkmcnt(5)
    v_mfma_f32_32x32x16_bf16 v[160:175], v[68:71], a[52:55], v[160:175]
    ds_read_b128 v[92:95], v5 offset:48128
    s_waitcnt vmcnt(14) lgkmcnt(5)
    v_mfma_f32_32x32x16_bf16 v[128:143], v[72:75], a[56:59], v[128:143]
    ds_read_b128 v[64:67], v5 offset:49152
    s_waitcnt vmcnt(12)
    v_accvgpr_read_b32 v224, a64
    buffer_load_dwordx4 a[108:111], v5, s[16:19], s37 offen offset:3072 sc1
    s_add_u32 s37, s37, 4096
    s_waitcnt lgkmcnt(5)
    v_mfma_f32_32x32x16_bf16 v[144:159], v[76:79], a[56:59], v[144:159]
    ds_read_b128 v[68:71], v5 offset:50176
    s_waitcnt vmcnt(12)
    v_accvgpr_read_b32 v225, a68
    s_waitcnt lgkmcnt(5)
    v_mfma_f32_32x32x16_bf16 v[160:175], v[80:83], a[56:59], v[160:175]
    ds_read_b128 v[72:75], v5 offset:51200
    s_waitcnt vmcnt(9)
    v_accvgpr_read_b32 v226, a72
    s_waitcnt vmcnt(11)
    v_subrev_u32 v1, s61, v1
    v_cmp_gt_u32 vcc, 64, v1
    s_and_b64 s[42:43], vcc, s[62:63]
    s_cmp_eq_u64 s[42:43], s[62:63]
    s_cbranch_scc0 slow_31
back_32:
    buffer_load_dwordx4 v[16:19], v36, s[16:19], s38 offen sc1
    s_waitcnt vmcnt(15) lgkmcnt(5)
    v_mfma_f32_32x32x16_bf16 v[128:143], v[84:87], a[60:63], v[128:143]
    ds_read_b128 v[76:79], v5 offset:52224
    s_waitcnt vmcnt(9)
    v_accvgpr_read_b32 v227, a76
    v_max3_u32 v224, v224, v225, v226
    v_max_u32 v224, v224, v227
    s_waitcnt lgkmcnt(5)
    v_mfma_f32_32x32x16_bf16 v[144:159], v[88:91], a[60:63], v[144:159]
    ds_read_b128 v[80:83], v5 offset:53248
    v_cmp_eq_u32 s[10:11], -1, v224
    buffer_load_dwordx4 v[20:23], v36, s[16:19], s38 offen offset:16 sc1
    s_waitcnt lgkmcnt(5)
    v_mfma_f32_32x32x16_bf16 v[160:175], v[92:95], a[60:63], v[160:175]
    ds_read_b128 v[84:87], v5 offset:54272
    s_cmp_lg_u64 s[10:11], 0
    s_cbranch_scc1 xt_25
xb_26:
    s_waitcnt vmcnt(15) lgkmcnt(5)
    v_mfma_f32_32x32x16_bf16 v[128:143], v[64:67], a[64:67], v[128:143]
    ds_read_b128 v[88:91], v5 offset:55296
    s_waitcnt vmcnt(12)
    v_subrev_u32 v40, s61, v40
    v_cmp_gt_u32 vcc, 64, v40
    s_and_b64 s[42:43], vcc, s[64:65]
    s_cmp_eq_u64 s[42:43], s[64:65]
    s_cbranch_scc0 slow_33
back_34:
    s_waitcnt lgkmcnt(5)
    v_mfma_f32_32x32x16_bf16 v[144:159], v[68:71], a[64:67], v[144:159]
    ds_read_b128 v[92:95], v5 offset:56320
    buffer_load_dwordx4 v[96:99], v5, s[16:19], s46 offen offset:0 sc1
    s_waitcnt lgkmcnt(5)
    v_mfma_f32_32x32x16_bf16 v[160:175], v[72:75], a[64:67], v[160:175]
    ds_read_b128 v[64:67], v7 offset:0
    s_waitcnt vmcnt(15) lgkmcnt(5)
    v_mfma_f32_32x32x16_bf16 v[128:143], v[76:79], a[68:71], v[128:143]
    ds_read_b128 v[68:71], v7 offset:1024
    buffer_load_dwordx4 v[100:103], v5, s[16:19], s46 offen offset:1024 sc1
    s_waitcnt lgkmcnt(5)
    v_mfma_f32_32x32x16_bf16 v[144:159], v[80:83], a[68:71], v[144:159]
    ds_read_b128 v[72:75], v7 offset:2048
    s_waitcnt lgkmcnt(5)
    v_mfma_f32_32x32x16_bf16 v[160:175], v[84:87], a[68:71], v[160:175]
    ds_read_b128 v[76:79], v7 offset:3072
    buffer_load_dwordx4 v[104:107], v5, s[16:19], s46 offen offset:2048 sc1
    s_waitcnt vmcnt(14) lgkmcnt(5)
    v_mfma_f32_32x32x16_bf16 v[128:143], v[88:91], a[72:75], v[128:143]
    ds_read_b128 v[80:83], v7 offset:4096
    s_waitcnt vmcnt(12)
    v_accvgpr_read_b32 v224, a80
    s_waitcnt lgkmcnt(5)
    v_mfma_f32_32x32x16_bf16 v[144:159], v[92:95], a[72:75], v[144:159]
    ds_read_b128 v[84:87], v7 offset:5120
    s_waitcnt vmcnt(11)
    v_accvgpr_read_b32 v225, a84
    s_mov_b32 m0, s26
    s_nop 0
    buffer_load_dwordx4 v5, s[16:19], s22 offen offset:0 sc1 lds
    s_waitcnt lgkmcnt(5)
    v_mfma_f32_32x32x16_bf16 v[160:175], v[64:67], a[72:75], v[160:175]
    ds_read_b128 v[88:91], v7 offset:6144
    s_waitcnt vmcnt(11)
    v_accvgpr_read_b32 v226, a88
    s_waitcnt vmcnt(14) lgkmcnt(5)
    v_mfma_f32_32x32x16_bf16 v[128:143], v[68:71], a[76:79], v[128:143]
    ds_read_b128 v[92:95], v7 offset:7168
    s_waitcnt vmcnt(10)
    v_accvgpr_read_b32 v227, a92
    v_max3_u32 v224, v224, v225, v226
    v_max_u32 v224, v224, v227
    buffer_load_dwordx4 v5, s[16:19], s22 offen offset:1024 sc1 lds
    s_waitcnt lgkmcnt(5)
    v_mfma_f32_32x32x16_bf16 v[144:159], v[72:75], a[76:79], v[144:159]
    ds_read_b128 v[64:67], v7 offset:8192
    v_cmp_eq_u32 s[10:11], -1, v224
    s_waitcnt lgkmcnt(5)
    v_mfma_f32_32x32x16_bf16 v[160:175], v[76:79], a[76:79], v[160:175]
    ds_read_b128 v[68:71], v7 offset:9216
    s_cmp_lg_u64 s[10:11], 0
    s_cbranch_scc1 xt_27
xb_28:
    buffer_load_dwordx4 v5, s[16:19], s22 offen offset:2048 sc1 lds
    s_waitcnt vmcnt(15) lgkmcnt(5)
    v_mfma_f32_32x32x16_bf16 v[128:143], v[80:83], a[80:83], v[128:143]
    ds_read_b128 v[72:75], v7 offset:10240
    s_waitcnt lgkmcnt(5)
    v_mfma_f32_32x32x16_bf16 v[144:159], v[84:87], a[80:83], v[144:159]
    ds_read_b128 v[76:79], v7 offset:11264
    buffer_load_dwordx4 v5, s[16:19], s22 offen offset:3072 sc1 lds
    s_add_u32 s22, s22, 16384
    s_sub_u32 s26, s26, 147456
    s_waitcnt lgkmcnt(5)
    v_mfma_f32_32x32x16_bf16 v[160:175], v[88:91], a[80:83], v[160:175]
    ds_read_b128 v[80:83], v7 offset:12288
    s_waitcnt vmcnt(15) lgkmcnt(5)
    v_mfma_f32_32x32x16_bf16 v[128:143], v[92:95], a[84:87], v[128:143]
    ds_read_b128 v[84:87], v7 offset:13312
    s_mov_b32 m0, s26
    s_nop 0
    buffer_load_dwordx4 v5, s[16:19], s22 offen offset:0 sc1 lds
    s_waitcnt lgkmcnt(5)
    v_mfma_f32_32x32x16_bf16 v[144:159], v[64:67], a[84:87], v[144:159]
    ds_read_b128 v[88:91], v7 offset:14336
    s_waitcnt lgkmcnt(5)
    v_mfma_f32_32x32x16_bf16 v[160:175], v[68:71], a[84:87], v[160:175]
    ds_read_b128 v[92:95], v7 offset:15360
    buffer_load_dwordx4 v5, s[16:19], s22 offen offset:1024 sc1 lds
    s_waitcnt vmcnt(16) lgkmcnt(5)
    v_mfma_f32_32x32x16_bf16 v[128:143], v[72:75], a[88:91], v[128:143]
    ds_read_b128 v[64:67], v7 offset:16384
    s_waitcnt vmcnt(14)
    v_accvgpr_read_b32 v224, a96
    s_mov_b32 s4, 0
    s_mov_b32 s5, -1
    s_waitcnt vmcnt(9)
    v_cndmask_b32 v22, v22, 0, s[4:5]
    v_cndmask_b32 v23, v23, 0, s[4:5]
    v_add_f32 v16, v16, v18
    v_add_f32 v17, v17, v19
    s_waitcnt lgkmcnt(5)
    v_mfma_f32_32x32x16_bf16 v[144:159], v[76:79], a[88:91], v[144:159]
    ds_read_b128 v[68:71], v7 offset:17408
    s_waitcnt vmcnt(13)
    v_accvgpr_read_b32 v225, a100
    buffer_load_dwordx4 v5, s[16:19], s22 offen offset:2048 sc1 lds
    v_add_f32 v20, v20, v22
    v_add_f32 v21, v21, v23
    v_add_f32 v16, v16, v20
    s_waitcnt lgkmcnt(5)
    v_mfma_f32_32x32x16_bf16 v[160:175], v[80:83], a[88:91], v[160:175]
    ds_read_b128 v[72:75], v7 offset:18432
    s_waitcnt vmcnt(13)
    v_accvgpr_read_b32 v226, a104
    v_add_f32 v17, v17, v21
    v_mov_b32 v18, v16
    v_mov_b32 v19, v17
    s_nop 1
    s_waitcnt vmcnt(16) lgkmcnt(5)
    v_mfma_f32_32x32x16_bf16 v[128:143], v[84:87], a[92:95], v[128:143]
    ds_read_b128 v[76:79], v7 offset:19456
    s_waitcnt vmcnt(12)
    v_accvgpr_read_b32 v227, a108
    v_max3_u32 v224, v224, v225, v226
    v_max_u32 v224, v224, v227
    buffer_load_dwordx4 v5, s[16:19], s22 offen offset:3072 sc1 lds
    s_add_u32 s22, s22, 16384
    s_add_u32 s26, s26, 16384
    s_waitcnt lgkmcnt(5)
    v_mfma_f32_32x32x16_bf16 v[144:159], v[88:91], a[92:95], v[144:159]
    ds_read_b128 v[80:83], v7 offset:20480
    v_cmp_eq_u32 s[10:11], -1, v224
    v_permlane32_swap_b32 v16, v18
    v_permlane32_swap_b32 v17, v19
    s_nop 1
    v_add_f32 v16, v16, v18
    s_waitcnt lgkmcnt(5)
    v_mfma_f32_32x32x16_bf16 v[160:175], v[92:95], a[92:95], v[160:175]
    ds_read_b128 v[84:87], v7 offset:21504
    s_cmp_lg_u64 s[10:11], 0
    s_cbranch_scc1 xt_29
xb_30:
    s_mov_b32 m0, s26
    s_nop 0
    buffer_load_dwordx4 v5, s[16:19], s22 offen offset:0 sc1 lds
    v_add_f32 v17, v17, v19
    s_waitcnt vmcnt(17) lgkmcnt(5)
    v_mfma_f32_32x32x16_bf16 v[128:143], v[64:67], a[96:99], v[128:143]
    ds_read_b128 v[88:91], v7 offset:22528
    s_barrier
    v_mul_f32 v18, 0x3b124925, v16
    v_mul_f32 v19, 0x3b124925, v17
    v_fma_f32 v19, -v18, v18, v19
    v_max_f32 v19, 0, v19
    v_sub_f32 v18, 0, v18
    v_cvt_pk_bf16_f32 v24, v18, v18
    s_waitcnt lgkmcnt(5)
    v_mfma_f32_32x32x16_bf16 v[144:159], v[68:71], a[96:99], v[144:159]
    ds_read_b128 v[92:95], v7 offset:23552
    buffer_load_dwordx4 v5, s[16:19], s22 offen offset:1024 sc1 lds
    v_cvt_pk_bf16_f32 v19, v19, v19
    v_lshlrev_b32 v19, 16, v19
    v_add_f32 v19, 0x3727c5ac, v19
    v_cvt_pk_bf16_f32 v19, v19, v19
    s_waitcnt lgkmcnt(5)
    v_mfma_f32_32x32x16_bf16 v[160:175], v[72:75], a[96:99], v[160:175]
    ds_read_b128 v[64:67], v7 offset:24576
    v_lshlrev_b32 v19, 16, v19
    v_sqrt_f32 v19, v19
    s_nop 0
    v_cvt_pk_bf16_f32 v25, v19, v19
    v_lshlrev_b32 v19, 16, v25
    s_waitcnt vmcnt(17) lgkmcnt(5)
    v_mfma_f32_32x32x16_bf16 v[128:143], v[76:79], a[100:103], v[128:143]
    ds_read_b128 v[68:71], v7 offset:25600
    buffer_load_dwordx4 v5, s[16:19], s22 offen offset:2048 sc1 lds
    v_rcp_f32 v18, v19
    v_mul_f32 v32, v19, v19
    v_cndmask_b32 v24, v24, 0, s[4:5]
    s_waitcnt lgkmcnt(5)
    v_mfma_f32_32x32x16_bf16 v[144:159], v[80:83], a[100:103], v[144:159]
    ds_read_b128 v[72:75], v7 offset:26624
    v_cndmask_b32 v25, v25, 0, s[4:5]
    v_mov_b32 v26, 0
    v_mov_b32 v27, 0
    v_mul_f32 v28, 0xc0135761, v18
    v_mul_f32 v30, v18, v18
    v_mul_f32 v30, v30, v18
    s_waitcnt lgkmcnt(5)
    v_mfma_f32_32x32x16_bf16 v[160:175], v[84:87], a[100:103], v[160:175]
    ds_read_b128 v[76:79], v7 offset:27648
    buffer_load_dwordx4 v5, s[16:19], s22 offen offset:3072 sc1 lds
    s_add_u32 s22, s22, 16384
    s_add_u32 s26, s26, 16384
    v_mul_f32 v30, 0xbdd2d3e8, v30
    v_mov_b32 v33, v32
    v_mov_b32 v29, v28
    s_waitcnt vmcnt(18) lgkmcnt(5)
    v_mfma_f32_32x32x16_bf16 v[128:143], v[88:91], a[104:107], v[128:143]
    v_mov_b32 v31, v30
    v_lshrrev_b32 v9, 4, v34
    v_lshlrev_b32 v9, 14, v9
    v_lshl_add_u32 v9, v35, 8, v9
    v_lshl_add_u32 v9, v3, 4, v9
    s_lshl_b32 s40, s9, 8
    s_add_u32 s40, s40, s3
    s_lshl_b32 s40, s40, 10
    s_add_u32 s40, s40, 0x2400000
    s_mov_b32 s7, s40
    s_waitcnt lgkmcnt(4)
    v_mfma_f32_32x32x16_bf16 v[144:159], v[92:95], a[104:107], v[144:159]
    s_sub_u32 s26, s26, s23
    s_sub_u32 s22, s22, s23
    s_mov_b32 m0, s26
    s_nop 0
    buffer_load_dwordx4 v5, s[16:19], s22 offen offset:0 sc1 lds
    s_mul_i32 s21, s32, 81920
    s_and_b32 s21, s21, 147456
    v_add_u32 v12, s21, v5
    s_mul_i32 s21, s33, 81920
    s_and_b32 s21, s21, 147456
    s_waitcnt lgkmcnt(3)
    v_mfma_f32_32x32x16_bf16 v[160:175], v[64:67], a[104:107], v[160:175]
    v_add_u32 v13, s21, v5
    s_mul_i32 s21, s34, 81920
    s_and_b32 s21, s21, 147456
    v_add_u32 v14, s21, v5
    s_mul_i32 s21, s35, 81920
    s_and_b32 s21, s21, 147456
    v_add_u32 v15, s21, v5
    s_mul_i32 s21, s32, 12288
    v_add_u32 v112, s21, v5
    s_mul_i32 s21, s33, 12288
    s_waitcnt vmcnt(18) lgkmcnt(2)
    v_mfma_f32_32x32x16_bf16 v[128:143], v[68:71], a[108:111], v[128:143]
    ds_read_b128 v[92:95], v7 offset:28672
    buffer_load_dwordx4 v[108:111], v5, s[16:19], s46 offen offset:3072 sc1
    v_add_u32 v113, s21, v5
    s_mul_i32 s21, s34, 12288
    s_add_u32 s21, s21, 4096
    v_add_u32 v114, s21, v5
    s_mul_i32 s21, s35, 12288
    s_add_u32 s21, s21, 8192
    s_waitcnt lgkmcnt(2)
    v_mfma_f32_32x32x16_bf16 v[144:159], v[72:75], a[108:111], v[144:159]
    ds_read_b128 v[64:67], v7 offset:29696
    v_add_u32 v115, s21, v5
    s_waitcnt lgkmcnt(2)
    v_mfma_f32_32x32x16_bf16 v[160:175], v[76:79], a[108:111], v[160:175]
    ds_read_b128 v[68:71], v7 offset:30720
    s_add_u32 s46, s46, 4096
    buffer_load_dwordx4 v[240:243], v5, s[16:19], s46 offen offset:0 sc1
    s_nop 1
    s_waitcnt vmcnt(17)
    v_mfma_f32_32x32x16_bf16 v[128:143], v[96:99], v[24:27], v[128:143]
    ds_read_b128 v[72:75], v7 offset:31744
    s_waitcnt vmcnt(16)
    v_mfma_f32_32x32x16_bf16 v[144:159], v[100:103], v[24:27], v[144:159]
    ds_read_b128 v[76:79], v7 offset:32768
    buffer_load_dwordx4 v[244:247], v5, s[16:19], s46 offen offset:1024 sc1
    s_waitcnt vmcnt(16)
    v_mfma_f32_32x32x16_bf16 v[160:175], v[104:107], v[24:27], v[160:175]
    ds_read_b128 v[80:83], v7 offset:33792
    s_waitcnt lgkmcnt(5)
    v_mfma_f32_32x32x16_bf16 v[176:191], v[92:95], a[0:3], 0
    ds_read_b128 v[84:87], v7 offset:34816
    buffer_load_dwordx4 v[248:251], v5, s[16:19], s46 offen offset:2048 sc1
    s_waitcnt lgkmcnt(5)
    v_mfma_f32_32x32x16_bf16 v[176:191], v[64:67], a[4:7], v[176:191]
    ds_read_b128 v[88:91], v7 offset:35840
    s_waitcnt lgkmcnt(5)
    v_mfma_f32_32x32x16_bf16 v[176:191], v[68:71], a[8:11], v[176:191]
    ds_read_b128 v[92:95], v7 offset:36864
    buffer_load_dwordx4 a[224:227], v5, s[16:19], s41 offen offset:0 sc1
    v_mul_f32 v40, v128, v128
    v_mul_f32 v41, v129, v129
    v_mul_f32 v42, v130, v130
    v_mul_f32 v43, v131, v131
    s_waitcnt lgkmcnt(5)
    v_mfma_f32_32x32x16_bf16 v[176:191], v[72:75], a[12:15], v[176:191]
    ds_read_b128 v[64:67], v7 offset:37888
    v_mul_f32 v44, v132, v132
    v_mul_f32 v45, v133, v133
    v_mul_f32 v46, v134, v134
    v_mul_f32 v47, v135, v135
    v_fma_f32 v40, v40, v30, v28
    v_fma_f32 v41, v41, v30, v28
    s_waitcnt lgkmcnt(5)
    v_mfma_f32_32x32x16_bf16 v[176:191], v[76:79], a[16:19], v[176:191]
    ds_read_b128 v[68:71], v7 offset:38912
    buffer_load_dwordx4 a[228:231], v5, s[16:19], s41 offen offset:1024 sc1
    v_fma_f32 v42, v42, v30, v28
    v_fma_f32 v43, v43, v30, v28
    v_fma_f32 v44, v44, v30, v28
    v_fma_f32 v45, v45, v30, v28
    s_waitcnt lgkmcnt(5)
    v_mfma_f32_32x32x16_bf16 v[176:191], v[80:83], a[20:23], v[176:191]
    ds_read_b128 v[72:75], v7 offset:39936
    v_fma_f32 v46, v46, v30, v28
    v_fma_f32 v47, v47, v30, v28
    v_mul_f32 v40, v40, v128
    v_mul_f32 v41, v41, v129
    v_mul_f32 v42, v42, v130
    v_mul_f32 v43, v43, v131
    s_waitcnt lgkmcnt(5)
    v_mfma_f32_32x32x16_bf16 v[176:191], v[84:87], a[24:27], v[176:191]
    ds_read_b128 v[76:79], v7 offset:40960
    buffer_load_dwordx4 a[232:235], v5, s[16:19], s41 offen offset:2048 sc1
    v_mul_f32 v44, v44, v132
    v_mul_f32 v45, v45, v133
    v_mul_f32 v46, v46, v134
    v_mul_f32 v47, v47, v135
    s_waitcnt lgkmcnt(5)
    v_mfma_f32_32x32x16_bf16 v[176:191], v[88:91], a[28:31], v[176:191]
    ds_read_b128 v[80:83], v7 offset:41984
    v_exp_f32 v40, v40
    v_mul_f32 v48, v128, v136
    v_exp_f32 v41, v41
    v_mul_f32 v49, v129, v137
    s_waitcnt lgkmcnt(5)
    v_mfma_f32_32x32x16_bf16 v[176:191], v[92:95], a[32:35], v[176:191]
    ds_read_b128 v[84:87], v7 offset:43008
    buffer_load_dwordx4 a[236:239], v5, s[16:19], s41 offen offset:3072 sc1
    s_add_u32 s41, s41, 16384
    v_exp_f32 v42, v42
    v_mul_f32 v50, v130, v138
    s_waitcnt lgkmcnt(5)
    v_mfma_f32_32x32x16_bf16 v[176:191], v[64:67], a[36:39], v[176:191]
    ds_read_b128 v[88:91], v7 offset:44032
    v_exp_f32 v43, v43
    v_mul_f32 v51, v131, v139
    v_exp_f32 v44, v44
    v_mul_f32 v52, v132, v140
    s_waitcnt lgkmcnt(5)
    v_mfma_f32_32x32x16_bf16 v[176:191], v[68:71], a[40:43], v[176:191]
    ds_read_b128 v[92:95], v7 offset:45056
    buffer_load_dwordx4 a[240:243], v5, s[16:19], s41 offen offset:0 sc1
    v_exp_f32 v45, v45
    v_mul_f32 v53, v133, v141
    s_waitcnt lgkmcnt(5)
    v_mfma_f32_32x32x16_bf16 v[176:191], v[72:75], a[44:47], v[176:191]
    ds_read_b128 v[64:67], v7 offset:46080
    v_exp_f32 v46, v46
    v_mul_f32 v54, v134, v142
    v_exp_f32 v47, v47
    v_mul_f32 v55, v135, v143
    s_waitcnt lgkmcnt(5)
    v_mfma_f32_32x32x16_bf16 v[176:191], v[76:79], a[48:51], v[176:191]
    ds_read_b128 v[68:71], v7 offset:47104
    buffer_load_dwordx4 a[244:247], v5, s[16:19], s41 offen offset:1024 sc1
    v_fma_f32 v40, v40, v32, v32
    v_fma_f32 v41, v41, v32, v32
    v_fma_f32 v42, v42, v32, v32
    v_fma_f32 v43, v43, v32, v32
    s_waitcnt lgkmcnt(5)
    v_mfma_f32_32x32x16_bf16 v[176:191], v[80:83], a[52:55], v[176:191]
    ds_read_b128 v[72:75], v7 offset:48128
    s_cmp_eq_u32 s8, 7
    s_cselect_b32 s40, 0x7f000000, s40
    v_fma_f32 v44, v44, v32, v32
    v_fma_f32 v45, v45, v32, v32
    v_fma_f32 v46, v46, v32, v32
    v_fma_f32 v47, v47, v32, v32
    s_waitcnt lgkmcnt(5)
    v_mfma_f32_32x32x16_bf16 v[176:191], v[84:87], a[56:59], v[176:191]
    ds_read_b128 v[76:79], v7 offset:49152
    buffer_load_dwordx4 a[248:251], v5, s[16:19], s41 offen offset:2048 sc1
    v_rcp_f32 v40, v40
    v_rcp_f32 v41, v41
    s_waitcnt lgkmcnt(5)
    v_mfma_f32_32x32x16_bf16 v[176:191], v[88:91], a[60:63], v[176:191]
    ds_read_b128 v[80:83], v7 offset:50176
    v_mul_f32 v48, v48, v40
    v_rcp_f32 v42, v42
    v_mul_f32 v49, v49, v41
    v_rcp_f32 v43, v43
    s_waitcnt lgkmcnt(5)
    v_mfma_f32_32x32x16_bf16 v[176:191], v[92:95], a[64:67], v[176:191]
    ds_read_b128 v[84:87], v7 offset:51200
    buffer_load_dwordx4 a[252:255], v5, s[16:19], s41 offen offset:3072 sc1
    s_add_u32 s41, s41, 16384
    v_mul_f32 v50, v50, v42
    v_rcp_f32 v44, v44
    v_mul_f32 v51, v51, v43
    s_waitcnt lgkmcnt(5)
    v_mfma_f32_32x32x16_bf16 v[176:191], v[64:67], a[68:71], v[176:191]
    ds_read_b128 v[88:91], v7 offset:52224
    s_waitcnt vmcnt(21)
    s_barrier
    v_rcp_f32 v45, v45
    v_mul_f32 v52, v52, v44
    v_rcp_f32 v46, v46
    v_mul_f32 v53, v53, v45
    s_waitcnt lgkmcnt(5)
    v_mfma_f32_32x32x16_bf16 v[176:191], v[68:71], a[72:75], v[176:191]
    ds_read_b128 v[92:95], v7 offset:53248
    buffer_load_dwordx4 a[112:115], v5, s[16:19], s41 offen offset:0 sc1
    v_rcp_f32 v47, v47
    v_mul_f32 v54, v54, v46
    v_cvt_pk_bf16_f32 v56, v48, v49
    s_waitcnt lgkmcnt(5)
    v_mfma_f32_32x32x16_bf16 v[176:191], v[72:75], a[76:79], v[176:191]
    ds_read_b128 v[64:67], v7 offset:54272
    v_mul_f32 v55, v55, v47
    v_cvt_pk_bf16_f32 v57, v50, v51
    v_cvt_pk_bf16_f32 v58, v52, v53
    v_cvt_pk_bf16_f32 v59, v54, v55
    buffer_store_dwordx4 v[56:59], v9, s[16:19], s80 offen sc1
    s_add_u32 s80, s80, 8192
    s_waitcnt lgkmcnt(5)
    v_mfma_f32_32x32x16_bf16 v[176:191], v[76:79], a[80:83], v[176:191]
    ds_read_b128 v[68:71], v7 offset:55296
    buffer_load_dwordx4 a[116:119], v5, s[16:19], s41 offen offset:1024 sc1
    v_mul_f32 v40, v144, v144
    v_mul_f32 v41, v145, v145
    v_mul_f32 v42, v146, v146
    v_mul_f32 v43, v147, v147
    s_waitcnt lgkmcnt(5)
    v_mfma_f32_32x32x16_bf16 v[176:191], v[80:83], a[84:87], v[176:191]
    ds_read_b128 v[72:75], v7 offset:56320
    v_mul_f32 v44, v148, v148
    v_mul_f32 v45, v149, v149
    v_mul_f32 v46, v150, v150
    v_mul_f32 v47, v151, v151
    v_fma_f32 v40, v40, v30, v28
    v_fma_f32 v41, v41, v30, v28
    s_waitcnt lgkmcnt(5)
    v_mfma_f32_32x32x16_bf16 v[176:191], v[84:87], a[88:91], v[176:191]
    buffer_load_dwordx4 a[120:123], v5, s[16:19], s41 offen offset:2048 sc1
    v_fma_f32 v42, v42, v30, v28
    v_fma_f32 v43, v43, v30, v28
    v_fma_f32 v44, v44, v30, v28
    v_fma_f32 v45, v45, v30, v28
    v_fma_f32 v46, v46, v30, v28
    s_waitcnt lgkmcnt(4)
    v_mfma_f32_32x32x16_bf16 v[176:191], v[88:91], a[92:95], v[176:191]
    ds_read_b128 v[80:83], v8 offset:0
    v_fma_f32 v47, v47, v30, v28
    v_mul_f32 v40, v40, v144
    v_mul_f32 v41, v41, v145
    v_mul_f32 v42, v42, v146
    v_mul_f32 v43, v43, v147
    v_mul_f32 v44, v44, v148
    s_waitcnt lgkmcnt(4)
    v_mfma_f32_32x32x16_bf16 v[176:191], v[92:95], a[96:99], v[176:191]
    ds_read_b128 v[84:87], v8 offset:1024
    buffer_load_dwordx4 a[124:127], v5, s[16:19], s41 offen offset:3072 sc1
    s_add_u32 s41, s41, 16384
    v_mul_f32 v45, v45, v149
    v_mul_f32 v46, v46, v150
    v_mul_f32 v47, v47, v151
    s_waitcnt lgkmcnt(4)
    v_mfma_f32_32x32x16_bf16 v[176:191], v[64:67], a[100:103], v[176:191]
    ds_read_b128 v[88:91], v8 offset:2048
    v_exp_f32 v40, v40
    v_mul_f32 v48, v144, v152
    v_exp_f32 v41, v41
    v_mul_f32 v49, v145, v153
    s_waitcnt lgkmcnt(4)
    v_mfma_f32_32x32x16_bf16 v[176:191], v[68:71], a[104:107], v[176:191]
    ds_read_b128 v[92:95], v8 offset:3072
    s_lshl_b32 s21, s3, 13
    s_add_u32 m0, s21, 36864
    s_nop 0
    buffer_load_dwordx4 v5, s[16:19], s41 offen offset:0 sc1 lds
    v_exp_f32 v42, v42
    s_waitcnt lgkmcnt(4)
    v_mfma_f32_32x32x16_bf16 v[176:191], v[72:75], a[108:111], v[176:191]
    ds_read_b128 v[64:67], v8 offset:4096
    v_mul_f32 v50, v146, v154
    v_exp_f32 v43, v43
    v_mul_f32 v51, v147, v155
    v_exp_f32 v44, v44
    s_waitcnt vmcnt(17)
    v_mfma_f32_32x32x16_bf16 v[176:191], v[108:111], v[24:27], v[176:191]
    ds_read_b128 v[68:71], v8 offset:5120
    buffer_load_dwordx4 v5, s[16:19], s41 offen offset:1024 sc1 lds
    v_mul_f32 v52, v148, v156
    v_exp_f32 v45, v45
    v_mul_f32 v53, v149, v157
    s_waitcnt lgkmcnt(5)
    v_mfma_f32_32x32x16_bf16 v[192:207], v[80:83], a[0:3], 0
    ds_read_b128 v[72:75], v8 offset:6144
    v_exp_f32 v46, v46
    v_mul_f32 v54, v150, v158
    v_exp_f32 v47, v47
    v_mul_f32 v55, v151, v159
    s_waitcnt lgkmcnt(5)
    v_mfma_f32_32x32x16_bf16 v[192:207], v[84:87], a[4:7], v[192:207]
    ds_read_b128 v[76:79], v8 offset:7168
    buffer_load_dwordx4 v5, s[16:19], s41 offen offset:2048 sc1 lds
    v_fma_f32 v40, v40, v32, v32
    v_fma_f32 v41, v41, v32, v32
    v_fma_f32 v42, v42, v32, v32
    v_fma_f32 v43, v43, v32, v32
    s_waitcnt lgkmcnt(5)
    v_mfma_f32_32x32x16_bf16 v[192:207], v[88:91], a[8:11], v[192:207]
    ds_read_b128 v[80:83], v8 offset:8192
    v_fma_f32 v44, v44, v32, v32
    v_fma_f32 v45, v45, v32, v32
    v_fma_f32 v46, v46, v32, v32
    v_fma_f32 v47, v47, v32, v32
    v_rcp_f32 v40, v40
    s_waitcnt lgkmcnt(5)
    v_mfma_f32_32x32x16_bf16 v[192:207], v[92:95], a[12:15], v[192:207]
    ds_read_b128 v[84:87], v8 offset:9216
    buffer_load_dwordx4 v5, s[16:19], s41 offen offset:3072 sc1 lds
    s_add_u32 s41, s41, 16384
    v_rcp_f32 v41, v41
    v_mul_f32 v48, v48, v40
    s_waitcnt lgkmcnt(5)
    v_mfma_f32_32x32x16_bf16 v[192:207], v[64:67], a[16:19], v[192:207]
    ds_read_b128 v[88:91], v8 offset:10240
    v_rcp_f32 v42, v42
    v_mul_f32 v49, v49, v41
    v_rcp_f32 v43, v43
    v_mul_f32 v50, v50, v42
    s_waitcnt lgkmcnt(5)
    v_mfma_f32_32x32x16_bf16 v[192:207], v[68:71], a[20:23], v[192:207]
    ds_read_b128 v[92:95], v8 offset:11264
    s_lshl_b32 s21, s3, 13
    s_add_u32 m0, s21, 40960
    s_nop 0
    buffer_load_dwordx4 v5, s[16:19], s41 offen offset:0 sc1 lds
    v_rcp_f32 v44, v44
    s_waitcnt lgkmcnt(5)
    v_mfma_f32_32x32x16_bf16 v[192:207], v[72:75], a[24:27], v[192:207]
    ds_read_b128 v[64:67], v8 offset:12288
    s_waitcnt vmcnt(22)
    s_barrier
    v_mul_f32 v51, v51, v43
    v_rcp_f32 v45, v45
    v_mul_f32 v52, v52, v44
    v_rcp_f32 v46, v46
    s_waitcnt lgkmcnt(5)
    v_mfma_f32_32x32x16_bf16 v[192:207], v[76:79], a[28:31], v[192:207]
    ds_read_b128 v[68:71], v8 offset:13312
    buffer_load_dwordx4 v5, s[16:19], s41 offen offset:1024 sc1 lds
    v_mul_f32 v53, v53, v45
    v_rcp_f32 v47, v47
    v_mul_f32 v54, v54, v46
    s_waitcnt lgkmcnt(5)
    v_mfma_f32_32x32x16_bf16 v[192:207], v[80:83], a[32:35], v[192:207]
    ds_read_b128 v[72:75], v8 offset:14336
    v_cvt_pk_bf16_f32 v60, v48, v49
    v_mul_f32 v55, v55, v47
    v_cvt_pk_bf16_f32 v61, v50, v51
    v_cvt_pk_bf16_f32 v62, v52, v53
    v_cvt_pk_bf16_f32 v63, v54, v55
    s_waitcnt lgkmcnt(5)
    v_mfma_f32_32x32x16_bf16 v[192:207], v[84:87], a[36:39], v[192:207]
    ds_read_b128 v[76:79], v8 offset:15360
    buffer_load_dwordx4 v5, s[16:19], s41 offen offset:2048 sc1 lds
    buffer_store_dwordx4 v[60:63], v9, s[16:19], s80 offen sc1
    s_add_u32 s80, s80, 24576
    v_mul_f32 v40, v160, v160
    v_mul_f32 v41, v161, v161
    s_waitcnt lgkmcnt(5)
    v_mfma_f32_32x32x16_bf16 v[192:207], v[88:91], a[40:43], v[192:207]
    ds_read_b128 v[80:83], v8 offset:16384
    v_mul_f32 v42, v162, v162
    v_mul_f32 v43, v163, v163
    v_mul_f32 v44, v164, v164
    v_mul_f32 v45, v165, v165
    v_mul_f32 v46, v166, v166
    v_mul_f32 v47, v167, v167
    s_waitcnt lgkmcnt(5)
    v_mfma_f32_32x32x16_bf16 v[192:207], v[92:95], a[44:47], v[192:207]
    ds_read_b128 v[84:87], v8 offset:17408
    buffer_load_dwordx4 v5, s[16:19], s41 offen offset:3072 sc1 lds
    s_add_u32 s41, s41, 16384
    v_fma_f32 v40, v40, v30, v28
    v_fma_f32 v41, v41, v30, v28
    v_fma_f32 v42, v42, v30, v28
    v_fma_f32 v43, v43, v30, v28
    s_waitcnt lgkmcnt(5)
    v_mfma_f32_32x32x16_bf16 v[192:207], v[64:67], a[48:51], v[192:207]
    ds_read_b128 v[88:91], v8 offset:18432
    v_fma_f32 v44, v44, v30, v28
    v_fma_f32 v45, v45, v30, v28
    v_fma_f32 v46, v46, v30, v28
    v_fma_f32 v47, v47, v30, v28
    v_mul_f32 v40, v40, v160
    v_mul_f32 v41, v41, v161
    s_waitcnt lgkmcnt(5)
    v_mfma_f32_32x32x16_bf16 v[192:207], v[68:71], a[52:55], v[192:207]
    ds_read_b128 v[92:95], v8 offset:19456
    s_lshl_b32 s21, s3, 13
    s_add_u32 m0, s21, 69632
    s_nop 0
    buffer_load_dwordx4 v5, s[16:19], s41 offen offset:0 sc1 lds
    v_mul_f32 v42, v42, v162
    v_mul_f32 v43, v43, v163
    s_waitcnt lgkmcnt(5)
    v_mfma_f32_32x32x16_bf16 v[192:207], v[72:75], a[56:59], v[192:207]
    ds_read_b128 v[64:67], v8 offset:20480
    v_mul_f32 v44, v44, v164
    v_mul_f32 v45, v45, v165
    v_mul_f32 v46, v46, v166
    v_mul_f32 v47, v47, v167
    v_exp_f32 v40, v40
    s_waitcnt lgkmcnt(5)
    v_mfma_f32_32x32x16_bf16 v[192:207], v[76:79], a[60:63], v[192:207]
    ds_read_b128 v[68:71], v8 offset:21504
    buffer_load_dwordx4 v5, s[16:19], s41 offen offset:1024 sc1 lds
    v_mul_f32 v48, v160, v168
    v_exp_f32 v41, v41
    v_mul_f32 v49, v161, v169
    s_waitcnt lgkmcnt(5)
    v_mfma_f32_32x32x16_bf16 v[192:207], v[80:83], a[64:67], v[192:207]
    ds_read_b128 v[72:75], v8 offset:22528
    v_exp_f32 v42, v42
    v_mul_f32 v50, v162, v170
    v_exp_f32 v43, v43
    v_mul_f32 v51, v163, v171
    s_waitcnt lgkmcnt(5)
    v_mfma_f32_32x32x16_bf16 v[192:207], v[84:87], a[68:71], v[192:207]
    ds_read_b128 v[76:79], v8 offset:23552
    buffer_load_dwordx4 v5, s[16:19], s41 offen offset:2048 sc1 lds
    v_exp_f32 v44, v44
    v_mul_f32 v52, v164, v172
    s_waitcnt lgkmcnt(5)
    v_mfma_f32_32x32x16_bf16 v[192:207], v[88:91], a[72:75], v[192:207]
    ds_read_b128 v[80:83], v8 offset:24576
    v_exp_f32 v45, v45
    v_mul_f32 v53, v165, v173
    v_exp_f32 v46, v46
    v_mul_f32 v54, v166, v174
    s_waitcnt lgkmcnt(5)
    v_mfma_f32_32x32x16_bf16 v[192:207], v[92:95], a[76:79], v[192:207]
    ds_read_b128 v[84:87], v8 offset:25600
    buffer_load_dwordx4 v5, s[16:19], s41 offen offset:3072 sc1 lds
    s_add_u32 s41, s41, 16384
    v_exp_f32 v47, v47
    v_mul_f32 v55, v167, v175
    v_fma_f32 v40, v40, v32, v32
    s_waitcnt lgkmcnt(5)
    v_mfma_f32_32x32x16_bf16 v[192:207], v[64:67], a[80:83], v[192:207]
    ds_read_b128 v[88:91], v8 offset:26624
    v_fma_f32 v41, v41, v32, v32
    v_fma_f32 v42, v42, v32, v32
    v_fma_f32 v43, v43, v32, v32
    v_fma_f32 v44, v44, v32, v32
    v_fma_f32 v45, v45, v32, v32
    v_fma_f32 v46, v46, v32, v32
    s_waitcnt lgkmcnt(5)
    v_mfma_f32_32x32x16_bf16 v[192:207], v[68:71], a[84:87], v[192:207]
    ds_read_b128 v[92:95], v8 offset:27648
    s_lshl_b32 s21, s3, 13
    s_add_u32 m0, s21, 73728
    s_nop 0
    buffer_load_dwordx4 v5, s[16:19], s41 offen offset:0 sc1 lds
    v_fma_f32 v47, v47, v32, v32
    s_waitcnt lgkmcnt(5)
    v_mfma_f32_32x32x16_bf16 v[192:207], v[72:75], a[88:91], v[192:207]
    v_rcp_f32 v40, v40
    v_rcp_f32 v41, v41
    v_mul_f32 v48, v48, v40
    v_rcp_f32 v42, v42
    s_waitcnt lgkmcnt(4)
    v_mfma_f32_32x32x16_bf16 v[192:207], v[76:79], a[92:95], v[192:207]
    ds_read_b128 v[68:71], v8 offset:28672
    buffer_load_dwordx4 v5, s[16:19], s41 offen offset:1024 sc1 lds
    v_mul_f32 v49, v49, v41
    v_rcp_f32 v43, v43
    v_mul_f32 v50, v50, v42
    s_waitcnt lgkmcnt(4)
    v_mfma_f32_32x32x16_bf16 v[192:207], v[80:83], a[96:99], v[192:207]
    ds_read_b128 v[72:75], v8 offset:29696
    v_rcp_f32 v44, v44
    v_mul_f32 v51, v51, v43
    v_rcp_f32 v45, v45
    v_mul_f32 v52, v52, v44
    s_waitcnt lgkmcnt(4)
    v_mfma_f32_32x32x16_bf16 v[192:207], v[84:87], a[100:103], v[192:207]
    ds_read_b128 v[76:79], v8 offset:30720
    buffer_load_dwordx4 v5, s[16:19], s41 offen offset:2048 sc1 lds
    v_rcp_f32 v46, v46
    v_mul_f32 v53, v53, v45
    s_waitcnt lgkmcnt(4)
    v_mfma_f32_32x32x16_bf16 v[192:207], v[88:91], a[104:107], v[192:207]
    ds_read_b128 v[80:83], v8 offset:31744
    buffer_load_dwordx4 v[132:135], v13, s[16:19], s40 offen sc1
    v_rcp_f32 v47, v47
    v_mul_f32 v54, v54, v46
    v_cvt_pk_bf16_f32 v56, v48, v49
    s_waitcnt lgkmcnt(4)
    v_mfma_f32_32x32x16_bf16 v[192:207], v[92:95], a[108:111], v[192:207]
    ds_read_b128 v[84:87], v8 offset:32768
    buffer_load_dwordx4 v5, s[16:19], s41 offen offset:3072 sc1 lds
    s_add_u32 s41, s41, 16384
    v_mul_f32 v55, v55, v47
    v_cvt_pk_bf16_f32 v57, v50, v51
    v_cvt_pk_bf16_f32 v58, v52, v53
    v_cvt_pk_bf16_f32 v59, v54, v55
    s_waitcnt vmcnt(33)
    v_mfma_f32_32x32x16_bf16 v[192:207], v[240:243], v[24:27], v[192:207]
    ds_read_b128 v[88:91], v8 offset:33792
    buffer_load_dwordx4 v[136:139], v14, s[16:19], s40 offen sc1
    buffer_store_dwordx4 v[56:59], v9, s[16:19], s80 offen sc1
    s_add_u32 s80, s80, 8192
    v_mul_f32 v40, v176, v176
    v_mul_f32 v41, v177, v177
    s_waitcnt lgkmcnt(5)
    v_mfma_f32_32x32x16_bf16 v[208:223], v[68:71], a[0:3], 0
    ds_read_b128 v[92:95], v8 offset:34816
    s_lshl_b32 s21, s3, 12
    s_add_u32 m0, s21, 102400
    s_nop 0
    buffer_load_dwordx4 v5, s[16:19], s41 offen offset:0 sc1 lds
    v_mul_f32 v42, v178, v178
    v_mul_f32 v43, v179, v179
    s_waitcnt lgkmcnt(5)
    v_mfma_f32_32x32x16_bf16 v[208:223], v[72:75], a[4:7], v[208:223]
    ds_read_b128 v[64:67], v8 offset:35840
    buffer_load_dwordx4 v[140:143], v15, s[16:19], s40 offen sc1
    v_mul_f32 v44, v180, v180
    v_mul_f32 v45, v181, v181
    v_mul_f32 v46, v182, v182
    v_mul_f32 v47, v183, v183
    s_waitcnt lgkmcnt(5)
    v_mfma_f32_32x32x16_bf16 v[208:223], v[76:79], a[8:11], v[208:223]
    ds_read_b128 v[68:71], v8 offset:36864
    buffer_load_dwordx4 v5, s[16:19], s41 offen offset:1024 sc1 lds
    v_fma_f32 v40, v40, v30, v28
    v_fma_f32 v41, v41, v30, v28
    v_fma_f32 v42, v42, v30, v28
    v_fma_f32 v43, v43, v30, v28
    s_waitcnt lgkmcnt(5)
    v_mfma_f32_32x32x16_bf16 v[208:223], v[80:83], a[12:15], v[208:223]
    ds_read_b128 v[72:75], v8 offset:37888
    buffer_load_dwordx4 v[128:131], v12, s[16:19], s40 offen sc1
    s_add_u32 s40, s40, 4096
    v_fma_f32 v44, v44, v30, v28
    v_fma_f32 v45, v45, v30, v28
    v_fma_f32 v46, v46, v30, v28
    v_fma_f32 v47, v47, v30, v28
    s_waitcnt lgkmcnt(5)
    v_mfma_f32_32x32x16_bf16 v[208:223], v[84:87], a[16:19], v[208:223]
    ds_read_b128 v[76:79], v8 offset:38912
    buffer_load_dwordx4 v5, s[16:19], s41 offen offset:2048 sc1 lds
    v_mul_f32 v40, v40, v176
    v_mul_f32 v41, v41, v177
    v_mul_f32 v42, v42, v178
    v_mul_f32 v43, v43, v179
    s_waitcnt lgkmcnt(5)
    v_mfma_f32_32x32x16_bf16 v[208:223], v[88:91], a[20:23], v[208:223]
    ds_read_b128 v[80:83], v8 offset:39936
    buffer_load_dwordx4 v[148:151], v13, s[16:19], s40 offen sc1
    v_mul_f32 v44, v44, v180
    v_mul_f32 v45, v45, v181
    v_mul_f32 v46, v46, v182
    v_mul_f32 v47, v47, v183
    s_waitcnt lgkmcnt(5)
    v_mfma_f32_32x32x16_bf16 v[208:223], v[92:95], a[24:27], v[208:223]
    ds_read_b128 v[84:87], v8 offset:40960
    buffer_load_dwordx4 v5, s[16:19], s41 offen offset:3072 sc1 lds
    v_exp_f32 v40, v40
    v_mul_f32 v48, v176, v184
    s_waitcnt lgkmcnt(5)
    v_mfma_f32_32x32x16_bf16 v[208:223], v[64:67], a[28:31], v[208:223]
    ds_read_b128 v[88:91], v8 offset:41984
    buffer_load_dwordx4 v[152:155], v14, s[16:19], s40 offen sc1
    v_exp_f32 v41, v41
    v_mul_f32 v49, v177, v185
    s_waitcnt lgkmcnt(5)
    v_mfma_f32_32x32x16_bf16 v[208:223], v[68:71], a[32:35], v[208:223]
    ds_read_b128 v[92:95], v8 offset:43008
    v_exp_f32 v42, v42
    v_mul_f32 v50, v178, v186
    v_exp_f32 v43, v43
    v_mul_f32 v51, v179, v187
    s_waitcnt lgkmcnt(5)
    v_mfma_f32_32x32x16_bf16 v[208:223], v[72:75], a[36:39], v[208:223]
    ds_read_b128 v[64:67], v8 offset:44032
    buffer_load_dwordx4 v[156:159], v15, s[16:19], s40 offen sc1
    v_exp_f32 v44, v44
    v_mul_f32 v52, v180, v188
    s_waitcnt lgkmcnt(5)
    v_mfma_f32_32x32x16_bf16 v[208:223], v[76:79], a[40:43], v[208:223]
    ds_read_b128 v[68:71], v8 offset:45056
    v_exp_f32 v45, v45
    v_mul_f32 v53, v181, v189
    v_exp_f32 v46, v46
    v_mul_f32 v54, v182, v190
    s_waitcnt lgkmcnt(5)
    v_mfma_f32_32x32x16_bf16 v[208:223], v[80:83], a[44:47], v[208:223]
    ds_read_b128 v[72:75], v8 offset:46080
    buffer_load_dwordx4 v[144:147], v12, s[16:19], s40 offen sc1
    s_add_u32 s40, s40, 4096
    v_exp_f32 v47, v47
    v_mul_f32 v55, v183, v191
    v_fma_f32 v40, v40, v32, v32
    s_waitcnt lgkmcnt(5)
    v_mfma_f32_32x32x16_bf16 v[208:223], v[84:87], a[48:51], v[208:223]
    ds_read_b128 v[76:79], v8 offset:47104
    v_fma_f32 v41, v41, v32, v32
    v_fma_f32 v42, v42, v32, v32
    v_fma_f32 v43, v43, v32, v32
    v_fma_f32 v44, v44, v32, v32
    v_fma_f32 v45, v45, v32, v32
    v_fma_f32 v46, v46, v32, v32
    s_waitcnt lgkmcnt(5)
    v_mfma_f32_32x32x16_bf16 v[208:223], v[88:91], a[52:55], v[208:223]
    ds_read_b128 v[80:83], v8 offset:48128
    v_fma_f32 v47, v47, v32, v32
    v_rcp_f32 v40, v40
    v_rcp_f32 v41, v41
    v_mul_f32 v48, v48, v40
    s_waitcnt lgkmcnt(5)
    v_mfma_f32_32x32x16_bf16 v[208:223], v[92:95], a[56:59], v[208:223]
    ds_read_b128 v[84:87], v5 offset:0
    v_rcp_f32 v42, v42
    v_mul_f32 v49, v49, v41
    v_rcp_f32 v43, v43
    v_mul_f32 v50, v50, v42
    s_waitcnt lgkmcnt(5)
    v_mfma_f32_32x32x16_bf16 v[208:223], v[64:67], a[60:63], v[208:223]
    ds_read_b128 v[88:91], v5 offset:1024
    buffer_load_dwordx4 v[164:167], v13, s[16:19], s40 offen sc1
    v_rcp_f32 v44, v44
    v_mul_f32 v51, v51, v43
    s_waitcnt lgkmcnt(5)
    v_mfma_f32_32x32x16_bf16 v[208:223], v[68:71], a[64:67], v[208:223]
    ds_read_b128 v[92:95], v5 offset:2048
    v_rcp_f32 v45, v45
    v_mul_f32 v52, v52, v44
    v_rcp_f32 v46, v46
    v_mul_f32 v53, v53, v45
    s_waitcnt lgkmcnt(5)
    v_mfma_f32_32x32x16_bf16 v[208:223], v[72:75], a[68:71], v[208:223]
    ds_read_b128 v[64:67], v5 offset:3072
    buffer_load_dwordx4 v[168:171], v14, s[16:19], s40 offen sc1
    v_rcp_f32 v47, v47
    v_mul_f32 v54, v54, v46
    v_cvt_pk_bf16_f32 v60, v48, v49
    s_waitcnt lgkmcnt(5)
    v_mfma_f32_32x32x16_bf16 v[208:223], v[76:79], a[72:75], v[208:223]
    ds_read_b128 v[68:71], v5 offset:4096
    v_mul_f32 v55, v55, v47
    v_cvt_pk_bf16_f32 v61, v50, v51
    v_cvt_pk_bf16_f32 v62, v52, v53
    v_cvt_pk_bf16_f32 v63, v54, v55
    buffer_store_dwordx4 v[60:63], v9, s[16:19], s80 offen sc1
    s_add_u32 s80, s80, 24576
    s_waitcnt lgkmcnt(5)
    v_mfma_f32_32x32x16_bf16 v[208:223], v[80:83], a[76:79], v[208:223]
    ds_read_b128 v[72:75], v5 offset:5120
    buffer_load_dwordx4 v[172:175], v15, s[16:19], s40 offen sc1
    v_mul_f32 v40, v192, v192
    v_mul_f32 v41, v193, v193
    v_mul_f32 v42, v194, v194
    v_mul_f32 v43, v195, v195
    s_waitcnt lgkmcnt(5)
    v_mfma_f32_32x32x16_bf16 v[208:223], v[84:87], a[80:83], v[208:223]
    ds_read_b128 v[76:79], v5 offset:6144
    v_mul_f32 v44, v196, v196
    v_mul_f32 v45, v197, v197
    v_mul_f32 v46, v198, v198
    v_mul_f32 v47, v199, v199
    v_fma_f32 v40, v40, v30, v28
    v_fma_f32 v41, v41, v30, v28
    s_waitcnt lgkmcnt(5)
    v_mfma_f32_32x32x16_bf16 v[208:223], v[88:91], a[84:87], v[208:223]
    ds_read_b128 v[80:83], v5 offset:7168
    buffer_load_dwordx4 v[160:163], v12, s[16:19], s40 offen sc1
    s_add_u32 s40, s40, 4096
    v_fma_f32 v42, v42, v30, v28
    v_fma_f32 v43, v43, v30, v28
    v_fma_f32 v44, v44, v30, v28
    v_fma_f32 v45, v45, v30, v28
    s_waitcnt lgkmcnt(5)
    v_mfma_f32_32x32x16_bf16 v[208:223], v[92:95], a[88:91], v[208:223]
    v_fma_f32 v46, v46, v30, v28
    v_fma_f32 v47, v47, v30, v28
    v_mul_f32 v40, v40, v192
    v_mul_f32 v41, v41, v193
    v_mul_f32 v42, v42, v194
    v_mul_f32 v43, v43, v195
    v_mul_f32 v44, v44, v196
    s_waitcnt lgkmcnt(4)
    v_mfma_f32_32x32x16_bf16 v[208:223], v[64:67], a[92:95], v[208:223]
    ds_read_b128 v[88:91], v5 offset:8192
    buffer_load_dwordx4 v[100:103], v13, s[16:19], s40 offen sc1
    v_mul_f32 v45, v45, v197
    v_mul_f32 v46, v46, v198
    v_mul_f32 v47, v47, v199
    s_waitcnt lgkmcnt(4)
    v_mfma_f32_32x32x16_bf16 v[208:223], v[68:71], a[96:99], v[208:223]
    ds_read_b128 v[92:95], v5 offset:9216
    v_exp_f32 v40, v40
    v_mul_f32 v48, v192, v200
    v_exp_f32 v41, v41
    v_mul_f32 v49, v193, v201
    s_waitcnt lgkmcnt(4)
    v_mfma_f32_32x32x16_bf16 v[208:223], v[72:75], a[100:103], v[208:223]
    ds_read_b128 v[64:67], v5 offset:10240
    buffer_load_dwordx4 v[104:107], v14, s[16:19], s40 offen sc1
    v_exp_f32 v42, v42
    v_mul_f32 v50, v194, v202
    s_waitcnt lgkmcnt(4)
    v_mfma_f32_32x32x16_bf16 v[208:223], v[76:79], a[104:107], v[208:223]
    ds_read_b128 v[68:71], v5 offset:11264
    v_exp_f32 v43, v43
    v_mul_f32 v51, v195, v203
    v_exp_f32 v44, v44
    v_mul_f32 v52, v196, v204
    s_waitcnt lgkmcnt(4)
    v_mfma_f32_32x32x16_bf16 v[208:223], v[80:83], a[108:111], v[208:223]
    ds_read_b128 v[72:75], v5 offset:12288
    buffer_load_dwordx4 v[108:111], v15, s[16:19], s40 offen sc1
    v_exp_f32 v45, v45
    v_mul_f32 v53, v197, v205
    s_waitcnt vmcnt(52)
    v_mfma_f32_32x32x16_bf16 v[208:223], v[244:247], v[24:27], v[208:223]
    ds_read_b128 v[76:79], v5 offset:13312
    v_exp_f32 v46, v46
    v_mul_f32 v54, v198, v206
    v_exp_f32 v47, v47
    v_mul_f32 v55, v199, v207
    s_waitcnt lgkmcnt(5)
    v_mfma_f32_32x32x16_bf16 v[224:239], v[88:91], a[0:3], 0
    ds_read_b128 v[80:83], v5 offset:14336
    buffer_load_dwordx4 v[96:99], v12, s[16:19], s40 offen sc1
    s_add_u32 s40, s40, 20480
    v_fma_f32 v40, v40, v32, v32
    v_fma_f32 v41, v41, v32, v32
    v_fma_f32 v42, v42, v32, v32
    v_fma_f32 v43, v43, v32, v32
    s_waitcnt lgkmcnt(5)
    v_mfma_f32_32x32x16_bf16 v[224:239], v[92:95], a[4:7], v[224:239]
    ds_read_b128 v[84:87], v5 offset:15360
    v_fma_f32 v44, v44, v32, v32
    v_fma_f32 v45, v45, v32, v32
    v_fma_f32 v46, v46, v32, v32
    v_fma_f32 v47, v47, v32, v32
    v_rcp_f32 v40, v40
    s_waitcnt lgkmcnt(5)
    v_mfma_f32_32x32x16_bf16 v[224:239], v[64:67], a[8:11], v[224:239]
    ds_read_b128 v[88:91], v5 offset:16384
    v_rcp_f32 v41, v41
    v_mul_f32 v48, v48, v40
    v_rcp_f32 v42, v42
    v_mul_f32 v49, v49, v41
    s_waitcnt lgkmcnt(5)
    v_mfma_f32_32x32x16_bf16 v[224:239], v[68:71], a[12:15], v[224:239]
    ds_read_b128 v[92:95], v5 offset:17408
    v_rcp_f32 v43, v43
    v_mul_f32 v50, v50, v42
    v_rcp_f32 v44, v44
    v_mul_f32 v51, v51, v43
    s_waitcnt lgkmcnt(5)
    v_mfma_f32_32x32x16_bf16 v[224:239], v[72:75], a[16:19], v[224:239]
    ds_read_b128 v[64:67], v5 offset:18432
    v_rcp_f32 v45, v45
    v_mul_f32 v52, v52, v44
    v_rcp_f32 v46, v46
    v_mul_f32 v53, v53, v45
    s_waitcnt lgkmcnt(5)
    v_mfma_f32_32x32x16_bf16 v[224:239], v[76:79], a[20:23], v[224:239]
    ds_read_b128 v[68:71], v5 offset:19456
    buffer_load_dwordx4 v[180:183], v13, s[16:19], s40 offen sc1
    v_rcp_f32 v47, v47
    v_mul_f32 v54, v54, v46
    v_cvt_pk_bf16_f32 v56, v48, v49
    s_waitcnt lgkmcnt(5)
    v_mfma_f32_32x32x16_bf16 v[224:239], v[80:83], a[24:27], v[224:239]
    ds_read_b128 v[72:75], v5 offset:20480
    v_mul_f32 v55, v55, v47
    v_cvt_pk_bf16_f32 v57, v50, v51
    v_cvt_pk_bf16_f32 v58, v52, v53
    v_cvt_pk_bf16_f32 v59, v54, v55
    buffer_store_dwordx4 v[56:59], v9, s[16:19], s80 offen sc1
    s_add_u32 s80, s80, 8192
    s_waitcnt lgkmcnt(5)
    v_mfma_f32_32x32x16_bf16 v[224:239], v[84:87], a[28:31], v[224:239]
    ds_read_b128 v[76:79], v5 offset:21504
    buffer_load_dwordx4 v[184:187], v14, s[16:19], s40 offen sc1
    v_mul_f32 v40, v208, v208
    v_mul_f32 v41, v209, v209
    v_mul_f32 v42, v210, v210
    v_mul_f32 v43, v211, v211
    s_waitcnt lgkmcnt(5)
    v_mfma_f32_32x32x16_bf16 v[224:239], v[88:91], a[32:35], v[224:239]
    ds_read_b128 v[80:83], v5 offset:22528
    v_mul_f32 v44, v212, v212
    v_mul_f32 v45, v213, v213
    v_mul_f32 v46, v214, v214
    v_mul_f32 v47, v215, v215
    v_fma_f32 v40, v40, v30, v28
    v_fma_f32 v41, v41, v30, v28
    s_waitcnt lgkmcnt(5)
    v_mfma_f32_32x32x16_bf16 v[224:239], v[92:95], a[36:39], v[224:239]
    ds_read_b128 v[84:87], v5 offset:23552
    buffer_load_dwordx4 v[188:191], v15, s[16:19], s40 offen sc1
    v_fma_f32 v42, v42, v30, v28
    v_fma_f32 v43, v43, v30, v28
    v_fma_f32 v44, v44, v30, v28
    v_fma_f32 v45, v45, v30, v28
    s_waitcnt lgkmcnt(5)
    v_mfma_f32_32x32x16_bf16 v[224:239], v[64:67], a[40:43], v[224:239]
    ds_read_b128 v[88:91], v5 offset:24576
    v_fma_f32 v46, v46, v30, v28
    v_fma_f32 v47, v47, v30, v28
    v_mul_f32 v40, v40, v208
    v_mul_f32 v41, v41, v209
    v_mul_f32 v42, v42, v210
    v_mul_f32 v43, v43, v211
    s_waitcnt lgkmcnt(5)
    v_mfma_f32_32x32x16_bf16 v[224:239], v[68:71], a[44:47], v[224:239]
    ds_read_b128 v[92:95], v5 offset:25600
    buffer_load_dwordx4 v[176:179], v12, s[16:19], s40 offen sc1
    s_add_u32 s40, s40, 4096
    v_mul_f32 v44, v44, v212
    v_mul_f32 v45, v45, v213
    v_mul_f32 v46, v46, v214
    v_mul_f32 v47, v47, v215
    s_waitcnt lgkmcnt(5)
    v_mfma_f32_32x32x16_bf16 v[224:239], v[72:75], a[48:51], v[224:239]
    ds_read_b128 v[64:67], v5 offset:26624
    v_exp_f32 v40, v40
    v_mul_f32 v48, v208, v216
    v_exp_f32 v41, v41
    v_mul_f32 v49, v209, v217
    s_waitcnt lgkmcnt(5)
    v_mfma_f32_32x32x16_bf16 v[224:239], v[76:79], a[52:55], v[224:239]
    ds_read_b128 v[68:71], v5 offset:27648
    buffer_load_dwordx4 v[196:199], v13, s[16:19], s40 offen sc1
    v_exp_f32 v42, v42
    v_mul_f32 v50, v210, v218
    s_waitcnt lgkmcnt(5)
    v_mfma_f32_32x32x16_bf16 v[224:239], v[80:83], a[56:59], v[224:239]
    ds_read_b128 v[72:75], v5 offset:28672
    v_exp_f32 v43, v43
    v_mul_f32 v51, v211, v219
    v_exp_f32 v44, v44
    v_mul_f32 v52, v212, v220
    s_waitcnt lgkmcnt(5)
    v_mfma_f32_32x32x16_bf16 v[224:239], v[84:87], a[60:63], v[224:239]
    ds_read_b128 v[76:79], v5 offset:29696
    buffer_load_dwordx4 v[200:203], v14, s[16:19], s40 offen sc1
    v_exp_f32 v45, v45
    v_mul_f32 v53, v213, v221
    s_waitcnt lgkmcnt(5)
    v_mfma_f32_32x32x16_bf16 v[224:239], v[88:91], a[64:67], v[224:239]
    ds_read_b128 v[80:83], v5 offset:30720
    v_exp_f32 v46, v46
    v_mul_f32 v54, v214, v222
    v_exp_f32 v47, v47
    v_mul_f32 v55, v215, v223
    s_waitcnt lgkmcnt(5)
    v_mfma_f32_32x32x16_bf16 v[224:239], v[92:95], a[68:71], v[224:239]
    ds_read_b128 v[84:87], v5 offset:31744
    buffer_load_dwordx4 v[204:207], v15, s[16:19], s40 offen sc1
    v_fma_f32 v40, v40, v32, v32
    v_fma_f32 v41, v41, v32, v32
    v_fma_f32 v42, v42, v32, v32
    v_fma_f32 v43, v43, v32, v32
    s_waitcnt lgkmcnt(5)
    v_mfma_f32_32x32x16_bf16 v[224:239], v[64:67], a[72:75], v[224:239]
    ds_read_b128 v[88:91], v5 offset:32768
    v_fma_f32 v44, v44, v32, v32
    v_fma_f32 v45, v45, v32, v32
    v_fma_f32 v46, v46, v32, v32
    v_fma_f32 v47, v47, v32, v32
    v_rcp_f32 v40, v40
    s_waitcnt lgkmcnt(5)
    v_mfma_f32_32x32x16_bf16 v[224:239], v[68:71], a[76:79], v[224:239]
    ds_read_b128 v[92:95], v5 offset:33792
    buffer_load_dwordx4 v[192:195], v12, s[16:19], s40 offen sc1
    s_add_u32 s40, s40, 4096
    v_rcp_f32 v41, v41
    v_mul_f32 v48, v48, v40
    s_waitcnt lgkmcnt(5)
    v_mfma_f32_32x32x16_bf16 v[224:239], v[72:75], a[80:83], v[224:239]
    ds_read_b128 v[64:67], v5 offset:34816
    v_rcp_f32 v42, v42
    v_mul_f32 v49, v49, v41
    v_rcp_f32 v43, v43
    v_mul_f32 v50, v50, v42
    s_waitcnt lgkmcnt(5)
    v_mfma_f32_32x32x16_bf16 v[224:239], v[76:79], a[84:87], v[224:239]
    ds_read_b128 v[68:71], v5 offset:35840
    v_rcp_f32 v44, v44
    v_mul_f32 v51, v51, v43
    v_rcp_f32 v45, v45
    v_mul_f32 v52, v52, v44
    s_waitcnt lgkmcnt(5)
    v_mfma_f32_32x32x16_bf16 v[224:239], v[80:83], a[88:91], v[224:239]
    v_rcp_f32 v46, v46
    v_mul_f32 v53, v53, v45
    v_rcp_f32 v47, v47
    v_mul_f32 v54, v54, v46
    v_cvt_pk_bf16_f32 v60, v48, v49
    s_waitcnt lgkmcnt(4)
    v_mfma_f32_32x32x16_bf16 v[224:239], v[84:87], a[92:95], v[224:239]
    v_mul_f32 v55, v55, v47
    v_cvt_pk_bf16_f32 v61, v50, v51
    v_cvt_pk_bf16_f32 v62, v52, v53
    v_cvt_pk_bf16_f32 v63, v54, v55
    buffer_store_dwordx4 v[60:63], v9, s[16:19], s80 offen sc1
    s_add_u32 s80, s80, 24576
    s_waitcnt lgkmcnt(3)
    v_mfma_f32_32x32x16_bf16 v[224:239], v[88:91], a[96:99], v[224:239]
    s_waitcnt lgkmcnt(2)
    v_mfma_f32_32x32x16_bf16 v[224:239], v[92:95], a[100:103], v[224:239]
    s_waitcnt lgkmcnt(1)
    v_mfma_f32_32x32x16_bf16 v[224:239], v[64:67], a[104:107], v[224:239]
    s_waitcnt lgkmcnt(0)
    v_mfma_f32_32x32x16_bf16 v[224:239], v[68:71], a[108:111], v[224:239]
    s_waitcnt vmcnt(62)
    v_mfma_f32_32x32x16_bf16 v[224:239], v[248:251], v[24:27], v[224:239]
    s_nop 11
    v_pk_mul_f32 v[40:41], v[224:225], v[224:225]
    v_pk_mul_f32 v[42:43], v[226:227], v[226:227]
    v_pk_mul_f32 v[44:45], v[228:229], v[228:229]
    v_pk_mul_f32 v[46:47], v[230:231], v[230:231]
    v_pk_fma_f32 v[40:41], v[40:41], v[30:31], v[28:29]
    v_pk_fma_f32 v[42:43], v[42:43], v[30:31], v[28:29]
    v_pk_fma_f32 v[44:45], v[44:45], v[30:31], v[28:29]
    v_pk_fma_f32 v[46:47], v[46:47], v[30:31], v[28:29]
    v_pk_mul_f32 v[40:41], v[40:41], v[224:225]
    v_pk_mul_f32 v[42:43], v[42:43], v[226:227]
    v_pk_mul_f32 v[44:45], v[44:45], v[228:229]
    v_pk_mul_f32 v[46:47], v[46:47], v[230:231]
    v_exp_f32 v40, v40
    v_exp_f32 v41, v41
    v_exp_f32 v42, v42
    v_exp_f32 v43, v43
    v_exp_f32 v44, v44
    v_exp_f32 v45, v45
    v_exp_f32 v46, v46
    v_exp_f32 v47, v47
    v_pk_mul_f32 v[48:49], v[224:225], v[232:233]
    v_pk_mul_f32 v[50:51], v[226:227], v[234:235]
    v_pk_mul_f32 v[52:53], v[228:229], v[236:237]
    v_pk_mul_f32 v[54:55], v[230:231], v[238:239]
    v_pk_fma_f32 v[40:41], v[40:41], v[32:33], v[32:33]
    v_pk_fma_f32 v[42:43], v[42:43], v[32:33], v[32:33]
    v_pk_fma_f32 v[44:45], v[44:45], v[32:33], v[32:33]
    v_pk_fma_f32 v[46:47], v[46:47], v[32:33], v[32:33]
    v_rcp_f32 v40, v40
    v_rcp_f32 v41, v41
    v_rcp_f32 v42, v42
    v_rcp_f32 v43, v43
    v_rcp_f32 v44, v44
    v_rcp_f32 v45, v45
    v_rcp_f32 v46, v46
    v_rcp_f32 v47, v47
    s_nop 0
    v_pk_mul_f32 v[48:49], v[48:49], v[40:41]
    v_pk_mul_f32 v[50:51], v[50:51], v[42:43]
    v_pk_mul_f32 v[52:53], v[52:53], v[44:45]
    v_pk_mul_f32 v[54:55], v[54:55], v[46:47]
    v_cvt_pk_bf16_f32 v56, v48, v49
    v_cvt_pk_bf16_f32 v57, v50, v51
    v_cvt_pk_bf16_f32 v58, v52, v53
    v_cvt_pk_bf16_f32 v59, v54, v55
    buffer_store_dwordx4 v[56:59], v9, s[16:19], s80 offen sc1
    s_cmp_eq_u32 s8, 7
    s_cbranch_scc1 k3_fin
    s_mov_b32 s48, s44
    s_and_b32 s49, s45, 0xffff
    s_mov_b32 s50, 0x1c0000
    s_mov_b32 s51, 0x00020000
    buffer_load_dwordx4 v[84:87], v13, s[16:19], s40 offen sc1
    buffer_load_dwordx4 v[88:91], v14, s[16:19], s40 offen sc1
    buffer_load_dwordx4 v[92:95], v15, s[16:19], s40 offen sc1
    buffer_load_dwordx4 v[80:83], v12, s[16:19], s40 offen sc1
    s_add_u32 s40, s40, 4096
    s_waitcnt vmcnt(30)
    v_max3_u32 v1, v128, v132, v136
    v_max_u32 v1, v1, v140
    v_cmp_eq_u32 vcc, -1, v1
    s_lshl_b32 s21, s3, 13
    s_add_u32 s21, s21, 36864
    v_add_u32 v7, s21, v5
    s_waitcnt vmcnt(50)
    ds_read_b128 a[0:3], v7 offset:0
    ds_read_b128 a[4:7], v7 offset:1024
    ds_read_b128 a[8:11], v7 offset:2048
    ds_read_b128 a[12:15], v7 offset:3072
    s_waitcnt vmcnt(45)
    ds_read_b128 a[16:19], v7 offset:4096
    ds_read_b128 a[20:23], v7 offset:5120
    ds_read_b128 a[24:27], v7 offset:6144
    ds_read_b128 a[28:31], v7 offset:7168
    s_waitcnt vmcnt(41)
    ds_read_b128 a[32:35], v7 offset:32768
    ds_read_b128 a[36:39], v7 offset:33792
    ds_read_b128 a[40:43], v7 offset:34816
    ds_read_b128 a[44:47], v7 offset:35840
    s_waitcnt vmcnt(36)
    ds_read_b128 a[48:51], v7 offset:36864
    ds_read_b128 a[52:55], v7 offset:37888
    ds_read_b128 a[56:59], v7 offset:38912
    ds_read_b128 a[60:63], v7 offset:39936
    s_lshl_b32 s21, s3, 12
    s_add_u32 s21, s21, 102400
    v_add_u32 v8, s21, v5
    s_waitcnt vmcnt(27)
    ds_read_b128 a[64:67], v8 offset:0
    ds_read_b128 a[68:71], v8 offset:1024
    ds_read_b128 a[72:75], v8 offset:2048
    ds_read_b128 a[76:79], v8 offset:3072
    s_cbranch_vccnz rt_35
rb_36:
    s_waitcnt vmcnt(63)
    v_mfma_f32_16x16x32_bf16 v[224:227], a[128:131], v[132:135], 0
    s_waitcnt vmcnt(63)
    v_mfma_f32_16x16x32_bf16 v[228:231], a[132:135], v[132:135], 0
    buffer_load_dwordx4 v[20:23], v13, s[16:19], s40 offen sc1
    s_waitcnt vmcnt(63)
    v_mfma_f32_16x16x32_bf16 v[232:235], a[136:139], v[132:135], 0
    s_waitcnt vmcnt(63)
    v_mfma_f32_16x16x32_bf16 v[236:239], a[140:143], v[132:135], 0
    buffer_load_dwordx4 v[24:27], v14, s[16:19], s40 offen sc1
    v_mfma_f32_16x16x32_bf16 v[240:243], a[128:131], v[136:139], 0
    v_mfma_f32_16x16x32_bf16 v[244:247], a[132:135], v[136:139], 0
    buffer_load_dwordx4 v[28:31], v15, s[16:19], s40 offen sc1
    v_mfma_f32_16x16x32_bf16 v[248:251], a[136:139], v[136:139], 0
    v_mfma_f32_16x16x32_bf16 v[252:255], a[140:143], v[136:139], 0
    buffer_load_dwordx4 v[16:19], v12, s[16:19], s40 offen sc1
    s_add_u32 s40, s40, 20480
    v_mfma_f32_16x16x32_bf16 v[64:67], a[128:131], v[140:143], 0
    v_mfma_f32_16x16x32_bf16 v[68:71], a[132:135], v[140:143], 0
    buffer_load_dwordx4 v[44:47], v13, s[16:19], s40 offen sc1
    v_mfma_f32_16x16x32_bf16 v[72:75], a[136:139], v[140:143], 0
    s_waitcnt vmcnt(29)
    v_max3_u32 v1, v144, v148, v152
    v_mfma_f32_16x16x32_bf16 v[76:79], a[140:143], v[140:143], 0
    v_max_u32 v1, v1, v156
    buffer_load_dwordx4 v[48:51], v14, s[16:19], s40 offen sc1
    v_mfma_f32_16x16x32_bf16 v[208:211], a[128:131], v[128:131], 0
    v_cmp_eq_u32 vcc, -1, v1
    v_mfma_f32_16x16x32_bf16 v[212:215], a[132:135], v[128:131], 0
    buffer_load_dwordx4 v[52:55], v15, s[16:19], s40 offen sc1
    v_mfma_f32_16x16x32_bf16 v[216:219], a[136:139], v[128:131], 0
    v_mfma_f32_16x16x32_bf16 v[220:223], a[140:143], v[128:131], 0
    s_cbranch_vccnz rt_37
rb_38:
    buffer_load_dwordx4 v[40:43], v12, s[16:19], s40 offen sc1
    s_add_u32 s40, s40, 4096
    s_waitcnt vmcnt(63)
    v_mfma_f32_16x16x32_bf16 v[224:227], a[144:147], v[148:151], v[224:227]
    s_waitcnt vmcnt(63)
    v_mfma_f32_16x16x32_bf16 v[228:231], a[148:151], v[148:151], v[228:231]
    buffer_load_dwordx4 v[132:135], v13, s[16:19], s40 offen sc1
    s_waitcnt vmcnt(63)
    v_mfma_f32_16x16x32_bf16 v[232:235], a[152:155], v[148:151], v[232:235]
    s_waitcnt vmcnt(63)
    v_mfma_f32_16x16x32_bf16 v[236:239], a[156:159], v[148:151], v[236:239]
    buffer_load_dwordx4 v[136:139], v14, s[16:19], s40 offen sc1
    v_mfma_f32_16x16x32_bf16 v[240:243], a[144:147], v[152:155], v[240:243]
    v_mfma_f32_16x16x32_bf16 v[244:247], a[148:151], v[152:155], v[244:247]
    buffer_load_dwordx4 v[140:143], v15, s[16:19], s40 offen sc1
    v_mfma_f32_16x16x32_bf16 v[248:251], a[152:155], v[152:155], v[248:251]
    v_mfma_f32_16x16x32_bf16 v[252:255], a[156:159], v[152:155], v[252:255]
    buffer_load_dwordx4 v[128:131], v12, s[16:19], s40 offen sc1
    s_add_u32 s40, s40, 4096
    v_mfma_f32_16x16x32_bf16 v[64:67], a[144:147], v[156:159], v[64:67]
    v_mfma_f32_16x16x32_bf16 v[68:71], a[148:151], v[156:159], v[68:71]
    v_mfma_f32_16x16x32_bf16 v[72:75], a[152:155], v[156:159], v[72:75]
    s_waitcnt vmcnt(31)
    v_max3_u32 v1, v160, v164, v168
    v_mfma_f32_16x16x32_bf16 v[76:79], a[156:159], v[156:159], v[76:79]
    v_max_u32 v1, v1, v172
    v_mfma_f32_16x16x32_bf16 v[208:211], a[144:147], v[144:147], v[208:211]
    v_cmp_eq_u32 vcc, -1, v1
    v_mfma_f32_16x16x32_bf16 v[212:215], a[148:151], v[144:147], v[212:215]
    v_mfma_f32_16x16x32_bf16 v[216:219], a[152:155], v[144:147], v[216:219]
    v_mfma_f32_16x16x32_bf16 v[220:223], a[156:159], v[144:147], v[220:223]
    s_cbranch_vccnz rt_39
rb_40:
    s_waitcnt vmcnt(63)
    v_mfma_f32_16x16x32_bf16 v[224:227], a[160:163], v[164:167], v[224:227]
    s_waitcnt vmcnt(63)
    v_mfma_f32_16x16x32_bf16 v[228:231], a[164:167], v[164:167], v[228:231]
    buffer_load_dwordx4 v[148:151], v13, s[16:19], s40 offen sc1
    s_waitcnt vmcnt(63)
    v_mfma_f32_16x16x32_bf16 v[232:235], a[168:171], v[164:167], v[232:235]
    s_waitcnt vmcnt(63)
    v_mfma_f32_16x16x32_bf16 v[236:239], a[172:175], v[164:167], v[236:239]
    buffer_load_dwordx4 v[152:155], v14, s[16:19], s40 offen sc1
    v_mfma_f32_16x16x32_bf16 v[240:243], a[160:163], v[168:171], v[240:243]
    v_mfma_f32_16x16x32_bf16 v[244:247], a[164:167], v[168:171], v[244:247]
    buffer_load_dwordx4 v[156:159], v15, s[16:19], s40 offen sc1
    v_mfma_f32_16x16x32_bf16 v[248:251], a[168:171], v[168:171], v[248:251]
    v_mfma_f32_16x16x32_bf16 v[252:255], a[172:175], v[168:171], v[252:255]
    buffer_load_dwordx4 v[144:147], v12, s[16:19], s40 offen sc1
    s_add_u32 s40, s40, 4096
    v_mfma_f32_16x16x32_bf16 v[64:67], a[160:163], v[172:175], v[64:67]
    v_mfma_f32_16x16x32_bf16 v[68:71], a[164:167], v[172:175], v[68:71]
    v_mfma_f32_16x16x32_bf16 v[72:75], a[168:171], v[172:175], v[72:75]
    s_waitcnt vmcnt(31)
    v_max3_u32 v1, v96, v100, v104
    v_mfma_f32_16x16x32_bf16 v[76:79], a[172:175], v[172:175], v[76:79]
    v_max_u32 v1, v1, v108
    v_mfma_f32_16x16x32_bf16 v[208:211], a[160:163], v[160:163], v[208:211]
    v_cmp_eq_u32 vcc, -1, v1
    v_mfma_f32_16x16x32_bf16 v[212:215], a[164:167], v[160:163], v[212:215]
    v_mfma_f32_16x16x32_bf16 v[216:219], a[168:171], v[160:163], v[216:219]
    v_mfma_f32_16x16x32_bf16 v[220:223], a[172:175], v[160:163], v[220:223]
    s_cbranch_vccnz rt_41
rb_42:
    s_waitcnt vmcnt(63)
    v_mfma_f32_16x16x32_bf16 v[224:227], a[176:179], v[100:103], v[224:227]
    s_waitcnt vmcnt(63)
    v_mfma_f32_16x16x32_bf16 v[228:231], a[180:183], v[100:103], v[228:231]
    buffer_load_dwordx4 v[164:167], v13, s[16:19], s40 offen sc1
    s_waitcnt vmcnt(63)
    v_mfma_f32_16x16x32_bf16 v[232:235], a[184:187], v[100:103], v[232:235]
    s_waitcnt vmcnt(63)
    v_mfma_f32_16x16x32_bf16 v[236:239], a[188:191], v[100:103], v[236:239]
    buffer_load_dwordx4 v[168:171], v14, s[16:19], s40 offen sc1
    v_mfma_f32_16x16x32_bf16 v[240:243], a[176:179], v[104:107], v[240:243]
    v_mfma_f32_16x16x32_bf16 v[244:247], a[180:183], v[104:107], v[244:247]
    buffer_load_dwordx4 v[172:175], v15, s[16:19], s40 offen sc1
    v_mfma_f32_16x16x32_bf16 v[248:251], a[184:187], v[104:107], v[248:251]
    v_mfma_f32_16x16x32_bf16 v[252:255], a[188:191], v[104:107], v[252:255]
    buffer_load_dwordx4 v[160:163], v12, s[16:19], s40 offen sc1
    s_add_u32 s40, s40, 20480
    v_mfma_f32_16x16x32_bf16 v[64:67], a[176:179], v[108:111], v[64:67]
    v_mfma_f32_16x16x32_bf16 v[68:71], a[180:183], v[108:111], v[68:71]
    v_mfma_f32_16x16x32_bf16 v[72:75], a[184:187], v[108:111], v[72:75]
    s_waitcnt vmcnt(30)
    v_max3_u32 v1, v176, v180, v184
    v_mfma_f32_16x16x32_bf16 v[76:79], a[188:191], v[108:111], v[76:79]
    v_max_u32 v1, v1, v188
    v_mfma_f32_16x16x32_bf16 v[208:211], a[176:179], v[96:99], v[208:211]
    v_cmp_eq_u32 vcc, -1, v1
    v_mfma_f32_16x16x32_bf16 v[212:215], a[180:183], v[96:99], v[212:215]
    v_mfma_f32_16x16x32_bf16 v[216:219], a[184:187], v[96:99], v[216:219]
    v_mfma_f32_16x16x32_bf16 v[220:223], a[188:191], v[96:99], v[220:223]
    s_cbranch_vccnz rt_43
rb_44:
    s_waitcnt vmcnt(63)
    v_mfma_f32_16x16x32_bf16 v[224:227], a[192:195], v[180:183], v[224:227]
    s_waitcnt vmcnt(63)
    v_mfma_f32_16x16x32_bf16 v[228:231], a[196:199], v[180:183], v[228:231]
    buffer_load_dwordx4 v[100:103], v13, s[16:19], s40 offen sc1
    s_waitcnt vmcnt(63)
    v_mfma_f32_16x16x32_bf16 v[232:235], a[200:203], v[180:183], v[232:235]
    s_waitcnt vmcnt(63)
    v_mfma_f32_16x16x32_bf16 v[236:239], a[204:207], v[180:183], v[236:239]
    buffer_load_dwordx4 v[104:107], v14, s[16:19], s40 offen sc1
    v_mfma_f32_16x16x32_bf16 v[240:243], a[192:195], v[184:187], v[240:243]
    v_mfma_f32_16x16x32_bf16 v[244:247], a[196:199], v[184:187], v[244:247]
    buffer_load_dwordx4 v[108:111], v15, s[16:19], s40 offen sc1
    v_mfma_f32_16x16x32_bf16 v[248:251], a[200:203], v[184:187], v[248:251]
    v_mfma_f32_16x16x32_bf16 v[252:255], a[204:207], v[184:187], v[252:255]
    buffer_load_dwordx4 v[96:99], v12, s[16:19], s40 offen sc1
    s_add_u32 s40, s40, 4096
    v_mfma_f32_16x16x32_bf16 v[64:67], a[192:195], v[188:191], v[64:67]
    v_mfma_f32_16x16x32_bf16 v[68:71], a[196:199], v[188:191], v[68:71]
    v_mfma_f32_16x16x32_bf16 v[72:75], a[200:203], v[188:191], v[72:75]
    s_waitcnt vmcnt(30)
    v_max3_u32 v1, v192, v196, v200
    v_mfma_f32_16x16x32_bf16 v[76:79], a[204:207], v[188:191], v[76:79]
    v_max_u32 v1, v1, v204
    v_mfma_f32_16x16x32_bf16 v[208:211], a[192:195], v[176:179], v[208:211]
    v_cmp_eq_u32 vcc, -1, v1
    v_mfma_f32_16x16x32_bf16 v[212:215], a[196:199], v[176:179], v[212:215]
    v_mfma_f32_16x16x32_bf16 v[216:219], a[200:203], v[176:179], v[216:219]
    v_mfma_f32_16x16x32_bf16 v[220:223], a[204:207], v[176:179], v[220:223]
    s_cbranch_vccnz rt_45
rb_46:
    s_waitcnt vmcnt(63)
    v_mfma_f32_16x16x32_bf16 v[224:227], a[208:211], v[196:199], v[224:227]
    s_waitcnt vmcnt(63)
    v_mfma_f32_16x16x32_bf16 v[228:231], a[212:215], v[196:199], v[228:231]
    buffer_load_dwordx4 v[180:183], v13, s[16:19], s40 offen sc1
    s_waitcnt vmcnt(63)
    v_mfma_f32_16x16x32_bf16 v[232:235], a[216:219], v[196:199], v[232:235]
    s_waitcnt vmcnt(63)
    v_mfma_f32_16x16x32_bf16 v[236:239], a[220:223], v[196:199], v[236:239]
    buffer_load_dwordx4 v[184:187], v14, s[16:19], s40 offen sc1
    v_mfma_f32_16x16x32_bf16 v[240:243], a[208:211], v[200:203], v[240:243]
    v_mfma_f32_16x16x32_bf16 v[244:247], a[212:215], v[200:203], v[244:247]
    buffer_load_dwordx4 v[188:191], v15, s[16:19], s40 offen sc1
    v_mfma_f32_16x16x32_bf16 v[248:251], a[216:219], v[200:203], v[248:251]
    v_mfma_f32_16x16x32_bf16 v[252:255], a[220:223], v[200:203], v[252:255]
    buffer_load_dwordx4 v[176:179], v12, s[16:19], s40 offen sc1
    v_mfma_f32_16x16x32_bf16 v[64:67], a[208:211], v[204:207], v[64:67]
    v_mfma_f32_16x16x32_bf16 v[68:71], a[212:215], v[204:207], v[68:71]
    v_mfma_f32_16x16x32_bf16 v[72:75], a[216:219], v[204:207], v[72:75]
    s_waitcnt vmcnt(28)
    v_max3_u32 v1, v80, v84, v88
    v_mfma_f32_16x16x32_bf16 v[76:79], a[220:223], v[204:207], v[76:79]
    v_max_u32 v1, v1, v92
    v_mfma_f32_16x16x32_bf16 v[208:211], a[208:211], v[192:195], v[208:211]
    v_cmp_eq_u32 vcc, -1, v1
    v_mfma_f32_16x16x32_bf16 v[212:215], a[212:215], v[192:195], v[212:215]
    v_mfma_f32_16x16x32_bf16 v[216:219], a[216:219], v[192:195], v[216:219]
    v_mfma_f32_16x16x32_bf16 v[220:223], a[220:223], v[192:195], v[220:223]
    s_cbranch_vccnz rt_47
rb_48:
    s_waitcnt vmcnt(63)
    v_mfma_f32_16x16x32_bf16 v[224:227], a[224:227], v[84:87], v[224:227]
    s_waitcnt vmcnt(63)
    v_mfma_f32_16x16x32_bf16 v[228:231], a[228:231], v[84:87], v[228:231]
    s_waitcnt vmcnt(63)
    v_mfma_f32_16x16x32_bf16 v[232:235], a[232:235], v[84:87], v[232:235]
    s_waitcnt vmcnt(63)
    v_mfma_f32_16x16x32_bf16 v[236:239], a[236:239], v[84:87], v[236:239]
    v_mfma_f32_16x16x32_bf16 v[240:243], a[224:227], v[88:91], v[240:243]
    v_mfma_f32_16x16x32_bf16 v[244:247], a[228:231], v[88:91], v[244:247]
    v_mfma_f32_16x16x32_bf16 v[248:251], a[232:235], v[88:91], v[248:251]
    v_mfma_f32_16x16x32_bf16 v[252:255], a[236:239], v[88:91], v[252:255]
    v_mfma_f32_16x16x32_bf16 v[64:67], a[224:227], v[92:95], v[64:67]
    v_mfma_f32_16x16x32_bf16 v[68:71], a[228:231], v[92:95], v[68:71]
    v_mfma_f32_16x16x32_bf16 v[72:75], a[232:235], v[92:95], v[72:75]
    s_waitcnt vmcnt(24)
    v_max3_u32 v1, v16, v20, v24
    v_mfma_f32_16x16x32_bf16 v[76:79], a[236:239], v[92:95], v[76:79]
    v_max_u32 v1, v1, v28
    v_mfma_f32_16x16x32_bf16 v[208:211], a[224:227], v[80:83], v[208:211]
    v_cmp_eq_u32 vcc, -1, v1
    v_mfma_f32_16x16x32_bf16 v[212:215], a[228:231], v[80:83], v[212:215]
    v_mfma_f32_16x16x32_bf16 v[216:219], a[232:235], v[80:83], v[216:219]
    v_mfma_f32_16x16x32_bf16 v[220:223], a[236:239], v[80:83], v[220:223]
    s_cbranch_vccnz rt_49
rb_50:
    s_waitcnt vmcnt(63)
    v_mfma_f32_16x16x32_bf16 v[224:227], a[240:243], v[20:23], v[224:227]
    s_waitcnt vmcnt(63)
    v_mfma_f32_16x16x32_bf16 v[228:231], a[244:247], v[20:23], v[228:231]
    s_waitcnt vmcnt(63)
    v_mfma_f32_16x16x32_bf16 v[232:235], a[248:251], v[20:23], v[232:235]
    s_waitcnt vmcnt(63)
    v_mfma_f32_16x16x32_bf16 v[236:239], a[252:255], v[20:23], v[236:239]
    v_mfma_f32_16x16x32_bf16 v[240:243], a[240:243], v[24:27], v[240:243]
    v_mfma_f32_16x16x32_bf16 v[244:247], a[244:247], v[24:27], v[244:247]
    v_mfma_f32_16x16x32_bf16 v[248:251], a[248:251], v[24:27], v[248:251]
    v_mfma_f32_16x16x32_bf16 v[252:255], a[252:255], v[24:27], v[252:255]
    v_mfma_f32_16x16x32_bf16 v[64:67], a[240:243], v[28:31], v[64:67]
    v_mfma_f32_16x16x32_bf16 v[68:71], a[244:247], v[28:31], v[68:71]
    v_mfma_f32_16x16x32_bf16 v[72:75], a[248:251], v[28:31], v[72:75]
    s_waitcnt vmcnt(20)
    v_max3_u32 v1, v40, v44, v48
    v_mfma_f32_16x16x32_bf16 v[76:79], a[252:255], v[28:31], v[76:79]
    v_max_u32 v1, v1, v52
    v_mfma_f32_16x16x32_bf16 v[208:211], a[240:243], v[16:19], v[208:211]
    v_cmp_eq_u32 vcc, -1, v1
    v_mfma_f32_16x16x32_bf16 v[212:215], a[244:247], v[16:19], v[212:215]
    v_mfma_f32_16x16x32_bf16 v[216:219], a[248:251], v[16:19], v[216:219]
    v_mfma_f32_16x16x32_bf16 v[220:223], a[252:255], v[16:19], v[220:223]
    s_cbranch_vccnz rt_51
rb_52:
    s_waitcnt vmcnt(63)
    v_mfma_f32_16x16x32_bf16 v[224:227], a[112:115], v[44:47], v[224:227]
    s_waitcnt vmcnt(63)
    v_mfma_f32_16x16x32_bf16 v[228:231], a[116:119], v[44:47], v[228:231]
    s_waitcnt vmcnt(63)
    v_mfma_f32_16x16x32_bf16 v[232:235], a[120:123], v[44:47], v[232:235]
    s_waitcnt vmcnt(63)
    v_mfma_f32_16x16x32_bf16 v[236:239], a[124:127], v[44:47], v[236:239]
    v_mfma_f32_16x16x32_bf16 v[240:243], a[112:115], v[48:51], v[240:243]
    v_mfma_f32_16x16x32_bf16 v[244:247], a[116:119], v[48:51], v[244:247]
    v_mfma_f32_16x16x32_bf16 v[248:251], a[120:123], v[48:51], v[248:251]
    v_mfma_f32_16x16x32_bf16 v[252:255], a[124:127], v[48:51], v[252:255]
    v_mfma_f32_16x16x32_bf16 v[64:67], a[112:115], v[52:55], v[64:67]
    v_mfma_f32_16x16x32_bf16 v[68:71], a[116:119], v[52:55], v[68:71]
    v_mfma_f32_16x16x32_bf16 v[72:75], a[120:123], v[52:55], v[72:75]
    s_waitcnt vmcnt(16)
    v_max3_u32 v1, v128, v132, v136
    v_mfma_f32_16x16x32_bf16 v[76:79], a[124:127], v[52:55], v[76:79]
    v_max_u32 v1, v1, v140
    v_mfma_f32_16x16x32_bf16 v[208:211], a[112:115], v[40:43], v[208:211]
    v_cmp_eq_u32 vcc, -1, v1
    v_mfma_f32_16x16x32_bf16 v[212:215], a[116:119], v[40:43], v[212:215]
    v_mfma_f32_16x16x32_bf16 v[216:219], a[120:123], v[40:43], v[216:219]
    v_mfma_f32_16x16x32_bf16 v[220:223], a[124:127], v[40:43], v[220:223]
    s_cbranch_vccnz rt_53
rb_54:
    s_waitcnt lgkmcnt(0)
    s_barrier
    s_waitcnt lgkmcnt(15)
    v_mfma_f32_16x16x32_bf16 v[224:227], a[0:3], v[132:135], v[224:227]
    s_waitcnt lgkmcnt(15)
    v_mfma_f32_16x16x32_bf16 v[228:231], a[4:7], v[132:135], v[228:231]
    buffer_load_dwordx4 v[192:195], v37, s[16:19], s30 offen offset:0 sc1
    s_waitcnt lgkmcnt(15)
    v_mfma_f32_16x16x32_bf16 v[232:235], a[8:11], v[132:135], v[232:235]
    s_waitcnt lgkmcnt(15)
    v_mfma_f32_16x16x32_bf16 v[236:239], a[12:15], v[132:135], v[236:239]
    buffer_load_dwordx4 v[196:199], v37, s[16:19], s30 offen offset:16 sc1
    v_mfma_f32_16x16x32_bf16 v[240:243], a[0:3], v[136:139], v[240:243]
    v_mfma_f32_16x16x32_bf16 v[244:247], a[4:7], v[136:139], v[244:247]
    buffer_load_dwordx4 v[200:203], v37, s[16:19], s30 offen offset:128 sc1
    v_mfma_f32_16x16x32_bf16 v[248:251], a[8:11], v[136:139], v[248:251]
    v_mfma_f32_16x16x32_bf16 v[252:255], a[12:15], v[136:139], v[252:255]
    buffer_load_dwordx4 v[204:207], v37, s[16:19], s30 offen offset:144 sc1
    v_mfma_f32_16x16x32_bf16 v[64:67], a[0:3], v[140:143], v[64:67]
    v_mfma_f32_16x16x32_bf16 v[68:71], a[4:7], v[140:143], v[68:71]
    v_mfma_f32_16x16x32_bf16 v[72:75], a[8:11], v[140:143], v[72:75]
    s_waitcnt vmcnt(16)
    v_max3_u32 v1, v144, v148, v152
    v_mfma_f32_16x16x32_bf16 v[76:79], a[12:15], v[140:143], v[76:79]
    v_max_u32 v1, v1, v156
    v_mfma_f32_16x16x32_bf16 v[208:211], a[0:3], v[128:131], v[208:211]
    v_cmp_eq_u32 vcc, -1, v1
    v_mfma_f32_16x16x32_bf16 v[212:215], a[4:7], v[128:131], v[212:215]
    v_mfma_f32_16x16x32_bf16 v[216:219], a[8:11], v[128:131], v[216:219]
    v_mfma_f32_16x16x32_bf16 v[220:223], a[12:15], v[128:131], v[220:223]
    s_cbranch_vccnz rt_55
rb_56:
    s_waitcnt lgkmcnt(12)
    v_mfma_f32_16x16x32_bf16 v[224:227], a[16:19], v[148:151], v[224:227]
    s_waitcnt lgkmcnt(12)
    v_mfma_f32_16x16x32_bf16 v[228:231], a[20:23], v[148:151], v[228:231]
    s_waitcnt lgkmcnt(12)
    v_mfma_f32_16x16x32_bf16 v[232:235], a[24:27], v[148:151], v[232:235]
    s_waitcnt lgkmcnt(12)
    v_mfma_f32_16x16x32_bf16 v[236:239], a[28:31], v[148:151], v[236:239]
    v_mfma_f32_16x16x32_bf16 v[240:243], a[16:19], v[152:155], v[240:243]
    v_mfma_f32_16x16x32_bf16 v[244:247], a[20:23], v[152:155], v[244:247]
    v_mfma_f32_16x16x32_bf16 v[248:251], a[24:27], v[152:155], v[248:251]
    v_mfma_f32_16x16x32_bf16 v[252:255], a[28:31], v[152:155], v[252:255]
    v_mfma_f32_16x16x32_bf16 v[64:67], a[16:19], v[156:159], v[64:67]
    v_mfma_f32_16x16x32_bf16 v[68:71], a[20:23], v[156:159], v[68:71]
    v_mfma_f32_16x16x32_bf16 v[72:75], a[24:27], v[156:159], v[72:75]
    s_waitcnt vmcnt(12)
    v_max3_u32 v1, v160, v164, v168
    v_mfma_f32_16x16x32_bf16 v[76:79], a[28:31], v[156:159], v[76:79]
    v_max_u32 v1, v1, v172
    v_mfma_f32_16x16x32_bf16 v[208:211], a[16:19], v[144:147], v[208:211]
    v_cmp_eq_u32 vcc, -1, v1
    v_mfma_f32_16x16x32_bf16 v[212:215], a[20:23], v[144:147], v[212:215]
    v_mfma_f32_16x16x32_bf16 v[216:219], a[24:27], v[144:147], v[216:219]
    v_mfma_f32_16x16x32_bf16 v[220:223], a[28:31], v[144:147], v[220:223]
    s_cbranch_vccnz rt_57
rb_58:
    s_waitcnt lgkmcnt(8)
    v_mfma_f32_16x16x32_bf16 v[224:227], a[32:35], v[164:167], v[224:227]
    s_waitcnt lgkmcnt(8)
    v_mfma_f32_16x16x32_bf16 v[228:231], a[36:39], v[164:167], v[228:231]
    s_waitcnt lgkmcnt(8)
    v_mfma_f32_16x16x32_bf16 v[232:235], a[40:43], v[164:167], v[232:235]
    s_waitcnt lgkmcnt(8)
    v_mfma_f32_16x16x32_bf16 v[236:239], a[44:47], v[164:167], v[236:239]
    v_mfma_f32_16x16x32_bf16 v[240:243], a[32:35], v[168:171], v[240:243]
    v_mfma_f32_16x16x32_bf16 v[244:247], a[36:39], v[168:171], v[244:247]
    v_mfma_f32_16x16x32_bf16 v[248:251], a[40:43], v[168:171], v[248:251]
    v_mfma_f32_16x16x32_bf16 v[252:255], a[44:47], v[168:171], v[252:255]
    v_mfma_f32_16x16x32_bf16 v[64:67], a[32:35], v[172:175], v[64:67]
    v_mfma_f32_16x16x32_bf16 v[68:71], a[36:39], v[172:175], v[68:71]
    v_mfma_f32_16x16x32_bf16 v[72:75], a[40:43], v[172:175], v[72:75]
    v_mfma_f32_16x16x32_bf16 v[76:79], a[44:47], v[172:175], v[76:79]
    v_mfma_f32_16x16x32_bf16 v[208:211], a[32:35], v[160:163], v[208:211]
    v_mfma_f32_16x16x32_bf16 v[212:215], a[36:39], v[160:163], v[212:215]
    s_waitcnt vmcnt(11)
    v_cmp_eq_u32 vcc, -1, v100
    v_mfma_f32_16x16x32_bf16 v[216:219], a[40:43], v[160:163], v[216:219]
    v_mfma_f32_16x16x32_bf16 v[220:223], a[44:47], v[160:163], v[220:223]
    s_cbranch_vccnz rt_59
rb_60:
    s_waitcnt lgkmcnt(4)
    v_mfma_f32_16x16x32_bf16 v[224:227], a[48:51], v[100:103], v[224:227]
    s_waitcnt lgkmcnt(4)
    v_mfma_f32_16x16x32_bf16 v[228:231], a[52:55], v[100:103], v[228:231]
    s_waitcnt vmcnt(10)
    v_cmp_eq_u32 vcc, -1, v104
    s_waitcnt lgkmcnt(4)
    v_mfma_f32_16x16x32_bf16 v[232:235], a[56:59], v[100:103], v[232:235]
    s_waitcnt lgkmcnt(4)
    v_mfma_f32_16x16x32_bf16 v[236:239], a[60:63], v[100:103], v[236:239]
    s_cbranch_vccnz rt_61
rb_62:
    v_mfma_f32_16x16x32_bf16 v[240:243], a[48:51], v[104:107], v[240:243]
    v_mfma_f32_16x16x32_bf16 v[244:247], a[52:55], v[104:107], v[244:247]
    s_waitcnt vmcnt(9)
    v_cmp_eq_u32 vcc, -1, v108
    v_mfma_f32_16x16x32_bf16 v[248:251], a[56:59], v[104:107], v[248:251]
    v_mfma_f32_16x16x32_bf16 v[252:255], a[60:63], v[104:107], v[252:255]
    s_cbranch_vccnz rt_63
rb_64:
    v_mfma_f32_16x16x32_bf16 v[64:67], a[48:51], v[108:111], v[64:67]
    v_mfma_f32_16x16x32_bf16 v[68:71], a[52:55], v[108:111], v[68:71]
    s_waitcnt vmcnt(8)
    v_cmp_eq_u32 vcc, -1, v96
    v_mfma_f32_16x16x32_bf16 v[72:75], a[56:59], v[108:111], v[72:75]
    v_mfma_f32_16x16x32_bf16 v[76:79], a[60:63], v[108:111], v[76:79]
    s_cbranch_vccnz rt_65
rb_66:
    v_mfma_f32_16x16x32_bf16 v[208:211], a[48:51], v[96:99], v[208:211]
    v_mfma_f32_16x16x32_bf16 v[212:215], a[52:55], v[96:99], v[212:215]
    s_waitcnt vmcnt(7)
    v_cmp_eq_u32 vcc, -1, v180
    v_mfma_f32_16x16x32_bf16 v[216:219], a[56:59], v[96:99], v[216:219]
    v_mfma_f32_16x16x32_bf16 v[220:223], a[60:63], v[96:99], v[220:223]
    s_cbranch_vccnz rt_67
rb_68:
    v_lshlrev_b32 v128, 16, v120
    v_and_b32 v129, 0xffff0000, v120
    v_lshlrev_b32 v130, 16, v121
    v_and_b32 v131, 0xffff0000, v121
    v_lshlrev_b32 v132, 16, v122
    v_and_b32 v133, 0xffff0000, v122
    v_lshlrev_b32 v134, 16, v123
    v_and_b32 v135, 0xffff0000, v123
    v_lshlrev_b32 v136, 16, v124
    v_and_b32 v137, 0xffff0000, v124
    v_lshlrev_b32 v138, 16, v125
    v_and_b32 v139, 0xffff0000, v125
    v_lshlrev_b32 v140, 16, v126
    v_and_b32 v141, 0xffff0000, v126
    v_lshlrev_b32 v142, 16, v127
    v_and_b32 v143, 0xffff0000, v127
    s_waitcnt lgkmcnt(0)
    v_mfma_f32_16x16x32_bf16 v[224:227], a[64:67], v[180:183], v[224:227]
    s_waitcnt lgkmcnt(0)
    v_mfma_f32_16x16x32_bf16 v[228:231], a[68:71], v[180:183], v[228:231]
    s_waitcnt vmcnt(6)
    v_cmp_eq_u32 vcc, -1, v184
    s_waitcnt lgkmcnt(0)
    v_mfma_f32_16x16x32_bf16 v[232:235], a[72:75], v[180:183], v[232:235]
    s_waitcnt lgkmcnt(0)
    v_mfma_f32_16x16x32_bf16 v[236:239], a[76:79], v[180:183], v[236:239]
    s_cbranch_vccnz rt_69
rb_70:
    v_mfma_f32_16x16x32_bf16 v[240:243], a[64:67], v[184:187], v[240:243]
    v_mfma_f32_16x16x32_bf16 v[244:247], a[68:71], v[184:187], v[244:247]
    s_waitcnt vmcnt(5)
    v_cmp_eq_u32 vcc, -1, v188
    v_mfma_f32_16x16x32_bf16 v[248:251], a[72:75], v[184:187], v[248:251]
    ds_write_b128 v113, v[224:227] offset:0
    ds_write_b128 v113, v[228:231] offset:1024
    v_mfma_f32_16x16x32_bf16 v[252:255], a[76:79], v[184:187], v[252:255]
    s_cbranch_vccnz rt_71
rb_72:
    ds_write_b128 v113, v[232:235] offset:2048
    ds_write_b128 v113, v[236:239] offset:3072
    v_mfma_f32_16x16x32_bf16 v[64:67], a[64:67], v[188:191], v[64:67]
    v_mfma_f32_16x16x32_bf16 v[68:71], a[68:71], v[188:191], v[68:71]
    s_waitcnt vmcnt(4)
    v_cmp_eq_u32 vcc, -1, v176
    v_mfma_f32_16x16x32_bf16 v[72:75], a[72:75], v[188:191], v[72:75]
    ds_write_b128 v114, v[240:243] offset:0
    ds_write_b128 v114, v[244:247] offset:1024
    v_mfma_f32_16x16x32_bf16 v[76:79], a[76:79], v[188:191], v[76:79]
    s_cbranch_vccnz rt_73
rb_74:
    ds_write_b128 v114, v[248:251] offset:2048
    ds_write_b128 v114, v[252:255] offset:3072
    s_waitcnt vmcnt(4)
    v_mfma_f32_16x16x32_bf16 v[208:211], a[64:67], v[176:179], v[208:211]
    v_mfma_f32_16x16x32_bf16 v[212:215], a[68:71], v[176:179], v[212:215]
    v_mfma_f32_16x16x32_bf16 v[216:219], a[72:75], v[176:179], v[216:219]
    ds_write_b128 v115, v[64:67] offset:0
    ds_write_b128 v115, v[68:71] offset:1024
    v_mfma_f32_16x16x32_bf16 v[220:223], a[76:79], v[176:179], v[220:223]
    ds_write_b128 v115, v[72:75] offset:2048
    ds_write_b128 v115, v[76:79] offset:3072
    s_waitcnt lgkmcnt(0)
    s_barrier
    ds_read_b128 v[64:67], v112 offset:0
    ds_read_b128 v[80:83], v112 offset:4096
    ds_read_b128 v[96:99], v112 offset:8192
    ds_read_b128 v[68:71], v112 offset:1024
    ds_read_b128 v[84:87], v112 offset:5120
    ds_read_b128 v[100:103], v112 offset:9216
    ds_read_b128 v[72:75], v112 offset:2048
    ds_read_b128 v[88:91], v112 offset:6144
    ds_read_b128 v[104:107], v112 offset:10240
    ds_read_b128 v[76:79], v112 offset:3072
    ds_read_b128 v[92:95], v112 offset:7168
    ds_read_b128 v[108:111], v112 offset:11264
    s_waitcnt lgkmcnt(9)
    v_pk_add_f32 v[64:65], v[64:65], v[80:81]
    v_pk_add_f32 v[208:209], v[208:209], v[96:97]
    v_pk_add_f32 v[66:67], v[66:67], v[82:83]
    v_pk_add_f32 v[210:211], v[210:211], v[98:99]
    v_pk_add_f32 v[208:209], v[208:209], v[64:65]
    v_pk_add_f32 v[210:211], v[210:211], v[66:67]
    s_waitcnt lgkmcnt(6)
    v_pk_add_f32 v[68:69], v[68:69], v[84:85]
    v_pk_add_f32 v[212:213], v[212:213], v[100:101]
    v_pk_add_f32 v[70:71], v[70:71], v[86:87]
    v_pk_add_f32 v[214:215], v[214:215], v[102:103]
    v_pk_add_f32 v[212:213], v[212:213], v[68:69]
    v_pk_add_f32 v[214:215], v[214:215], v[70:71]
    s_waitcnt lgkmcnt(3)
    v_pk_add_f32 v[72:73], v[72:73], v[88:89]
    v_pk_add_f32 v[216:217], v[216:217], v[104:105]
    v_pk_add_f32 v[74:75], v[74:75], v[90:91]
    v_pk_add_f32 v[218:219], v[218:219], v[106:107]
    v_pk_add_f32 v[216:217], v[216:217], v[72:73]
    v_pk_add_f32 v[218:219], v[218:219], v[74:75]
    s_waitcnt lgkmcnt(0)
    v_pk_add_f32 v[76:77], v[76:77], v[92:93]
    v_pk_add_f32 v[220:221], v[220:221], v[108:109]
    v_pk_add_f32 v[78:79], v[78:79], v[94:95]
    v_pk_add_f32 v[222:223], v[222:223], v[110:111]
    v_pk_add_f32 v[220:221], v[220:221], v[76:77]
    v_pk_add_f32 v[222:223], v[222:223], v[78:79]
    s_waitcnt vmcnt(0)
    v_pk_fma_f32 v[128:129], v[208:209], v[192:193], v[128:129]
    v_pk_fma_f32 v[130:131], v[210:211], v[194:195], v[130:131]
    v_pk_fma_f32 v[132:133], v[212:213], v[196:197], v[132:133]
    v_pk_fma_f32 v[134:135], v[214:215], v[198:199], v[134:135]
    v_pk_fma_f32 v[136:137], v[216:217], v[200:201], v[136:137]
    v_pk_fma_f32 v[138:139], v[218:219], v[202:203], v[138:139]
    v_pk_fma_f32 v[140:141], v[220:221], v[204:205], v[140:141]
    v_pk_fma_f32 v[142:143], v[222:223], v[206:207], v[142:143]
    v_cvt_pk_bf16_f32 v48, v128, v129
    v_cvt_pk_bf16_f32 v49, v130, v131
    v_cvt_pk_bf16_f32 v50, v132, v133
    v_cvt_pk_bf16_f32 v51, v134, v135
    v_cvt_pk_bf16_f32 v52, v136, v137
    v_cvt_pk_bf16_f32 v53, v138, v139
    v_cvt_pk_bf16_f32 v54, v140, v141
    v_cvt_pk_bf16_f32 v55, v142, v143
    buffer_store_dwordx4 v[48:51], v6, s[48:51], 0 offen
    buffer_store_dwordx4 v[52:55], v6, s[48:51], 0 offen offset:64
    s_endpgm
k3_fin:
k3_end:
    s_endpgm
slow_1:
    s_mov_b32 s67, 20000
spin_75:
    s_sleep 2
    buffer_load_dwordx4 v[216:219], v212, s[16:19], s64 offen offset:0 sc1
    s_waitcnt vmcnt(0)
    v_subrev_u32 v217, s61, v217
    v_subrev_u32 v219, s61, v219
    v_max_u32 v217, v217, v219
    v_cmp_gt_u32 vcc, 64, v217
    s_cmp_eq_u64 vcc, -1
    s_cbranch_scc1 back_2
    s_sub_u32 s67, s67, 1
    s_cmp_lg_u32 s67, 0
    s_cbranch_scc1 spin_75
    s_branch back_2
slow_3:
    s_mov_b32 s67, 20000
spin_76:
    s_mov_b64 exec, s[62:63]
    buffer_load_dword v1, v11, s[16:19], s53 offen offset:0 sc1
    s_mov_b64 exec, -1
    s_waitcnt vmcnt(0)
    v_subrev_u32 v1, s61, v1
    v_cmp_gt_u32 vcc, 64, v1
    s_and_b64 s[42:43], vcc, s[62:63]
    s_cmp_eq_u64 s[42:43], s[62:63]
    s_cbranch_scc1 back_4
    s_sub_u32 s67, s67, 1
    s_cmp_lg_u32 s67, 0
    s_cbranch_scc1 spin_76
    s_branch back_4
slow_5:
    s_mov_b32 s67, 20000
spin_77:
    s_sleep 4
    buffer_load_dwordx4 v[28:31], v5, s[16:19], s51 offen offset:0 sc1
    s_waitcnt vmcnt(0)
    v_subrev_u32 v28, s61, v28
    v_subrev_u32 v29, s61, v29
    v_subrev_u32 v30, s61, v30
    v_subrev_u32 v31, s61, v31
    v_max3_u32 v28, v28, v29, v30
    v_max_u32 v28, v28, v31
    v_cmp_gt_u32 vcc, 64, v28
    s_cmp_eq_u64 vcc, -1
    s_cbranch_scc1 back_6
    s_sub_u32 s67, s67, 1
    s_cmp_lg_u32 s67, 0
    s_cbranch_scc1 spin_77
    s_branch back_6
slow_7:
    s_mov_b32 s67, 20000
spin_78:
    s_mov_b64 exec, s[62:63]
    buffer_load_dword v1, v9, s[16:19], s47 offen offset:0 sc1
    s_mov_b64 exec, -1
    s_waitcnt vmcnt(0)
    v_subrev_u32 v1, s61, v1
    v_cmp_gt_u32 vcc, 64, v1
    s_and_b64 s[42:43], vcc, s[62:63]
    s_cmp_eq_u64 s[42:43], s[62:63]
    s_cbranch_scc1 back_8
    s_sub_u32 s67, s67, 1
    s_cmp_lg_u32 s67, 0
    s_cbranch_scc1 spin_78
    s_branch back_8
slow_31:
    s_mov_b32 s67, 20000
spin_79:
    s_mov_b64 exec, s[62:63]
    buffer_load_dword v1, v11, s[16:19], s39 offen offset:8 sc1
    s_mov_b64 exec, -1
    s_waitcnt vmcnt(0)
    v_subrev_u32 v1, s61, v1
    v_cmp_gt_u32 vcc, 64, v1
    s_and_b64 s[42:43], vcc, s[62:63]
    s_cmp_eq_u64 s[42:43], s[62:63]
    s_cbranch_scc1 back_32
    s_sub_u32 s67, s67, 1
    s_cmp_lg_u32 s67, 0
    s_cbranch_scc1 spin_79
    s_branch back_32
slow_33:
    s_mov_b32 s67, 20000
spin_80:
    s_mov_b64 exec, s[64:65]
    buffer_load_dword v40, v10, s[16:19], s47 offen offset:8 sc1
    s_mov_b64 exec, -1
    s_waitcnt vmcnt(0)
    v_subrev_u32 v40, s61, v40
    v_cmp_gt_u32 vcc, 64, v40
    s_and_b64 s[42:43], vcc, s[64:65]
    s_cmp_eq_u64 s[42:43], s[64:65]
    s_cbranch_scc1 back_34
    s_sub_u32 s67, s67, 1
    s_cmp_lg_u32 s67, 0
    s_cbranch_scc1 spin_80
    s_branch back_34
ot_9:
    s_mov_b32 s67, 4000
    s_sub_u32 s10, s20, 12288
ol_81:
    buffer_load_dwordx4 v[52:55], v13, s[16:19], s10 offen sc1
    buffer_load_dwordx4 v[56:59], v14, s[16:19], s10 offen sc1
    buffer_load_dwordx4 v[60:63], v15, s[16:19], s10 offen sc1
    buffer_load_dwordx4 v[48:51], v12, s[16:19], s10 offen sc1
    s_waitcnt vmcnt(0)
    v_max3_u32 v1, v48, v52, v56
    v_max_u32 v1, v1, v60
    v_cmp_eq_u32 vcc, -1, v1
    s_nop 1
    s_cbranch_vccz ob_10
    s_sub_u32 s67, s67, 1
    s_cmp_lg_u32 s67, 0
    s_cbranch_scc1 ol_81
    s_branch ob_10
ot_11:
    s_mov_b32 s67, 4000
    s_sub_u32 s10, s20, 8192
ol_82:
    buffer_load_dwordx4 v[76:79], v13, s[16:19], s10 offen sc1
    buffer_load_dwordx4 v[80:83], v14, s[16:19], s10 offen sc1
    buffer_load_dwordx4 v[84:87], v15, s[16:19], s10 offen sc1
    buffer_load_dwordx4 v[72:75], v12, s[16:19], s10 offen sc1
    s_waitcnt vmcnt(0)
    v_max3_u32 v1, v72, v76, v80
    v_max_u32 v1, v1, v84
    v_cmp_eq_u32 vcc, -1, v1
    s_nop 1
    s_cbranch_vccz ob_12
    s_sub_u32 s67, s67, 1
    s_cmp_lg_u32 s67, 0
    s_cbranch_scc1 ol_82
    s_branch ob_12
ot_13:
    s_mov_b32 s67, 4000
    s_sub_u32 s10, s20, 4096
ol_83:
    buffer_load_dwordx4 v[92:95], v13, s[16:19], s10 offen sc1
    buffer_load_dwordx4 v[96:99], v14, s[16:19], s10 offen sc1
    buffer_load_dwordx4 v[100:103], v15, s[16:19], s10 offen sc1
    buffer_load_dwordx4 v[88:91], v12, s[16:19], s10 offen sc1
    s_waitcnt vmcnt(0)
    v_max3_u32 v1, v88, v92, v96
    v_max_u32 v1, v1, v100
    v_cmp_eq_u32 vcc, -1, v1
    s_nop 1
    s_cbranch_vccz ob_14
    s_sub_u32 s67, s67, 1
    s_cmp_lg_u32 s67, 0
    s_cbranch_scc1 ol_83
    s_branch ob_14
ot_15:
    s_mov_b32 s67, 4000
    s_sub_u32 s10, s20, 0
ol_84:
    buffer_load_dwordx4 v[164:167], v13, s[16:19], s10 offen sc1
    buffer_load_dwordx4 v[168:171], v14, s[16:19], s10 offen sc1
    buffer_load_dwordx4 v[172:175], v15, s[16:19], s10 offen sc1
    buffer_load_dwordx4 v[160:163], v12, s[16:19], s10 offen sc1
    s_waitcnt vmcnt(0)
    v_max3_u32 v1, v160, v164, v168
    v_max_u32 v1, v1, v172
    v_cmp_eq_u32 vcc, -1, v1
    s_nop 1
    s_cbranch_vccz ob_16
    s_sub_u32 s67, s67, 1
    s_cmp_lg_u32 s67, 0
    s_cbranch_scc1 ol_84
    s_branch ob_16
xt_17:
    s_mov_b32 s67, 4000
    s_mul_i32 s10, s59, 28672
    s_add_u32 s10, s10, 0x2000000
xl_85:
    buffer_load_dwordx4 a[0:3], v5, s[16:19], s10 offen offset:0 sc1
    buffer_load_dwordx4 a[4:7], v5, s[16:19], s10 offen offset:1024 sc1
    buffer_load_dwordx4 a[8:11], v5, s[16:19], s10 offen offset:2048 sc1
    buffer_load_dwordx4 a[12:15], v5, s[16:19], s10 offen offset:3072 sc1
    s_waitcnt vmcnt(0)
    v_accvgpr_read_b32 v224, a0
    v_accvgpr_read_b32 v225, a4
    v_accvgpr_read_b32 v226, a8
    v_accvgpr_read_b32 v227, a12
    v_max3_u32 v224, v224, v225, v226
    v_max_u32 v224, v224, v227
    v_cmp_eq_u32 vcc, -1, v224
    s_nop 0
    s_cbranch_vccz xb_18
    s_sub_u32 s67, s67, 1
    s_cmp_lg_u32 s67, 0
    s_cbranch_scc1 xl_85
    s_branch xb_18
xt_19:
    s_mov_b32 s67, 4000
    s_mul_i32 s10, s59, 28672
    s_add_u32 s10, s10, 0x2001000
xl_86:
    buffer_load_dwordx4 a[16:19], v5, s[16:19], s10 offen offset:0 sc1
    buffer_load_dwordx4 a[20:23], v5, s[16:19], s10 offen offset:1024 sc1
    buffer_load_dwordx4 a[24:27], v5, s[16:19], s10 offen offset:2048 sc1
    buffer_load_dwordx4 a[28:31], v5, s[16:19], s10 offen offset:3072 sc1
    s_waitcnt vmcnt(0)
    v_accvgpr_read_b32 v224, a16
    v_accvgpr_read_b32 v225, a20
    v_accvgpr_read_b32 v226, a24
    v_accvgpr_read_b32 v227, a28
    v_max3_u32 v224, v224, v225, v226
    v_max_u32 v224, v224, v227
    v_cmp_eq_u32 vcc, -1, v224
    s_nop 0
    s_cbranch_vccz xb_20
    s_sub_u32 s67, s67, 1
    s_cmp_lg_u32 s67, 0
    s_cbranch_scc1 xl_86
    s_branch xb_20
xt_21:
    s_mov_b32 s67, 4000
    s_mul_i32 s10, s59, 28672
    s_add_u32 s10, s10, 0x2002000
xl_87:
    buffer_load_dwordx4 a[32:35], v5, s[16:19], s10 offen offset:0 sc1
    buffer_load_dwordx4 a[36:39], v5, s[16:19], s10 offen offset:1024 sc1
    buffer_load_dwordx4 a[40:43], v5, s[16:19], s10 offen offset:2048 sc1
    buffer_load_dwordx4 a[44:47], v5, s[16:19], s10 offen offset:3072 sc1
    s_waitcnt vmcnt(0)
    v_accvgpr_read_b32 v224, a32
    v_accvgpr_read_b32 v225, a36
    v_accvgpr_read_b32 v226, a40
    v_accvgpr_read_b32 v227, a44
    v_max3_u32 v224, v224, v225, v226
    v_max_u32 v224, v224, v227
    v_cmp_eq_u32 vcc, -1, v224
    s_nop 0
    s_cbranch_vccz xb_22
    s_sub_u32 s67, s67, 1
    s_cmp_lg_u32 s67, 0
    s_cbranch_scc1 xl_87
    s_branch xb_22
xt_23:
    s_mov_b32 s67, 4000
    s_mul_i32 s10, s59, 28672
    s_add_u32 s10, s10, 0x2003000
xl_88:
    buffer_load_dwordx4 a[48:51], v5, s[16:19], s10 offen offset:0 sc1
    buffer_load_dwordx4 a[52:55], v5, s[16:19], s10 offen offset:1024 sc1
    buffer_load_dwordx4 a[56:59], v5, s[16:19], s10 offen offset:2048 sc1
    buffer_load_dwordx4 a[60:63], v5, s[16:19], s10 offen offset:3072 sc1
    s_waitcnt vmcnt(0)
    v_accvgpr_read_b32 v224, a48
    v_accvgpr_read_b32 v225, a52
    v_accvgpr_read_b32 v226, a56
    v_accvgpr_read_b32 v227, a60
    v_max3_u32 v224, v224, v225, v226
    v_max_u32 v224, v224, v227
    v_cmp_eq_u32 vcc, -1, v224
    s_nop 0
    s_cbranch_vccz xb_24
    s_sub_u32 s67, s67, 1
    s_cmp_lg_u32 s67, 0
    s_cbranch_scc1 xl_88
    s_branch xb_24
xt_25:
    s_mov_b32 s67, 4000
    s_mul_i32 s10, s59, 28672
    s_add_u32 s10, s10, 0x2004000
xl_89:
    buffer_load_dwordx4 a[64:67], v5, s[16:19], s10 offen offset:0 sc1
    buffer_load_dwordx4 a[68:71], v5, s[16:19], s10 offen offset:1024 sc1
    buffer_load_dwordx4 a[72:75], v5, s[16:19], s10 offen offset:2048 sc1
    buffer_load_dwordx4 a[76:79], v5, s[16:19], s10 offen offset:3072 sc1
    s_waitcnt vmcnt(0)
    v_accvgpr_read_b32 v224, a64
    v_accvgpr_read_b32 v225, a68
    v_accvgpr_read_b32 v226, a72
    v_accvgpr_read_b32 v227, a76
    v_max3_u32 v224, v224, v225, v226
    v_max_u32 v224, v224, v227
    v_cmp_eq_u32 vcc, -1, v224
    s_nop 0
    s_cbranch_vccz xb_26
    s_sub_u32 s67, s67, 1
    s_cmp_lg_u32 s67, 0
    s_cbranch_scc1 xl_89
    s_branch xb_26
xt_27:
    s_mov_b32 s67, 4000
    s_mul_i32 s10, s59, 28672
    s_add_u32 s10, s10, 0x2005000
xl_90:
    buffer_load_dwordx4 a[80:83], v5, s[16:19], s10 offen offset:0 sc1
    buffer_load_dwordx4 a[84:87], v5, s[16:19], s10 offen offset:1024 sc1
    buffer_load_dwordx4 a[88:91], v5, s[16:19], s10 offen offset:2048 sc1
    buffer_load_dwordx4 a[92:95], v5, s[16:19], s10 offen offset:3072 sc1
    s_waitcnt vmcnt(0)
    v_accvgpr_read_b32 v224, a80
    v_accvgpr_read_b32 v225, a84
    v_accvgpr_read_b32 v226, a88
    v_accvgpr_read_b32 v227, a92
    v_max3_u32 v224, v224, v225, v226
    v_max_u32 v224, v224, v227
    v_cmp_eq_u32 vcc, -1, v224
    s_nop 0
    s_cbranch_vccz xb_28
    s_sub_u32 s67, s67, 1
    s_cmp_lg_u32 s67, 0
    s_cbranch_scc1 xl_90
    s_branch xb_28
xt_29:
    s_mov_b32 s67, 4000
    s_mul_i32 s10, s59, 28672
    s_add_u32 s10, s10, 0x2006000
xl_91:
    buffer_load_dwordx4 a[96:99], v5, s[16:19], s10 offen offset:0 sc1
    buffer_load_dwordx4 a[100:103], v5, s[16:19], s10 offen offset:1024 sc1
    buffer_load_dwordx4 a[104:107], v5, s[16:19], s10 offen offset:2048 sc1
    buffer_load_dwordx4 a[108:111], v5, s[16:19], s10 offen offset:3072 sc1
    s_waitcnt vmcnt(0)
    v_accvgpr_read_b32 v224, a96
    v_accvgpr_read_b32 v225, a100
    v_accvgpr_read_b32 v226, a104
    v_accvgpr_read_b32 v227, a108
    v_max3_u32 v224, v224, v225, v226
    v_max_u32 v224, v224, v227
    v_cmp_eq_u32 vcc, -1, v224
    s_nop 0
    s_cbranch_vccz xb_30
    s_sub_u32 s67, s67, 1
    s_cmp_lg_u32 s67, 0
    s_cbranch_scc1 xl_91
    s_branch xb_30
rt_35:
    s_mov_b32 s67, 4000
    s_add_u32 s10, s7, 0
rl_92:
    buffer_load_dwordx4 v[132:135], v13, s[16:19], s10 offen sc1
    buffer_load_dwordx4 v[136:139], v14, s[16:19], s10 offen sc1
    buffer_load_dwordx4 v[140:143], v15, s[16:19], s10 offen sc1
    buffer_load_dwordx4 v[128:131], v12, s[16:19], s10 offen sc1
    s_waitcnt vmcnt(0)
    v_max3_u32 v1, v128, v132, v136
    v_max_u32 v1, v1, v140
    v_cmp_eq_u32 vcc, -1, v1
    s_cbranch_vccz rb_36
    s_sub_u32 s67, s67, 1
    s_cmp_lg_u32 s67, 0
    s_cbranch_scc1 rl_92
    s_branch rb_36
rt_37:
    s_mov_b32 s67, 4000
    s_add_u32 s10, s7, 4096
rl_93:
    buffer_load_dwordx4 v[148:151], v13, s[16:19], s10 offen sc1
    buffer_load_dwordx4 v[152:155], v14, s[16:19], s10 offen sc1
    buffer_load_dwordx4 v[156:159], v15, s[16:19], s10 offen sc1
    buffer_load_dwordx4 v[144:147], v12, s[16:19], s10 offen sc1
    s_waitcnt vmcnt(0)
    v_max3_u32 v1, v144, v148, v152
    v_max_u32 v1, v1, v156
    v_cmp_eq_u32 vcc, -1, v1
    s_cbranch_vccz rb_38
    s_sub_u32 s67, s67, 1
    s_cmp_lg_u32 s67, 0
    s_cbranch_scc1 rl_93
    s_branch rb_38
rt_39:
    s_mov_b32 s67, 4000
    s_add_u32 s10, s7, 8192
rl_94:
    buffer_load_dwordx4 v[164:167], v13, s[16:19], s10 offen sc1
    buffer_load_dwordx4 v[168:171], v14, s[16:19], s10 offen sc1
    buffer_load_dwordx4 v[172:175], v15, s[16:19], s10 offen sc1
    buffer_load_dwordx4 v[160:163], v12, s[16:19], s10 offen sc1
    s_waitcnt vmcnt(0)
    v_max3_u32 v1, v160, v164, v168
    v_max_u32 v1, v1, v172
    v_cmp_eq_u32 vcc, -1, v1
    s_cbranch_vccz rb_40
    s_sub_u32 s67, s67, 1
    s_cmp_lg_u32 s67, 0
    s_cbranch_scc1 rl_94
    s_branch rb_40
rt_41:
    s_mov_b32 s67, 4000
    s_add_u32 s10, s7, 12288
rl_95:
    buffer_load_dwordx4 v[100:103], v13, s[16:19], s10 offen sc1
    buffer_load_dwordx4 v[104:107], v14, s[16:19], s10 offen sc1
    buffer_load_dwordx4 v[108:111], v15, s[16:19], s10 offen sc1
    buffer_load_dwordx4 v[96:99], v12, s[16:19], s10 offen sc1
    s_waitcnt vmcnt(0)
    v_max3_u32 v1, v96, v100, v104
    v_max_u32 v1, v1, v108
    v_cmp_eq_u32 vcc, -1, v1
    s_cbranch_vccz rb_42
    s_sub_u32 s67, s67, 1
    s_cmp_lg_u32 s67, 0
    s_cbranch_scc1 rl_95
    s_branch rb_42
rt_43:
    s_mov_b32 s67, 4000
    s_add_u32 s10, s7, 32768
rl_96:
    buffer_load_dwordx4 v[180:183], v13, s[16:19], s10 offen sc1
    buffer_load_dwordx4 v[184:187], v14, s[16:19], s10 offen sc1
    buffer_load_dwordx4 v[188:191], v15, s[16:19], s10 offen sc1
    buffer_load_dwordx4 v[176:179], v12, s[16:19], s10 offen sc1
    s_waitcnt vmcnt(0)
    v_max3_u32 v1, v176, v180, v184
    v_max_u32 v1, v1, v188
    v_cmp_eq_u32 vcc, -1, v1
    s_cbranch_vccz rb_44
    s_sub_u32 s67, s67, 1
    s_cmp_lg_u32 s67, 0
    s_cbranch_scc1 rl_96
    s_branch rb_44
rt_45:
    s_mov_b32 s67, 4000
    s_add_u32 s10, s7, 36864
rl_97:
    buffer_load_dwordx4 v[196:199], v13, s[16:19], s10 offen sc1
    buffer_load_dwordx4 v[200:203], v14, s[16:19], s10 offen sc1
    buffer_load_dwordx4 v[204:207], v15, s[16:19], s10 offen sc1
    buffer_load_dwordx4 v[192:195], v12, s[16:19], s10 offen sc1
    s_waitcnt vmcnt(0)
    v_max3_u32 v1, v192, v196, v200
    v_max_u32 v1, v1, v204
    v_cmp_eq_u32 vcc, -1, v1
    s_cbranch_vccz rb_46
    s_sub_u32 s67, s67, 1
    s_cmp_lg_u32 s67, 0
    s_cbranch_scc1 rl_97
    s_branch rb_46
rt_47:
    s_mov_b32 s67, 4000
    s_add_u32 s10, s7, 40960
rl_98:
    buffer_load_dwordx4 v[84:87], v13, s[16:19], s10 offen sc1
    buffer_load_dwordx4 v[88:91], v14, s[16:19], s10 offen sc1
    buffer_load_dwordx4 v[92:95], v15, s[16:19], s10 offen sc1
    buffer_load_dwordx4 v[80:83], v12, s[16:19], s10 offen sc1
    s_waitcnt vmcnt(0)
    v_max3_u32 v1, v80, v84, v88
    v_max_u32 v1, v1, v92
    v_cmp_eq_u32 vcc, -1, v1
    s_cbranch_vccz rb_48
    s_sub_u32 s67, s67, 1
    s_cmp_lg_u32 s67, 0
    s_cbranch_scc1 rl_98
    s_branch rb_48
rt_49:
    s_mov_b32 s67, 4000
    s_add_u32 s10, s7, 45056
rl_99:
    buffer_load_dwordx4 v[20:23], v13, s[16:19], s10 offen sc1
    buffer_load_dwordx4 v[24:27], v14, s[16:19], s10 offen sc1
    buffer_load_dwordx4 v[28:31], v15, s[16:19], s10 offen sc1
    buffer_load_dwordx4 v[16:19], v12, s[16:19], s10 offen sc1
    s_waitcnt vmcnt(0)
    v_max3_u32 v1, v16, v20, v24
    v_max_u32 v1, v1, v28
    v_cmp_eq_u32 vcc, -1, v1
    s_cbranch_vccz rb_50
    s_sub_u32 s67, s67, 1
    s_cmp_lg_u32 s67, 0
    s_cbranch_scc1 rl_99
    s_branch rb_50
rt_51:
    s_mov_b32 s67, 4000
    s_add_u32 s10, s7, 65536
rl_100:
    buffer_load_dwordx4 v[44:47], v13, s[16:19], s10 offen sc1
    buffer_load_dwordx4 v[48:51], v14, s[16:19], s10 offen sc1
    buffer_load_dwordx4 v[52:55], v15, s[16:19], s10 offen sc1
    buffer_load_dwordx4 v[40:43], v12, s[16:19], s10 offen sc1
    s_waitcnt vmcnt(0)
    v_max3_u32 v1, v40, v44, v48
    v_max_u32 v1, v1, v52
    v_cmp_eq_u32 vcc, -1, v1
    s_cbranch_vccz rb_52
    s_sub_u32 s67, s67, 1
    s_cmp_lg_u32 s67, 0
    s_cbranch_scc1 rl_100
    s_branch rb_52
rt_53:
    s_mov_b32 s67, 4000
    s_add_u32 s10, s7, 69632
rl_101:
    buffer_load_dwordx4 v[132:135], v13, s[16:19], s10 offen sc1
    buffer_load_dwordx4 v[136:139], v14, s[16:19], s10 offen sc1
    buffer_load_dwordx4 v[140:143], v15, s[16:19], s10 offen sc1
    buffer_load_dwordx4 v[128:131], v12, s[16:19], s10 offen sc1
    s_waitcnt vmcnt(0)
    v_max3_u32 v1, v128, v132, v136
    v_max_u32 v1, v1, v140
    v_cmp_eq_u32 vcc, -1, v1
    s_cbranch_vccz rb_54
    s_sub_u32 s67, s67, 1
    s_cmp_lg_u32 s67, 0
    s_cbranch_scc1 rl_101
    s_branch rb_54
rt_55:
    s_mov_b32 s67, 4000
    s_add_u32 s10, s7, 73728
rl_102:
    buffer_load_dwordx4 v[148:151], v13, s[16:19], s10 offen sc1
    buffer_load_dwordx4 v[152:155], v14, s[16:19], s10 offen sc1
    buffer_load_dwordx4 v[156:159], v15, s[16:19], s10 offen sc1
    buffer_load_dwordx4 v[144:147], v12, s[16:19], s10 offen sc1
    s_waitcnt vmcnt(0)
    v_max3_u32 v1, v144, v148, v152
    v_max_u32 v1, v1, v156
    v_cmp_eq_u32 vcc, -1, v1
    s_cbranch_vccz rb_56
    s_sub_u32 s67, s67, 1
    s_cmp_lg_u32 s67, 0
    s_cbranch_scc1 rl_102
    s_branch rb_56
rt_57:
    s_mov_b32 s67, 4000
    s_add_u32 s10, s7, 77824
rl_103:
    buffer_load_dwordx4 v[164:167], v13, s[16:19], s10 offen sc1
    buffer_load_dwordx4 v[168:171], v14, s[16:19], s10 offen sc1
    buffer_load_dwordx4 v[172:175], v15, s[16:19], s10 offen sc1
    buffer_load_dwordx4 v[160:163], v12, s[16:19], s10 offen sc1
    s_waitcnt vmcnt(0)
    v_max3_u32 v1, v160, v164, v168
    v_max_u32 v1, v1, v172
    v_cmp_eq_u32 vcc, -1, v1
    s_cbranch_vccz rb_58
    s_sub_u32 s67, s67, 1
    s_cmp_lg_u32 s67, 0
    s_cbranch_scc1 rl_103
    s_branch rb_58
rt_59:
    s_mov_b32 s67, 4000
    s_add_u32 s10, s7, 98304
rl_104:
    buffer_load_dwordx4 v[100:103], v13, s[16:19], s10 offen sc1
    buffer_load_dwordx4 v[104:107], v14, s[16:19], s10 offen sc1
    buffer_load_dwordx4 v[108:111], v15, s[16:19], s10 offen sc1
    buffer_load_dwordx4 v[96:99], v12, s[16:19], s10 offen sc1
    s_waitcnt vmcnt(0)
    v_cmp_eq_u32 vcc, -1, v100
    s_cbranch_vccz rb_60
    s_sub_u32 s67, s67, 1
    s_cmp_lg_u32 s67, 0
    s_cbranch_scc1 rl_104
    s_branch rb_60
rt_61:
    s_mov_b32 s67, 4000
    s_add_u32 s10, s7, 98304
rl_105:
    buffer_load_dwordx4 v[104:107], v14, s[16:19], s10 offen sc1
    buffer_load_dwordx4 v[108:111], v15, s[16:19], s10 offen sc1
    buffer_load_dwordx4 v[96:99], v12, s[16:19], s10 offen sc1
    s_waitcnt vmcnt(0)
    v_cmp_eq_u32 vcc, -1, v104
    s_cbranch_vccz rb_62
    s_sub_u32 s67, s67, 1
    s_cmp_lg_u32 s67, 0
    s_cbranch_scc1 rl_105
    s_branch rb_62
rt_63:
    s_mov_b32 s67, 4000
    s_add_u32 s10, s7, 98304
rl_106:
    buffer_load_dwordx4 v[108:111], v15, s[16:19], s10 offen sc1
    buffer_load_dwordx4 v[96:99], v12, s[16:19], s10 offen sc1
    s_waitcnt vmcnt(0)
    v_cmp_eq_u32 vcc, -1, v108
    s_cbranch_vccz rb_64
    s_sub_u32 s67, s67, 1
    s_cmp_lg_u32 s67, 0
    s_cbranch_scc1 rl_106
    s_branch rb_64
rt_65:
    s_mov_b32 s67, 4000
    s_add_u32 s10, s7, 98304
rl_107:
    buffer_load_dwordx4 v[96:99], v12, s[16:19], s10 offen sc1
    s_waitcnt vmcnt(0)
    v_cmp_eq_u32 vcc, -1, v96
    s_cbranch_vccz rb_66
    s_sub_u32 s67, s67, 1
    s_cmp_lg_u32 s67, 0
    s_cbranch_scc1 rl_107
    s_branch rb_66
rt_67:
    s_mov_b32 s67, 4000
    s_add_u32 s10, s7, 102400
rl_108:
    buffer_load_dwordx4 v[180:183], v13, s[16:19], s10 offen sc1
    buffer_load_dwordx4 v[184:187], v14, s[16:19], s10 offen sc1
    buffer_load_dwordx4 v[188:191], v15, s[16:19], s10 offen sc1
    buffer_load_dwordx4 v[176:179], v12, s[16:19], s10 offen sc1
    s_waitcnt vmcnt(0)
    v_cmp_eq_u32 vcc, -1, v180
    s_cbranch_vccz rb_68
    s_sub_u32 s67, s67, 1
    s_cmp_lg_u32 s67, 0
    s_cbranch_scc1 rl_108
    s_branch rb_68
rt_69:
    s_mov_b32 s67, 4000
    s_add_u32 s10, s7, 102400
rl_109:
    buffer_load_dwordx4 v[184:187], v14, s[16:19], s10 offen sc1
    buffer_load_dwordx4 v[188:191], v15, s[16:19], s10 offen sc1
    buffer_load_dwordx4 v[176:179], v12, s[16:19], s10 offen sc1
    s_waitcnt vmcnt(0)
    v_cmp_eq_u32 vcc, -1, v184
    s_cbranch_vccz rb_70
    s_sub_u32 s67, s67, 1
    s_cmp_lg_u32 s67, 0
    s_cbranch_scc1 rl_109
    s_branch rb_70
rt_71:
    s_mov_b32 s67, 4000
    s_add_u32 s10, s7, 102400
rl_110:
    buffer_load_dwordx4 v[188:191], v15, s[16:19], s10 offen sc1
    buffer_load_dwordx4 v[176:179], v12, s[16:19], s10 offen sc1
    s_waitcnt vmcnt(0)
    v_cmp_eq_u32 vcc, -1, v188
    s_cbranch_vccz rb_72
    s_sub_u32 s67, s67, 1
    s_cmp_lg_u32 s67, 0
    s_cbranch_scc1 rl_110
    s_branch rb_72
rt_73:
    s_mov_b32 s67, 4000
    s_add_u32 s10, s7, 102400
rl_111:
    buffer_load_dwordx4 v[176:179], v12, s[16:19], s10 offen sc1
    s_waitcnt vmcnt(0)
    v_cmp_eq_u32 vcc, -1, v176
    s_cbranch_vccz rb_74
    s_sub_u32 s67, s67, 1
    s_cmp_lg_u32 s67, 0
    s_cbranch_scc1 rl_111
    s_branch rb_74
k2_slow:
    s_mov_b32 s15, 0x7f800000
    s_cmp_eq_u32 s14, s15
    s_cbranch_scc1 k2_ok
    s_mov_b32 s14, 0x3e8b97f6
    v_lshlrev_b32 v20, 2, v35
    v_mov_b32 v22, 0xff800000
    s_cmp_lt_u32 s59, 8
    s_cselect_b32 s15, 0xff800000, 0
    v_mov_b32 v23, s15
    s_mov_b32 s14, 0x7f800000
    v_add_u32 v21, 0, v20
    v_cmp_gt_u32 vcc, v21, v34
    s_nop 0
    s_nop 0
    v_cndmask_b32 v96, v22, v23, vcc
    v_add_u32 v21, 1, v20
    v_cmp_gt_u32 vcc, v21, v34
    s_nop 0
    s_nop 0
    v_cndmask_b32 v97, v22, v23, vcc
    v_add_u32 v21, 2, v20
    v_cmp_gt_u32 vcc, v21, v34
    s_nop 0
    s_nop 0
    v_cndmask_b32 v98, v22, v23, vcc
    v_add_u32 v21, 3, v20
    v_cmp_gt_u32 vcc, v21, v34
    s_nop 0
    s_nop 0
    v_cndmask_b32 v99, v22, v23, vcc
    v_add_u32 v21, 8, v20
    v_cmp_gt_u32 vcc, v21, v34
    s_nop 0
    s_nop 0
    v_cndmask_b32 v100, v22, v23, vcc
    v_add_u32 v21, 9, v20
    v_cmp_gt_u32 vcc, v21, v34
    s_nop 0
    s_nop 0
    v_cndmask_b32 v101, v22, v23, vcc
    v_add_u32 v21, 10, v20
    v_cmp_gt_u32 vcc, v21, v34
    s_nop 0
    s_nop 0
    v_cndmask_b32 v102, v22, v23, vcc
    v_add_u32 v21, 11, v20
    v_cmp_gt_u32 vcc, v21, v34
    s_nop 0
    s_nop 0
    v_cndmask_b32 v103, v22, v23, vcc
    v_add_u32 v21, 16, v20
    v_cmp_gt_u32 vcc, v21, v34
    s_nop 0
    s_nop 0
    v_cndmask_b32 v104, v22, v23, vcc
    v_add_u32 v21, 17, v20
    v_cmp_gt_u32 vcc, v21, v34
    s_nop 0
    s_nop 0
    v_cndmask_b32 v105, v22, v23, vcc
    v_add_u32 v21, 18, v20
    v_cmp_gt_u32 vcc, v21, v34
    s_nop 0
    s_nop 0
    v_cndmask_b32 v106, v22, v23, vcc
    v_add_u32 v21, 19, v20
    v_cmp_gt_u32 vcc, v21, v34
    s_nop 0
    s_nop 0
    v_cndmask_b32 v107, v22, v23, vcc
    v_add_u32 v21, 24, v20
    v_cmp_gt_u32 vcc, v21, v34
    s_nop 0
    s_nop 0
    v_cndmask_b32 v108, v22, v23, vcc
    v_add_u32 v21, 25, v20
    v_cmp_gt_u32 vcc, v21, v34
    s_nop 0
    s_nop 0
    v_cndmask_b32 v109, v22, v23, vcc
    v_add_u32 v21, 26, v20
    v_cmp_gt_u32 vcc, v21, v34
    s_nop 0
    s_nop 0
    v_cndmask_b32 v110, v22, v23, vcc
    v_add_u32 v21, 27, v20
    v_cmp_gt_u32 vcc, v21, v34
    s_nop 0
    s_nop 0
    v_cndmask_b32 v111, v22, v23, vcc
    s_cmp_lt_u32 s59, 7
    s_cselect_b32 s15, 0xff800000, 0
    v_mov_b32 v112, s15
    v_mov_b32 v113, s15
    v_mov_b32 v114, s15
    v_mov_b32 v115, s15
    v_mov_b32 v116, s15
    v_mov_b32 v117, s15
    v_mov_b32 v118, s15
    v_mov_b32 v119, s15
    v_mov_b32 v120, s15
    v_mov_b32 v121, s15
    v_mov_b32 v122, s15
    v_mov_b32 v123, s15
    v_mov_b32 v124, s15
    v_mov_b32 v125, s15
    v_mov_b32 v126, s15
    v_mov_b32 v127, s15
    s_cmp_lt_u32 s59, 6
    s_cselect_b32 s15, 0xff800000, 0
    v_mov_b32 v128, s15
    v_mov_b32 v129, s15
    v_mov_b32 v130, s15
    v_mov_b32 v131, s15
    v_mov_b32 v132, s15
    v_mov_b32 v133, s15
    v_mov_b32 v134, s15
    v_mov_b32 v135, s15
    v_mov_b32 v136, s15
    v_mov_b32 v137, s15
    v_mov_b32 v138, s15
    v_mov_b32 v139, s15
    v_mov_b32 v140, s15
    v_mov_b32 v141, s15
    v_mov_b32 v142, s15
    v_mov_b32 v143, s15
    s_cmp_lt_u32 s59, 5
    s_cselect_b32 s15, 0xff800000, 0
    v_mov_b32 v144, s15
    v_mov_b32 v145, s15
    v_mov_b32 v146, s15
    v_mov_b32 v147, s15
    v_mov_b32 v148, s15
    v_mov_b32 v149, s15
    v_mov_b32 v150, s15
    v_mov_b32 v151, s15
    v_mov_b32 v152, s15
    v_mov_b32 v153, s15
    v_mov_b32 v154, s15
    v_mov_b32 v155, s15
    v_mov_b32 v156, s15
    v_mov_b32 v157, s15
    v_mov_b32 v158, s15
    v_mov_b32 v159, s15
    s_cmp_lt_u32 s59, 4
    s_cselect_b32 s15, 0xff800000, 0
    v_mov_b32 v160, s15
    v_mov_b32 v161, s15
    v_mov_b32 v162, s15
    v_mov_b32 v163, s15
    v_mov_b32 v164, s15
    v_mov_b32 v165, s15
    v_mov_b32 v166, s15
    v_mov_b32 v167, s15
    v_mov_b32 v168, s15
    v_mov_b32 v169, s15
    v_mov_b32 v170, s15
    v_mov_b32 v171, s15
    v_mov_b32 v172, s15
    v_mov_b32 v173, s15
    v_mov_b32 v174, s15
    v_mov_b32 v175, s15
    s_cmp_lt_u32 s59, 3
    s_cselect_b32 s15, 0xff800000, 0
    v_mov_b32 v176, s15
    v_mov_b32 v177, s15
    v_mov_b32 v178, s15
    v_mov_b32 v179, s15
    v_mov_b32 v180, s15
    v_mov_b32 v181, s15
    v_mov_b32 v182, s15
    v_mov_b32 v183, s15
    v_mov_b32 v184, s15
    v_mov_b32 v185, s15
    v_mov_b32 v186, s15
    v_mov_b32 v187, s15
    v_mov_b32 v188, s15
    v_mov_b32 v189, s15
    v_mov_b32 v190, s15
    v_mov_b32 v191, s15
    s_cmp_lt_u32 s59, 2
    s_cselect_b32 s15, 0xff800000, 0
    v_mov_b32 v192, s15
    v_mov_b32 v193, s15
    v_mov_b32 v194, s15
    v_mov_b32 v195, s15
    v_mov_b32 v196, s15
    v_mov_b32 v197, s15
    v_mov_b32 v198, s15
    v_mov_b32 v199, s15
    v_mov_b32 v200, s15
    v_mov_b32 v201, s15
    v_mov_b32 v202, s15
    v_mov_b32 v203, s15
    v_mov_b32 v204, s15
    v_mov_b32 v205, s15
    v_mov_b32 v206, s15
    v_mov_b32 v207, s15
    s_cmp_lt_u32 s59, 1
    s_cselect_b32 s15, 0xff800000, 0
    v_mov_b32 v208, s15
    v_mov_b32 v209, s15
    v_mov_b32 v210, s15
    v_mov_b32 v211, s15
    v_mov_b32 v212, s15
    v_mov_b32 v213, s15
    v_mov_b32 v214, s15
    v_mov_b32 v215, s15
    v_mov_b32 v216, s15
    v_mov_b32 v217, s15
    v_mov_b32 v218, s15
    v_mov_b32 v219, s15
    v_mov_b32 v220, s15
    v_mov_b32 v221, s15
    v_mov_b32 v222, s15
    v_mov_b32 v223, s15
    v_add_u32 v21, 0, v20
    v_cmp_gt_u32 vcc, v21, v34
    s_nop 0
    s_nop 0
    v_cndmask_b32 v224, 0, v22, vcc
    v_add_u32 v21, 1, v20
    v_cmp_gt_u32 vcc, v21, v34
    s_nop 0
    s_nop 0
    v_cndmask_b32 v225, 0, v22, vcc
    v_add_u32 v21, 2, v20
    v_cmp_gt_u32 vcc, v21, v34
    s_nop 0
    s_nop 0
    v_cndmask_b32 v226, 0, v22, vcc
    v_add_u32 v21, 3, v20
    v_cmp_gt_u32 vcc, v21, v34
    s_nop 0
    s_nop 0
    v_cndmask_b32 v227, 0, v22, vcc
    v_add_u32 v21, 8, v20
    v_cmp_gt_u32 vcc, v21, v34
    s_nop 0
    s_nop 0
    v_cndmask_b32 v228, 0, v22, vcc
    v_add_u32 v21, 9, v20
    v_cmp_gt_u32 vcc, v21, v34
    s_nop 0
    s_nop 0
    v_cndmask_b32 v229, 0, v22, vcc
    v_add_u32 v21, 10, v20
    v_cmp_gt_u32 vcc, v21, v34
    s_nop 0
    s_nop 0
    v_cndmask_b32 v230, 0, v22, vcc
    v_add_u32 v21, 11, v20
    v_cmp_gt_u32 vcc, v21, v34
    s_nop 0
    s_nop 0
    v_cndmask_b32 v231, 0, v22, vcc
    v_add_u32 v21, 16, v20
    v_cmp_gt_u32 vcc, v21, v34
    s_nop 0
    s_nop 0
    v_cndmask_b32 v232, 0, v22, vcc
    v_add_u32 v21, 17, v20
    v_cmp_gt_u32 vcc, v21, v34
    s_nop 0
    s_nop 0
    v_cndmask_b32 v233, 0, v22, vcc
    v_add_u32 v21, 18, v20
    v_cmp_gt_u32 vcc, v21, v34
    s_nop 0
    s_nop 0
    v_cndmask_b32 v234, 0, v22, vcc
    v_add_u32 v21, 19, v20
    v_cmp_gt_u32 vcc, v21, v34
    s_nop 0
    s_nop 0
    v_cndmask_b32 v235, 0, v22, vcc
    v_add_u32 v21, 24, v20
    v_cmp_gt_u32 vcc, v21, v34
    s_nop 0
    s_nop 0
    v_cndmask_b32 v236, 0, v22, vcc
    v_add_u32 v21, 25, v20
    v_cmp_gt_u32 vcc, v21, v34
    s_nop 0
    s_nop 0
    v_cndmask_b32 v237, 0, v22, vcc
    v_add_u32 v21, 26, v20
    v_cmp_gt_u32 vcc, v21, v34
    s_nop 0
    s_nop 0
    v_cndmask_b32 v238, 0, v22, vcc
    v_add_u32 v21, 27, v20
    v_cmp_gt_u32 vcc, v21, v34
    s_nop 0
    s_nop 0
    v_cndmask_b32 v239, 0, v22, vcc
    ds_read_b128 a[0:3], v7 offset:0
    s_waitcnt lgkmcnt(0)
    v_mfma_f32_32x32x16_bf16 v[96:111], a[0:3], v[56:59], v[96:111]
    s_nop 7
    s_nop 7
    ds_read_b128 a[0:3], v7 offset:1024
    s_waitcnt lgkmcnt(0)
    v_mfma_f32_32x32x16_bf16 v[96:111], a[0:3], v[60:63], v[96:111]
    s_nop 7
    s_nop 7
    ds_read_b128 a[0:3], v7 offset:4096
    s_waitcnt lgkmcnt(0)
    v_mfma_f32_32x32x16_bf16 v[112:127], a[0:3], v[56:59], v[112:127]
    s_nop 7
    s_nop 7
    ds_read_b128 a[0:3], v7 offset:5120
    s_waitcnt lgkmcnt(0)
    v_mfma_f32_32x32x16_bf16 v[112:127], a[0:3], v[60:63], v[112:127]
    s_nop 7
    s_nop 7
    ds_read_b128 a[0:3], v7 offset:8192
    s_waitcnt lgkmcnt(0)
    v_mfma_f32_32x32x16_bf16 v[128:143], a[0:3], v[56:59], v[128:143]
    s_nop 7
    s_nop 7
    ds_read_b128 a[0:3], v7 offset:9216
    s_waitcnt lgkmcnt(0)
    v_mfma_f32_32x32x16_bf16 v[128:143], a[0:3], v[60:63], v[128:143]
    s_nop 7
    s_nop 7
    ds_read_b128 a[0:3], v7 offset:12288
    s_waitcnt lgkmcnt(0)
    v_mfma_f32_32x32x16_bf16 v[144:159], a[0:3], v[56:59], v[144:159]
    s_nop 7
    s_nop 7
    ds_read_b128 a[0:3], v7 offset:13312
    s_waitcnt lgkmcnt(0)
    v_mfma_f32_32x32x16_bf16 v[144:159], a[0:3], v[60:63], v[144:159]
    s_nop 7
    s_nop 7
    ds_read_b128 a[0:3], v7 offset:16384
    s_waitcnt lgkmcnt(0)
    v_mfma_f32_32x32x16_bf16 v[160:175], a[0:3], v[56:59], v[160:175]
    s_nop 7
    s_nop 7
    ds_read_b128 a[0:3], v7 offset:17408
    s_waitcnt lgkmcnt(0)
    v_mfma_f32_32x32x16_bf16 v[160:175], a[0:3], v[60:63], v[160:175]
    s_nop 7
    s_nop 7
    ds_read_b128 a[0:3], v7 offset:20480
    s_waitcnt lgkmcnt(0)
    v_mfma_f32_32x32x16_bf16 v[176:191], a[0:3], v[56:59], v[176:191]
    s_nop 7
    s_nop 7
    ds_read_b128 a[0:3], v7 offset:21504
    s_waitcnt lgkmcnt(0)
    v_mfma_f32_32x32x16_bf16 v[176:191], a[0:3], v[60:63], v[176:191]
    s_nop 7
    s_nop 7
    ds_read_b128 a[0:3], v7 offset:24576
    s_waitcnt lgkmcnt(0)
    v_mfma_f32_32x32x16_bf16 v[192:207], a[0:3], v[56:59], v[192:207]
    s_nop 7
    s_nop 7
    ds_read_b128 a[0:3], v7 offset:25600
    s_waitcnt lgkmcnt(0)
    v_mfma_f32_32x32x16_bf16 v[192:207], a[0:3], v[60:63], v[192:207]
    s_nop 7
    s_nop 7
    ds_read_b128 a[0:3], v7 offset:28672
    s_waitcnt lgkmcnt(0)
    v_mfma_f32_32x32x16_bf16 v[208:223], a[0:3], v[56:59], v[208:223]
    s_nop 7
    s_nop 7
    ds_read_b128 a[0:3], v7 offset:29696
    s_waitcnt lgkmcnt(0)
    v_mfma_f32_32x32x16_bf16 v[208:223], a[0:3], v[60:63], v[208:223]
    s_nop 7
    s_nop 7
    ds_read_b128 a[0:3], v7 offset:32768
    s_waitcnt lgkmcnt(0)
    v_mfma_f32_32x32x16_bf16 v[224:239], a[0:3], v[56:59], v[224:239]
    s_nop 7
    s_nop 7
    ds_read_b128 a[0:3], v7 offset:33792
    s_waitcnt lgkmcnt(0)
    v_mfma_f32_32x32x16_bf16 v[224:239], a[0:3], v[60:63], v[224:239]
    s_nop 7
    s_nop 7
    s_nop 7
    v_max_f32 v20, v96, v97
    v_max3_f32 v20, v20, v98, v99
    v_max3_f32 v20, v20, v100, v101
    v_max3_f32 v20, v20, v102, v103
    v_max3_f32 v20, v20, v104, v105
    v_max3_f32 v20, v20, v106, v107
    v_max3_f32 v20, v20, v108, v109
    v_max3_f32 v20, v20, v110, v111
    v_max3_f32 v20, v20, v112, v113
    v_max3_f32 v20, v20, v114, v115
    v_max3_f32 v20, v20, v116, v117
    v_max3_f32 v20, v20, v118, v119
    v_max3_f32 v20, v20, v120, v121
    v_max3_f32 v20, v20, v122, v123
    v_max3_f32 v20, v20, v124, v125
    v_max3_f32 v20, v20, v126, v127
    v_max3_f32 v20, v20, v128, v129
    v_max3_f32 v20, v20, v130, v131
    v_max3_f32 v20, v20, v132, v133
    v_max3_f32 v20, v20, v134, v135
    v_max3_f32 v20, v20, v136, v137
    v_max3_f32 v20, v20, v138, v139
    v_max3_f32 v20, v20, v140, v141
    v_max3_f32 v20, v20, v142, v143
    v_max3_f32 v20, v20, v144, v145
    v_max3_f32 v20, v20, v146, v147
    v_max3_f32 v20, v20, v148, v149
    v_max3_f32 v20, v20, v150, v151
    v_max3_f32 v20, v20, v152, v153
    v_max3_f32 v20, v20, v154, v155
    v_max3_f32 v20, v20, v156, v157
    v_max3_f32 v20, v20, v158, v159
    v_max3_f32 v20, v20, v160, v161
    v_max3_f32 v20, v20, v162, v163
    v_max3_f32 v20, v20, v164, v165
    v_max3_f32 v20, v20, v166, v167
    v_max3_f32 v20, v20, v168, v169
    v_max3_f32 v20, v20, v170, v171
    v_max3_f32 v20, v20, v172, v173
    v_max3_f32 v20, v20, v174, v175
    v_max3_f32 v20, v20, v176, v177
    v_max3_f32 v20, v20, v178, v179
    v_max3_f32 v20, v20, v180, v181
    v_max3_f32 v20, v20, v182, v183
    v_max3_f32 v20, v20, v184, v185
    v_max3_f32 v20, v20, v186, v187
    v_max3_f32 v20, v20, v188, v189
    v_max3_f32 v20, v20, v190, v191
    v_max3_f32 v20, v20, v192, v193
    v_max3_f32 v20, v20, v194, v195
    v_max3_f32 v20, v20, v196, v197
    v_max3_f32 v20, v20, v198, v199
    v_max3_f32 v20, v20, v200, v201
    v_max3_f32 v20, v20, v202, v203
    v_max3_f32 v20, v20, v204, v205
    v_max3_f32 v20, v20, v206, v207
    v_max3_f32 v20, v20, v208, v209
    v_max3_f32 v20, v20, v210, v211
    v_max3_f32 v20, v20, v212, v213
    v_max3_f32 v20, v20, v214, v215
    v_max3_f32 v20, v20, v216, v217
    v_max3_f32 v20, v20, v218, v219
    v_max3_f32 v20, v20, v220, v221
    v_max3_f32 v20, v20, v222, v223
    v_max3_f32 v20, v20, v224, v225
    v_max3_f32 v20, v20, v226, v227
    v_max3_f32 v20, v20, v228, v229
    v_max3_f32 v20, v20, v230, v231
    v_max3_f32 v20, v20, v232, v233
    v_max3_f32 v20, v20, v234, v235
    v_max3_f32 v20, v20, v236, v237
    v_max3_f32 v20, v20, v238, v239
    v_mov_b32 v21, v20
    s_nop 1
    v_permlane32_swap_b32 v20, v21
    s_nop 1
    v_max_f32 v20, v20, v21
    v_sub_f32 v96, v96, v20
    v_sub_f32 v97, v97, v20
    v_sub_f32 v98, v98, v20
    v_sub_f32 v99, v99, v20
    v_sub_f32 v100, v100, v20
    v_sub_f32 v101, v101, v20
    v_sub_f32 v102, v102, v20
    v_sub_f32 v103, v103, v20
    v_sub_f32 v104, v104, v20
    v_sub_f32 v105, v105, v20
    v_sub_f32 v106, v106, v20
    v_sub_f32 v107, v107, v20
    v_sub_f32 v108, v108, v20
    v_sub_f32 v109, v109, v20
    v_sub_f32 v110, v110, v20
    v_sub_f32 v111, v111, v20
    v_sub_f32 v112, v112, v20
    v_sub_f32 v113, v113, v20
    v_sub_f32 v114, v114, v20
    v_sub_f32 v115, v115, v20
    v_sub_f32 v116, v116, v20
    v_sub_f32 v117, v117, v20
    v_sub_f32 v118, v118, v20
    v_sub_f32 v119, v119, v20
    v_sub_f32 v120, v120, v20
    v_sub_f32 v121, v121, v20
    v_sub_f32 v122, v122, v20
    v_sub_f32 v123, v123, v20
    v_sub_f32 v124, v124, v20
    v_sub_f32 v125, v125, v20
    v_sub_f32 v126, v126, v20
    v_sub_f32 v127, v127, v20
    v_sub_f32 v128, v128, v20
    v_sub_f32 v129, v129, v20
    v_sub_f32 v130, v130, v20
    v_sub_f32 v131, v131, v20
    v_sub_f32 v132, v132, v20
    v_sub_f32 v133, v133, v20
    v_sub_f32 v134, v134, v20
    v_sub_f32 v135, v135, v20
    v_sub_f32 v136, v136, v20
    v_sub_f32 v137, v137, v20
    v_sub_f32 v138, v138, v20
    v_sub_f32 v139, v139, v20
    v_sub_f32 v140, v140, v20
    v_sub_f32 v141, v141, v20
    v_sub_f32 v142, v142, v20
    v_sub_f32 v143, v143, v20
    v_sub_f32 v144, v144, v20
    v_sub_f32 v145, v145, v20
    v_sub_f32 v146, v146, v20
    v_sub_f32 v147, v147, v20
    v_sub_f32 v148, v148, v20
    v_sub_f32 v149, v149, v20
    v_sub_f32 v150, v150, v20
    v_sub_f32 v151, v151, v20
    v_sub_f32 v152, v152, v20
    v_sub_f32 v153, v153, v20
    v_sub_f32 v154, v154, v20
    v_sub_f32 v155, v155, v20
    v_sub_f32 v156, v156, v20
    v_sub_f32 v157, v157, v20
    v_sub_f32 v158, v158, v20
    v_sub_f32 v159, v159, v20
    v_sub_f32 v160, v160, v20
    v_sub_f32 v161, v161, v20
    v_sub_f32 v162, v162, v20
    v_sub_f32 v163, v163, v20
    v_sub_f32 v164, v164, v20
    v_sub_f32 v165, v165, v20
    v_sub_f32 v166, v166, v20
    v_sub_f32 v167, v167, v20
    v_sub_f32 v168, v168, v20
    v_sub_f32 v169, v169, v20
    v_sub_f32 v170, v170, v20
    v_sub_f32 v171, v171, v20
    v_sub_f32 v172, v172, v20
    v_sub_f32 v173, v173, v20
    v_sub_f32 v174, v174, v20
    v_sub_f32 v175, v175, v20
    v_sub_f32 v176, v176, v20
    v_sub_f32 v177, v177, v20
    v_sub_f32 v178, v178, v20
    v_sub_f32 v179, v179, v20
    v_sub_f32 v180, v180, v20
    v_sub_f32 v181, v181, v20
    v_sub_f32 v182, v182, v20
    v_sub_f32 v183, v183, v20
    v_sub_f32 v184, v184, v20
    v_sub_f32 v185, v185, v20
    v_sub_f32 v186, v186, v20
    v_sub_f32 v187, v187, v20
    v_sub_f32 v188, v188, v20
    v_sub_f32 v189, v189, v20
    v_sub_f32 v190, v190, v20
    v_sub_f32 v191, v191, v20
    v_sub_f32 v192, v192, v20
    v_sub_f32 v193, v193, v20
    v_sub_f32 v194, v194, v20
    v_sub_f32 v195, v195, v20
    v_sub_f32 v196, v196, v20
    v_sub_f32 v197, v197, v20
    v_sub_f32 v198, v198, v20
    v_sub_f32 v199, v199, v20
    v_sub_f32 v200, v200, v20
    v_sub_f32 v201, v201, v20
    v_sub_f32 v202, v202, v20
    v_sub_f32 v203, v203, v20
    v_sub_f32 v204, v204, v20
    v_sub_f32 v205, v205, v20
    v_sub_f32 v206, v206, v20
    v_sub_f32 v207, v207, v20
    v_sub_f32 v208, v208, v20
    v_sub_f32 v209, v209, v20
    v_sub_f32 v210, v210, v20
    v_sub_f32 v211, v211, v20
    v_sub_f32 v212, v212, v20
    v_sub_f32 v213, v213, v20
    v_sub_f32 v214, v214, v20
    v_sub_f32 v215, v215, v20
    v_sub_f32 v216, v216, v20
    v_sub_f32 v217, v217, v20
    v_sub_f32 v218, v218, v20
    v_sub_f32 v219, v219, v20
    v_sub_f32 v220, v220, v20
    v_sub_f32 v221, v221, v20
    v_sub_f32 v222, v222, v20
    v_sub_f32 v223, v223, v20
    v_sub_f32 v224, v224, v20
    v_sub_f32 v225, v225, v20
    v_sub_f32 v226, v226, v20
    v_sub_f32 v227, v227, v20
    v_sub_f32 v228, v228, v20
    v_sub_f32 v229, v229, v20
    v_sub_f32 v230, v230, v20
    v_sub_f32 v231, v231, v20
    v_sub_f32 v232, v232, v20
    v_sub_f32 v233, v233, v20
    v_sub_f32 v234, v234, v20
    v_sub_f32 v235, v235, v20
    v_sub_f32 v236, v236, v20
    v_sub_f32 v237, v237, v20
    v_sub_f32 v238, v238, v20
    v_sub_f32 v239, v239, v20
    v_exp_f32 v96, v96
    v_exp_f32 v97, v97
    v_exp_f32 v98, v98
    v_exp_f32 v99, v99
    v_exp_f32 v100, v100
    v_exp_f32 v101, v101
    v_exp_f32 v102, v102
    v_exp_f32 v103, v103
    v_exp_f32 v104, v104
    v_exp_f32 v105, v105
    v_exp_f32 v106, v106
    v_exp_f32 v107, v107
    v_exp_f32 v108, v108
    v_exp_f32 v109, v109
    v_exp_f32 v110, v110
    v_exp_f32 v111, v111
    v_exp_f32 v112, v112
    v_exp_f32 v113, v113
    v_exp_f32 v114, v114
    v_exp_f32 v115, v115
    v_exp_f32 v116, v116
    v_exp_f32 v117, v117
    v_exp_f32 v118, v118
    v_exp_f32 v119, v119
    v_exp_f32 v120, v120
    v_exp_f32 v121, v121
    v_exp_f32 v122, v122
    v_exp_f32 v123, v123
    v_exp_f32 v124, v124
    v_exp_f32 v125, v125
    v_exp_f32 v126, v126
    v_exp_f32 v127, v127
    v_exp_f32 v128, v128
    v_exp_f32 v129, v129
    v_exp_f32 v130, v130
    v_exp_f32 v131, v131
    v_exp_f32 v132, v132
    v_exp_f32 v133, v133
    v_exp_f32 v134, v134
    v_exp_f32 v135, v135
    v_exp_f32 v136, v136
    v_exp_f32 v137, v137
    v_exp_f32 v138, v138
    v_exp_f32 v139, v139
    v_exp_f32 v140, v140
    v_exp_f32 v141, v141
    v_exp_f32 v142, v142
    v_exp_f32 v143, v143
    v_exp_f32 v144, v144
    v_exp_f32 v145, v145
    v_exp_f32 v146, v146
    v_exp_f32 v147, v147
    v_exp_f32 v148, v148
    v_exp_f32 v149, v149
    v_exp_f32 v150, v150
    v_exp_f32 v151, v151
    v_exp_f32 v152, v152
    v_exp_f32 v153, v153
    v_exp_f32 v154, v154
    v_exp_f32 v155, v155
    v_exp_f32 v156, v156
    v_exp_f32 v157, v157
    v_exp_f32 v158, v158
    v_exp_f32 v159, v159
    v_exp_f32 v160, v160
    v_exp_f32 v161, v161
    v_exp_f32 v162, v162
    v_exp_f32 v163, v163
    v_exp_f32 v164, v164
    v_exp_f32 v165, v165
    v_exp_f32 v166, v166
    v_exp_f32 v167, v167
    v_exp_f32 v168, v168
    v_exp_f32 v169, v169
    v_exp_f32 v170, v170
    v_exp_f32 v171, v171
    v_exp_f32 v172, v172
    v_exp_f32 v173, v173
    v_exp_f32 v174, v174
    v_exp_f32 v175, v175
    v_exp_f32 v176, v176
    v_exp_f32 v177, v177
    v_exp_f32 v178, v178
    v_exp_f32 v179, v179
    v_exp_f32 v180, v180
    v_exp_f32 v181, v181
    v_exp_f32 v182, v182
    v_exp_f32 v183, v183
    v_exp_f32 v184, v184
    v_exp_f32 v185, v185
    v_exp_f32 v186, v186
    v_exp_f32 v187, v187
    v_exp_f32 v188, v188
    v_exp_f32 v189, v189
    v_exp_f32 v190, v190
    v_exp_f32 v191, v191
    v_exp_f32 v192, v192
    v_exp_f32 v193, v193
    v_exp_f32 v194, v194
    v_exp_f32 v195, v195
    v_exp_f32 v196, v196
    v_exp_f32 v197, v197
    v_exp_f32 v198, v198
    v_exp_f32 v199, v199
    v_exp_f32 v200, v200
    v_exp_f32 v201, v201
    v_exp_f32 v202, v202
    v_exp_f32 v203, v203
    v_exp_f32 v204, v204
    v_exp_f32 v205, v205
    v_exp_f32 v206, v206
    v_exp_f32 v207, v207
    v_exp_f32 v208, v208
    v_exp_f32 v209, v209
    v_exp_f32 v210, v210
    v_exp_f32 v211, v211
    v_exp_f32 v212, v212
    v_exp_f32 v213, v213
    v_exp_f32 v214, v214
    v_exp_f32 v215, v215
    v_exp_f32 v216, v216
    v_exp_f32 v217, v217
    v_exp_f32 v218, v218
    v_exp_f32 v219, v219
    v_exp_f32 v220, v220
    v_exp_f32 v221, v221
    v_exp_f32 v222, v222
    v_exp_f32 v223, v223
    v_exp_f32 v224, v224
    v_exp_f32 v225, v225
    v_exp_f32 v226, v226
    v_exp_f32 v227, v227
    v_exp_f32 v228, v228
    v_exp_f32 v229, v229
    v_exp_f32 v230, v230
    v_exp_f32 v231, v231
    v_exp_f32 v232, v232
    v_exp_f32 v233, v233
    v_exp_f32 v234, v234
    v_exp_f32 v235, v235
    v_exp_f32 v236, v236
    v_exp_f32 v237, v237
    v_exp_f32 v238, v238
    v_exp_f32 v239, v239
    s_nop 0
    v_cvt_pk_bf16_f32 v96, v96, v97
    v_cvt_pk_bf16_f32 v97, v98, v99
    v_cvt_pk_bf16_f32 v98, v100, v101
    v_cvt_pk_bf16_f32 v99, v102, v103
    v_cvt_pk_bf16_f32 v100, v104, v105
    v_cvt_pk_bf16_f32 v101, v106, v107
    v_cvt_pk_bf16_f32 v102, v108, v109
    v_cvt_pk_bf16_f32 v103, v110, v111
    v_cvt_pk_bf16_f32 v112, v112, v113
    v_cvt_pk_bf16_f32 v113, v114, v115
    v_cvt_pk_bf16_f32 v114, v116, v117
    v_cvt_pk_bf16_f32 v115, v118, v119
    v_cvt_pk_bf16_f32 v116, v120, v121
    v_cvt_pk_bf16_f32 v117, v122, v123
    v_cvt_pk_bf16_f32 v118, v124, v125
    v_cvt_pk_bf16_f32 v119, v126, v127
    v_cvt_pk_bf16_f32 v128, v128, v129
    v_cvt_pk_bf16_f32 v129, v130, v131
    v_cvt_pk_bf16_f32 v130, v132, v133
    v_cvt_pk_bf16_f32 v131, v134, v135
    v_cvt_pk_bf16_f32 v132, v136, v137
    v_cvt_pk_bf16_f32 v133, v138, v139
    v_cvt_pk_bf16_f32 v134, v140, v141
    v_cvt_pk_bf16_f32 v135, v142, v143
    v_cvt_pk_bf16_f32 v144, v144, v145
    v_cvt_pk_bf16_f32 v145, v146, v147
    v_cvt_pk_bf16_f32 v146, v148, v149
    v_cvt_pk_bf16_f32 v147, v150, v151
    v_cvt_pk_bf16_f32 v148, v152, v153
    v_cvt_pk_bf16_f32 v149, v154, v155
    v_cvt_pk_bf16_f32 v150, v156, v157
    v_cvt_pk_bf16_f32 v151, v158, v159
    v_cvt_pk_bf16_f32 v160, v160, v161
    v_cvt_pk_bf16_f32 v161, v162, v163
    v_cvt_pk_bf16_f32 v162, v164, v165
    v_cvt_pk_bf16_f32 v163, v166, v167
    v_cvt_pk_bf16_f32 v164, v168, v169
    v_cvt_pk_bf16_f32 v165, v170, v171
    v_cvt_pk_bf16_f32 v166, v172, v173
    v_cvt_pk_bf16_f32 v167, v174, v175
    v_cvt_pk_bf16_f32 v176, v176, v177
    v_cvt_pk_bf16_f32 v177, v178, v179
    v_cvt_pk_bf16_f32 v178, v180, v181
    v_cvt_pk_bf16_f32 v179, v182, v183
    v_cvt_pk_bf16_f32 v180, v184, v185
    v_cvt_pk_bf16_f32 v181, v186, v187
    v_cvt_pk_bf16_f32 v182, v188, v189
    v_cvt_pk_bf16_f32 v183, v190, v191
    v_cvt_pk_bf16_f32 v192, v192, v193
    v_cvt_pk_bf16_f32 v193, v194, v195
    v_cvt_pk_bf16_f32 v194, v196, v197
    v_cvt_pk_bf16_f32 v195, v198, v199
    v_cvt_pk_bf16_f32 v196, v200, v201
    v_cvt_pk_bf16_f32 v197, v202, v203
    v_cvt_pk_bf16_f32 v198, v204, v205
    v_cvt_pk_bf16_f32 v199, v206, v207
    v_cvt_pk_bf16_f32 v208, v208, v209
    v_cvt_pk_bf16_f32 v209, v210, v211
    v_cvt_pk_bf16_f32 v210, v212, v213
    v_cvt_pk_bf16_f32 v211, v214, v215
    v_cvt_pk_bf16_f32 v212, v216, v217
    v_cvt_pk_bf16_f32 v213, v218, v219
    v_cvt_pk_bf16_f32 v214, v220, v221
    v_cvt_pk_bf16_f32 v215, v222, v223
    v_cvt_pk_bf16_f32 v224, v224, v225
    v_cvt_pk_bf16_f32 v225, v226, v227
    v_cvt_pk_bf16_f32 v226, v228, v229
    v_cvt_pk_bf16_f32 v227, v230, v231
    v_cvt_pk_bf16_f32 v228, v232, v233
    v_cvt_pk_bf16_f32 v229, v234, v235
    v_cvt_pk_bf16_f32 v230, v236, v237
    v_cvt_pk_bf16_f32 v231, v238, v239
    ds_read_b128 a[0:3], v7 offset:2048
    s_waitcnt lgkmcnt(0)
    v_mfma_f32_32x32x16_bf16 v[40:55], a[0:3], v[96:99], 0
    s_nop 7
    s_nop 7
    ds_read_b128 a[0:3], v7 offset:3072
    s_waitcnt lgkmcnt(0)
    v_mfma_f32_32x32x16_bf16 v[40:55], a[0:3], v[100:103], v[40:55]
    s_nop 7
    s_nop 7
    ds_read_b128 a[0:3], v7 offset:6144
    s_waitcnt lgkmcnt(0)
    v_mfma_f32_32x32x16_bf16 v[40:55], a[0:3], v[112:115], v[40:55]
    s_nop 7
    s_nop 7
    ds_read_b128 a[0:3], v7 offset:7168
    s_waitcnt lgkmcnt(0)
    v_mfma_f32_32x32x16_bf16 v[40:55], a[0:3], v[116:119], v[40:55]
    s_nop 7
    s_nop 7
    ds_read_b128 a[0:3], v7 offset:10240
    s_waitcnt lgkmcnt(0)
    v_mfma_f32_32x32x16_bf16 v[40:55], a[0:3], v[128:131], v[40:55]
    s_nop 7
    s_nop 7
    ds_read_b128 a[0:3], v7 offset:11264
    s_waitcnt lgkmcnt(0)
    v_mfma_f32_32x32x16_bf16 v[40:55], a[0:3], v[132:135], v[40:55]
    s_nop 7
    s_nop 7
    ds_read_b128 a[0:3], v7 offset:14336
    s_waitcnt lgkmcnt(0)
    v_mfma_f32_32x32x16_bf16 v[40:55], a[0:3], v[144:147], v[40:55]
    s_nop 7
    s_nop 7
    ds_read_b128 a[0:3], v7 offset:15360
    s_waitcnt lgkmcnt(0)
    v_mfma_f32_32x32x16_bf16 v[40:55], a[0:3], v[148:151], v[40:55]
    s_nop 7
    s_nop 7
    ds_read_b128 a[0:3], v7 offset:18432
    s_waitcnt lgkmcnt(0)
    v_mfma_f32_32x32x16_bf16 v[40:55], a[0:3], v[160:163], v[40:55]
    s_nop 7
    s_nop 7
    ds_read_b128 a[0:3], v7 offset:19456
    s_waitcnt lgkmcnt(0)
    v_mfma_f32_32x32x16_bf16 v[40:55], a[0:3], v[164:167], v[40:55]
    s_nop 7
    s_nop 7
    ds_read_b128 a[0:3], v7 offset:22528
    s_waitcnt lgkmcnt(0)
    v_mfma_f32_32x32x16_bf16 v[40:55], a[0:3], v[176:179], v[40:55]
    s_nop 7
    s_nop 7
    ds_read_b128 a[0:3], v7 offset:23552
    s_waitcnt lgkmcnt(0)
    v_mfma_f32_32x32x16_bf16 v[40:55], a[0:3], v[180:183], v[40:55]
    s_nop 7
    s_nop 7
    ds_read_b128 a[0:3], v7 offset:26624
    s_waitcnt lgkmcnt(0)
    v_mfma_f32_32x32x16_bf16 v[40:55], a[0:3], v[192:195], v[40:55]
    s_nop 7
    s_nop 7
    ds_read_b128 a[0:3], v7 offset:27648
    s_waitcnt lgkmcnt(0)
    v_mfma_f32_32x32x16_bf16 v[40:55], a[0:3], v[196:199], v[40:55]
    s_nop 7
    s_nop 7
    ds_read_b128 a[0:3], v7 offset:30720
    s_waitcnt lgkmcnt(0)
    v_mfma_f32_32x32x16_bf16 v[40:55], a[0:3], v[208:211], v[40:55]
    s_nop 7
    s_nop 7
    ds_read_b128 a[0:3], v7 offset:31744
    s_waitcnt lgkmcnt(0)
    v_mfma_f32_32x32x16_bf16 v[40:55], a[0:3], v[212:215], v[40:55]
    s_nop 7
    s_nop 7
    ds_read_b128 a[0:3], v7 offset:34816
    s_waitcnt lgkmcnt(0)
    v_mfma_f32_32x32x16_bf16 v[40:55], a[0:3], v[224:227], v[40:55]
    s_nop 7
    s_nop 7
    ds_read_b128 a[0:3], v7 offset:35840
    s_waitcnt lgkmcnt(0)
    v_mfma_f32_32x32x16_bf16 v[40:55], a[0:3], v[228:231], v[40:55]
    s_nop 7
    s_nop 7
    s_nop 7
    s_branch k2_norm
code_end:
.section .rodata,"a"
.p2align 6
.amdhsa_kernel k1_main_kernel
  .amdhsa_next_free_vgpr 512
  .amdhsa_next_free_sgpr 102
  .amdhsa_accum_offset 256
  .amdhsa_group_segment_fixed_size 0
  .amdhsa_kernarg_size 96
  .amdhsa_user_sgpr_count 2
  .amdhsa_user_sgpr_kernarg_segment_ptr 1
  .amdhsa_system_sgpr_workgroup_id_x 1
.end_amdhsa_kernel
```
